```python
import torch

def _softmax(x, axis=-1):
    return torch.softmax(x, dim=axis)

def _gelu(x):
    return torch.nn.functional.gelu(x, approximate='tanh')

def _silu(x):
    return torch.nn.functional.silu(x)

def _sigmoid(x):
    return torch.sigmoid(x)

def _layernorm(x, axis=-1, eps=1e-05):
    m = x.mean(dim=axis, keepdim=True)
    v = x.var(dim=axis, keepdim=True, unbiased=False)
    return (x - m) / torch.sqrt(v + eps)

def _scatter_add(tgt, idx, src, axis=0):
    return tgt.clone().index_add_(axis, idx, src)

def _segment_sum(src, seg, n):
    out = torch.zeros((n,) + src.shape[1:], dtype=src.dtype)
    return out.index_add_(0, seg, src)

def _pad(x, pw):
    flat = tuple((v for pair in reversed(pw) for v in pair))
    return torch.nn.functional.pad(x, flat)
kernel_name = 'sequential_preLN__memory_aug_recurrent_mem_tr__mixer_token_mlp__prompt'

def setup_inputs():

    _w = lambda a: (lambda t: t.to(torch.bfloat16) if t.is_floating_point() else t)(torch.as_tensor(a))

    def _A_setup():
        B, S, Dm = (1, 2048, 512)
        H, Dh = (32, 128)
        M, seg = (8, 32)
        seg = min(seg, S)
        S = S // seg * seg
        return {'x': _w((lambda *s: torch.randn(*s, dtype=torch.bfloat16) * 0.05)(B, S, Dm)), 'mem0': _w((lambda *s: torch.randn(*s, dtype=torch.bfloat16) * 0.2)(B, M, Dm)), 'Wq': _w((lambda *s: torch.randn(*s, dtype=torch.bfloat16) * 1.6)(Dm, H, Dh) * Dm ** (-0.5)), 'Wk': _w((lambda *s: torch.randn(*s, dtype=torch.bfloat16) * 1.6)(Dm, H, Dh) * Dm ** (-0.5)), 'Wv': _w((lambda *s: torch.randn(*s, dtype=torch.bfloat16) * 0.2)(Dm, H, Dh) * Dm ** (-0.5)), 'Wo': _w((lambda *s: torch.randn(*s, dtype=torch.bfloat16) * 0.2)(H, Dh, Dm) * (H * Dh) ** (-0.5)), 'seg_len': seg}
    _A_in = _A_setup()

    def _B_setup():
        B, S, D, F = (1, 2048, 512, 1792)
        return {'x': _w((lambda *s: torch.randn(*s, dtype=torch.bfloat16) * 0.05)(B, S, D)), 'w1': _w((lambda *s: torch.randn(*s, dtype=torch.bfloat16) * 0.4)(S, F) * S ** (-0.5)), 'b1': _w((lambda *s: torch.randn(*s, dtype=torch.bfloat16) * 3.2)(F) * 0.02), 'w2': _w((lambda *s: torch.randn(*s, dtype=torch.bfloat16) * 0.2)(F, S) * F ** (-0.5)), 'b2': _w((lambda *s: torch.randn(*s, dtype=torch.bfloat16) * 0.4)(S) * 0.02)}
    _B_in = _B_setup()
    return {'A_x': _A_in['x'], 'A_mem0': _A_in['mem0'], 'A_Wq': _A_in['Wq'], 'A_Wk': _A_in['Wk'], 'A_Wv': _A_in['Wv'], 'A_Wo': _A_in['Wo'], 'A_seg_len': _A_in['seg_len'], 'B_x': _B_in['x'], 'B_w1': _B_in['w1'], 'B_b1': _B_in['b1'], 'B_w2': _B_in['w2'], 'B_b2': _B_in['b2']}

def reference(A_x, A_mem0, A_Wq, A_Wk, A_Wv, A_Wo, A_seg_len, B_x, B_w1, B_b1, B_w2, B_b2):

    def _A_ref(x, mem0, Wq, Wk, Wv, Wo, seg_len):
        B, S, Dm = x.shape
        H, Dh = (Wq.shape[1], Wq.shape[2])
        M = mem0.shape[1]
        scale = Dh ** (-0.5)
        n_seg = S // seg_len
        L = M + seg_len
        idx = torch.arange(L)
        mask = (idx[:, None] < M) | (idx[:, None] >= idx[None, :])
        mem = mem0
        outs = []
        for s in range(n_seg):
            xs = x[:, s * seg_len:(s + 1) * seg_len, :].clone()
            h = torch.concatenate([mem, xs], axis=1)
            q = torch.einsum('btd,dhe->bhte', h, Wq)
            k = torch.einsum('btd,dhe->bhte', h, Wk)
            v = torch.einsum('btd,dhe->bhte', h, Wv)
            scores = torch.einsum('bhqe,bhke->bhqk', q, k) * scale
            scores = torch.where(mask[None, None], scores, -1000000000.0)
            p = _softmax(scores, axis=-1)
            o = torch.einsum('bhqk,bhke->bhqe', p, v)
            o = torch.einsum('bhte,hed->btd', o, Wo)
            mem = o[:, :M, :].clone()
            outs.append(o[:, M:, :])
        return torch.concatenate(outs, axis=1)

    def _B_ref(x, w1, b1, w2, b2):
        B, S, D = x.shape
        h = _layernorm(x, axis=-1)
        u = torch.einsum('bsd,sf->bdf', h, w1) + b1
        u = _gelu(u)
        y = torch.einsum('bdf,fs->bds', u, w2) + b2
        return (lambda x, *d: x.permute(*d))(y, 0, 2, 1)
    x = A_x
    h = x + _A_ref(_layernorm(x, axis=-1), A_mem0, A_Wq, A_Wk, A_Wv, A_Wo, A_seg_len)
    h2 = h + _B_ref(_layernorm(h, axis=-1), B_w1, B_b1, B_w2, B_b2)
    return h2
```

```asm
; @launch kernel=mega_kernel grid=(256,1,1) block=(256,1,1) lds=163840
.amdgcn_target "amdgcn-amd-amdhsa--gfx950"
.text
.globl mega_kernel
.p2align 8
.type mega_kernel,@function
mega_kernel:
    s_cmp_ge_u32 s2, 256
    s_cbranch_scc1 L_m_exit
    s_load_dwordx2 s[4:5], s[0:1], 104
    s_getreg_b32 s6, hwreg(HW_REG_XCC_ID)
    v_lshrrev_b32 v1, 6, v0
    s_and_b32 s6, s6, 7
    s_xor_b32 s6, s6, 7
    v_readfirstlane_b32 s100, v1
    v_mov_b32 v4, 0
    s_waitcnt lgkmcnt(0)
    s_mov_b32 s8, s4
    s_and_b32 s9, s5, 0xffff
    s_mov_b32 s10, 256
    s_mov_b32 s11, 0x00020000
    s_cmp_lg_u32 s100, 0
    s_cbranch_scc1 L_m_bc
    s_mov_b64 exec, 1
    v_mov_b32 v2, 1
    v_mov_b32 v5, 1
    s_lshl_b32 s7, s6, 2
    v_mov_b32 v3, s7
    buffer_atomic_add v2, v3, s[8:11], 0 offen sc0
    s_waitcnt vmcnt(0)
    buffer_atomic_add v5, v4, s[8:11], 0 offen offset:32
    v_readfirstlane_b32 s7, v2
    s_lshl_b32 s12, s6, 5
    s_add_u32 s12, s12, s7
    s_cmp_lt_u32 s7, 32
    s_cbranch_scc1 L_m_have
    s_mov_b32 s13, 2000000
L_m_ovf:
    buffer_load_dword v2, v4, s[8:11], 0 offen offset:32 sc1
    s_waitcnt vmcnt(0)
    v_readfirstlane_b32 s7, v2
    s_mov_b32 s12, 0xffff
    s_sub_u32 s13, s13, 1
    s_cbranch_scc1 L_m_have
    s_sleep 8
    s_cmp_lt_u32 s7, 256
    s_cbranch_scc1 L_m_ovf
    v_mov_b32 v2, 1
    buffer_atomic_add v2, v4, s[8:11], 0 offen offset:36 sc0
    buffer_load_dwordx4 v[8:11], v4, s[8:11], 0 offen sc1
    buffer_load_dwordx4 v[12:15], v4, s[8:11], 0 offen offset:16 sc1
    s_waitcnt vmcnt(0)
    v_readfirstlane_b32 s7, v2
    v_readfirstlane_b32 s13, v8
    s_min_u32 s13, s13, 32
    s_sub_u32 s14, 32, s13
    s_cmp_lt_u32 s7, s14
    s_cbranch_scc0 L_ov_1
    s_add_u32 s12, s13, 0
    s_add_u32 s12, s12, s7
    s_branch L_m_have
L_ov_1:
    s_sub_u32 s7, s7, s14
    v_readfirstlane_b32 s13, v9
    s_min_u32 s13, s13, 32
    s_sub_u32 s14, 32, s13
    s_cmp_lt_u32 s7, s14
    s_cbranch_scc0 L_ov_2
    s_add_u32 s12, s13, 32
    s_add_u32 s12, s12, s7
    s_branch L_m_have
L_ov_2:
    s_sub_u32 s7, s7, s14
    v_readfirstlane_b32 s13, v10
    s_min_u32 s13, s13, 32
    s_sub_u32 s14, 32, s13
    s_cmp_lt_u32 s7, s14
    s_cbranch_scc0 L_ov_3
    s_add_u32 s12, s13, 64
    s_add_u32 s12, s12, s7
    s_branch L_m_have
L_ov_3:
    s_sub_u32 s7, s7, s14
    v_readfirstlane_b32 s13, v11
    s_min_u32 s13, s13, 32
    s_sub_u32 s14, 32, s13
    s_cmp_lt_u32 s7, s14
    s_cbranch_scc0 L_ov_4
    s_add_u32 s12, s13, 96
    s_add_u32 s12, s12, s7
    s_branch L_m_have
L_ov_4:
    s_sub_u32 s7, s7, s14
    v_readfirstlane_b32 s13, v12
    s_min_u32 s13, s13, 32
    s_sub_u32 s14, 32, s13
    s_cmp_lt_u32 s7, s14
    s_cbranch_scc0 L_ov_5
    s_add_u32 s12, s13, 128
    s_add_u32 s12, s12, s7
    s_branch L_m_have
L_ov_5:
    s_sub_u32 s7, s7, s14
    v_readfirstlane_b32 s13, v13
    s_min_u32 s13, s13, 32
    s_sub_u32 s14, 32, s13
    s_cmp_lt_u32 s7, s14
    s_cbranch_scc0 L_ov_6
    s_add_u32 s12, s13, 160
    s_add_u32 s12, s12, s7
    s_branch L_m_have
L_ov_6:
    s_sub_u32 s7, s7, s14
    v_readfirstlane_b32 s13, v14
    s_min_u32 s13, s13, 32
    s_sub_u32 s14, 32, s13
    s_cmp_lt_u32 s7, s14
    s_cbranch_scc0 L_ov_7
    s_add_u32 s12, s13, 192
    s_add_u32 s12, s12, s7
    s_branch L_m_have
L_ov_7:
    s_sub_u32 s7, s7, s14
    v_readfirstlane_b32 s13, v15
    s_min_u32 s13, s13, 32
    s_sub_u32 s14, 32, s13
    s_cmp_lt_u32 s7, s14
    s_cbranch_scc0 L_ov_8
    s_add_u32 s12, s13, 224
    s_add_u32 s12, s12, s7
    s_branch L_m_have
L_ov_8:
    s_sub_u32 s7, s7, s14
L_m_have:
    v_mov_b32 v2, s12
    ds_write_b32 v4, v2
    s_waitcnt lgkmcnt(0)
    s_mov_b64 exec, -1
L_m_bc:
    s_barrier
    ds_read_b32 v2, v4
    s_waitcnt lgkmcnt(0)
    v_readfirstlane_b32 s2, v2
    s_barrier
    s_cmp_ge_u32 s2, 256
    s_cbranch_scc1 L_m_exit
    s_mov_b32 s98, s2
    s_mov_b32 s99, 0
    s_cmp_lt_u32 s2, 32
    s_cbranch_scc1 L_m_rec
    s_sub_u32 s101, s2, 32
    s_load_dwordx2 s[32:33], s[0:1], 0
    s_load_dwordx4 s[36:39], s[0:1], 16
    s_load_dwordx4 s[40:43], s[0:1], 32
    s_load_dwordx4 s[44:47], s[0:1], 104
    v_and_b32 v1, 63, v0
    s_mov_b32 s4, s100
    s_lshr_b32 s6, s101, 2
    s_and_b32 s5, s101, 3
    s_mov_b32 s52, 2
    s_cmp_lt_u32 s101, 64
    s_cbranch_scc1 L_w_i0
    s_sub_u32 s20, s101, 64
    s_mul_hi_u32 s6, s20, 429496730
    s_mul_i32 s7, s6, 10
    s_sub_u32 s5, s20, s7
    s_lshl_b32 s5, s5, 1
    s_add_u32 s5, s5, 4
    s_mov_b32 s52, 4
L_w_i0:
    s_mov_b32 s23, 0x05040100
    s_mov_b32 s24, 0x07060302
    s_mov_b32 s25, 0x3f803f80
    s_mov_b32 s29, 0
    s_lshl_b32 s27, s6, 2
    s_waitcnt lgkmcnt(0)
    s_mov_b32 s8, s46
    s_and_b32 s9, s47, 0xffff
    s_mov_b32 s10, 268435456
    s_mov_b32 s11, 0x00020000
    s_mov_b32 s12, s32
    s_and_b32 s13, s33, 0xffff
    s_mov_b32 s14, 2097152
    s_mov_b32 s15, 0x00020000
    s_mov_b32 s48, s44
    s_and_b32 s49, s45, 0xffff
    s_mov_b32 s50, 256
    s_mov_b32 s51, 0x00020000
    v_lshrrev_b32 v2, 4, v1
    v_and_b32 v3, 15, v1
    v_lshlrev_b32 v14, 4, v3
    v_lshl_add_u32 v14, v2, 10, v14
    v_mul_u32_u24 v7, 528, v3
    v_lshl_add_u32 v7, v2, 4, v7
    v_lshrrev_b32 v2, 5, v1
    v_lshlrev_b32 v2, 3, v2
    v_bfe_u32 v16, v1, 4, 1
    v_add_u32 v2, v2, v16
    v_mul_u32_u24 v2, 8192, v2
    v_and_b32 v16, 15, v1
    v_lshl_add_u32 v16, v16, 4, v2
    v_add_u32 v17, 16384, v16
    v_add_u32 v18, 32768, v16
    v_add_u32 v19, 49152, v16
    v_and_b32 v2, 3, v1
    v_bfe_u32 v3, v1, 2, 2
    v_lshl_add_u32 v2, v3, 3, v2
    v_bfe_u32 v3, v1, 4, 1
    v_lshl_add_u32 v2, v3, 2, v2
    v_lshrrev_b32 v4, 5, v1
    v_mul_u32_u24 v4, 528, v4
    v_add_u32 v4, 256, v4
    v_lshl_add_u32 v12, v2, 4, v4
    v_and_b32 v2, 19, v1
    v_bfe_u32 v3, v1, 2, 1
    v_lshl_add_u32 v2, v3, 3, v2
    v_bfe_u32 v3, v1, 3, 1
    v_lshl_add_u32 v2, v3, 2, v2
    v_lshl_add_u32 v13, v2, 4, v4
    v_and_b32 v2, 15, v1
    v_lshlrev_b32 v5, 4, v2
    v_bfe_u32 v3, v1, 4, 1
    v_lshl_add_u32 v5, v3, 12, v5
    v_lshrrev_b32 v3, 5, v1
    v_lshl_add_u32 v5, v3, 10, v5
    v_lshlrev_b32 v6, 8, v3
    v_and_b32 v2, 3, v1
    v_lshl_add_u32 v6, v2, 6, v6
    v_bfe_u32 v2, v1, 2, 2
    v_lshl_add_u32 v6, v2, 10, v6
    v_bfe_u32 v2, v1, 4, 1
    v_lshl_add_u32 v6, v2, 5, v6
    s_lshl_b32 s7, s4, 12
    s_add_u32 s7, s7, 135424
    v_add_u32 v6, s7, v6
    v_lshlrev_b32 v15, 4, v1
    v_add_u32 v20, s7, v15
    s_mov_b32 s97, 1
L_w_stage:
    s_lshl_b32 s7, s5, 16
    s_cmp_eq_u32 s52, 2
    s_cbranch_scc1 L_w_st2
    s_lshl_b32 s20, s4, 15
    s_add_u32 s7, s7, s20
    s_mul_i32 s20, s4, 33792
    s_add_u32 s20, s20, 256
    v_add_u32 v21, s20, v7
    buffer_load_dwordx4 v[64:67], v14, s[12:15], s7 offen offset:0
    buffer_load_dwordx4 v[68:71], v14, s[12:15], s7 offen offset:256
    buffer_load_dwordx4 v[72:75], v14, s[12:15], s7 offen offset:512
    buffer_load_dwordx4 v[76:79], v14, s[12:15], s7 offen offset:768
    s_add_u32 s7, s7, 4096
    buffer_load_dwordx4 v[80:83], v14, s[12:15], s7 offen offset:0
    buffer_load_dwordx4 v[84:87], v14, s[12:15], s7 offen offset:256
    buffer_load_dwordx4 v[88:91], v14, s[12:15], s7 offen offset:512
    buffer_load_dwordx4 v[92:95], v14, s[12:15], s7 offen offset:768
    s_add_u32 s7, s7, 4096
    buffer_load_dwordx4 v[96:99], v14, s[12:15], s7 offen offset:0
    buffer_load_dwordx4 v[100:103], v14, s[12:15], s7 offen offset:256
    buffer_load_dwordx4 v[104:107], v14, s[12:15], s7 offen offset:512
    buffer_load_dwordx4 v[108:111], v14, s[12:15], s7 offen offset:768
    s_add_u32 s7, s7, 4096
    buffer_load_dwordx4 v[112:115], v14, s[12:15], s7 offen offset:0
    buffer_load_dwordx4 v[116:119], v14, s[12:15], s7 offen offset:256
    buffer_load_dwordx4 v[120:123], v14, s[12:15], s7 offen offset:512
    buffer_load_dwordx4 v[124:127], v14, s[12:15], s7 offen offset:768
    s_add_u32 s7, s7, 4096
    s_branch L_w_st3
L_w_st2:
    s_lshl_b32 s20, s4, 14
    s_add_u32 s7, s7, s20
    s_lshr_b32 s20, s4, 1
    s_mul_i32 s20, s20, 33792
    v_add_u32 v21, s20, v7
    s_and_b32 s20, s4, 1
    s_lshl_b32 s20, s20, 8
    v_add_u32 v21, s20, v21
L_w_st3:
    buffer_load_dwordx4 v[128:131], v14, s[12:15], s7 offen offset:0
    buffer_load_dwordx4 v[132:135], v14, s[12:15], s7 offen offset:256
    buffer_load_dwordx4 v[136:139], v14, s[12:15], s7 offen offset:512
    buffer_load_dwordx4 v[140:143], v14, s[12:15], s7 offen offset:768
    s_add_u32 s7, s7, 4096
    buffer_load_dwordx4 v[144:147], v14, s[12:15], s7 offen offset:0
    buffer_load_dwordx4 v[148:151], v14, s[12:15], s7 offen offset:256
    buffer_load_dwordx4 v[152:155], v14, s[12:15], s7 offen offset:512
    buffer_load_dwordx4 v[156:159], v14, s[12:15], s7 offen offset:768
    s_add_u32 s7, s7, 4096
    buffer_load_dwordx4 v[160:163], v14, s[12:15], s7 offen offset:0
    buffer_load_dwordx4 v[164:167], v14, s[12:15], s7 offen offset:256
    buffer_load_dwordx4 v[168:171], v14, s[12:15], s7 offen offset:512
    buffer_load_dwordx4 v[172:175], v14, s[12:15], s7 offen offset:768
    s_add_u32 s7, s7, 4096
    buffer_load_dwordx4 v[176:179], v14, s[12:15], s7 offen offset:0
    buffer_load_dwordx4 v[180:183], v14, s[12:15], s7 offen offset:256
    buffer_load_dwordx4 v[184:187], v14, s[12:15], s7 offen offset:512
    buffer_load_dwordx4 v[188:191], v14, s[12:15], s7 offen offset:768
    s_add_u32 s7, s7, 4096
    s_cmp_lg_u32 s29, 0
    s_cbranch_scc1 L_w_nopt
    s_lshl_b32 s7, s101, 2
    s_add_u32 s7, s7, s4
    s_mul_i32 s7, s7, 5120
    v_lshlrev_b32 v2, 7, v1
    s_mov_b32 exec_hi, 0xff
    s_mov_b32 s16, s36
    s_and_b32 s17, s37, 0xffff
    s_mov_b32 s18, 4194304
    s_mov_b32 s19, 0x00020000
    buffer_load_dword v240, v2, s[16:19], s7 offen
    s_mov_b32 s16, s42
    s_and_b32 s17, s43, 0xffff
    s_mov_b32 s18, 4194304
    s_mov_b32 s19, 0x00020000
    buffer_load_dword v241, v2, s[16:19], s7 offen
    s_mov_b64 exec, -1
L_w_nopt:
    s_cmp_eq_u32 s52, 2
    s_cbranch_scc1 L_w_st4
    s_waitcnt vmcnt(28)
    v_mov_b32 v224, 0
    v_dot2_f32_bf16 v224, v64, s25, v224
    v_dot2_f32_bf16 v224, v65, s25, v224
    v_dot2_f32_bf16 v224, v66, s25, v224
    v_dot2_f32_bf16 v224, v67, s25, v224
    v_dot2_f32_bf16 v224, v68, s25, v224
    v_dot2_f32_bf16 v224, v69, s25, v224
    v_dot2_f32_bf16 v224, v70, s25, v224
    v_dot2_f32_bf16 v224, v71, s25, v224
    v_dot2_f32_bf16 v224, v72, s25, v224
    v_dot2_f32_bf16 v224, v73, s25, v224
    v_dot2_f32_bf16 v224, v74, s25, v224
    v_dot2_f32_bf16 v224, v75, s25, v224
    v_dot2_f32_bf16 v224, v76, s25, v224
    v_dot2_f32_bf16 v224, v77, s25, v224
    v_dot2_f32_bf16 v224, v78, s25, v224
    v_dot2_f32_bf16 v224, v79, s25, v224
    s_nop 2
    s_nop 1
    v_add_f32_dpp v224, v224, v224 row_ror:8 row_mask:0xf bank_mask:0xf
    s_nop 1
    v_add_f32_dpp v224, v224, v224 row_ror:4 row_mask:0xf bank_mask:0xf
    s_nop 1
    v_add_f32_dpp v224, v224, v224 row_ror:2 row_mask:0xf bank_mask:0xf
    s_nop 1
    v_add_f32_dpp v224, v224, v224 row_ror:1 row_mask:0xf bank_mask:0xf
    v_mul_f32 v226, 0xbb000000, v224
    v_cvt_pk_bf16_f32 v226, v226, v226
    v_lshlrev_b32 v226, 16, v226
    v_mov_b32 v227, v226
    v_lshlrev_b32 v192, 16, v64
    v_and_b32 v193, 0xffff0000, v64
    v_lshlrev_b32 v194, 16, v65
    v_and_b32 v195, 0xffff0000, v65
    v_lshlrev_b32 v196, 16, v66
    v_and_b32 v197, 0xffff0000, v66
    v_lshlrev_b32 v198, 16, v67
    v_and_b32 v199, 0xffff0000, v67
    v_lshlrev_b32 v200, 16, v68
    v_and_b32 v201, 0xffff0000, v68
    v_lshlrev_b32 v202, 16, v69
    v_and_b32 v203, 0xffff0000, v69
    v_lshlrev_b32 v204, 16, v70
    v_and_b32 v205, 0xffff0000, v70
    v_lshlrev_b32 v206, 16, v71
    v_and_b32 v207, 0xffff0000, v71
    v_lshlrev_b32 v208, 16, v72
    v_and_b32 v209, 0xffff0000, v72
    v_lshlrev_b32 v210, 16, v73
    v_and_b32 v211, 0xffff0000, v73
    v_lshlrev_b32 v212, 16, v74
    v_and_b32 v213, 0xffff0000, v74
    v_lshlrev_b32 v214, 16, v75
    v_and_b32 v215, 0xffff0000, v75
    v_lshlrev_b32 v216, 16, v76
    v_and_b32 v217, 0xffff0000, v76
    v_lshlrev_b32 v218, 16, v77
    v_and_b32 v219, 0xffff0000, v77
    v_lshlrev_b32 v220, 16, v78
    v_and_b32 v221, 0xffff0000, v78
    v_lshlrev_b32 v222, 16, v79
    v_and_b32 v223, 0xffff0000, v79
    v_pk_add_f32 v[192:193], v[192:193], v[226:227]
    v_pk_add_f32 v[194:195], v[194:195], v[226:227]
    v_pk_add_f32 v[196:197], v[196:197], v[226:227]
    v_pk_add_f32 v[198:199], v[198:199], v[226:227]
    v_pk_add_f32 v[200:201], v[200:201], v[226:227]
    v_pk_add_f32 v[202:203], v[202:203], v[226:227]
    v_pk_add_f32 v[204:205], v[204:205], v[226:227]
    v_pk_add_f32 v[206:207], v[206:207], v[226:227]
    v_pk_add_f32 v[208:209], v[208:209], v[226:227]
    v_pk_add_f32 v[210:211], v[210:211], v[226:227]
    v_pk_add_f32 v[212:213], v[212:213], v[226:227]
    v_pk_add_f32 v[214:215], v[214:215], v[226:227]
    v_pk_add_f32 v[216:217], v[216:217], v[226:227]
    v_pk_add_f32 v[218:219], v[218:219], v[226:227]
    v_pk_add_f32 v[220:221], v[220:221], v[226:227]
    v_pk_add_f32 v[222:223], v[222:223], v[226:227]
    v_pk_mul_f32 v[228:229], v[192:193], v[192:193]
    v_pk_fma_f32 v[228:229], v[194:195], v[194:195], v[228:229]
    v_pk_fma_f32 v[228:229], v[196:197], v[196:197], v[228:229]
    v_pk_fma_f32 v[228:229], v[198:199], v[198:199], v[228:229]
    v_pk_fma_f32 v[228:229], v[200:201], v[200:201], v[228:229]
    v_pk_fma_f32 v[228:229], v[202:203], v[202:203], v[228:229]
    v_pk_fma_f32 v[228:229], v[204:205], v[204:205], v[228:229]
    v_pk_fma_f32 v[228:229], v[206:207], v[206:207], v[228:229]
    v_pk_fma_f32 v[228:229], v[208:209], v[208:209], v[228:229]
    v_pk_fma_f32 v[228:229], v[210:211], v[210:211], v[228:229]
    v_pk_fma_f32 v[228:229], v[212:213], v[212:213], v[228:229]
    v_pk_fma_f32 v[228:229], v[214:215], v[214:215], v[228:229]
    v_pk_fma_f32 v[228:229], v[216:217], v[216:217], v[228:229]
    v_pk_fma_f32 v[228:229], v[218:219], v[218:219], v[228:229]
    v_pk_fma_f32 v[228:229], v[220:221], v[220:221], v[228:229]
    v_pk_fma_f32 v[228:229], v[222:223], v[222:223], v[228:229]
    v_add_f32 v228, v228, v229
    s_nop 1
    v_add_f32_dpp v228, v228, v228 row_ror:8 row_mask:0xf bank_mask:0xf
    s_nop 1
    v_add_f32_dpp v228, v228, v228 row_ror:4 row_mask:0xf bank_mask:0xf
    s_nop 1
    v_add_f32_dpp v228, v228, v228 row_ror:2 row_mask:0xf bank_mask:0xf
    s_nop 1
    v_add_f32_dpp v228, v228, v228 row_ror:1 row_mask:0xf bank_mask:0xf
    v_mul_f32 v228, 0x3b000000, v228
    v_cvt_pk_bf16_f32 v228, v228, v228
    v_lshlrev_b32 v228, 16, v228
    v_add_f32 v228, 0x3727c5ac, v228
    v_cvt_pk_bf16_f32 v228, v228, v228
    v_lshlrev_b32 v228, 16, v228
    v_sqrt_f32 v228, v228
    s_nop 0
    v_cvt_pk_bf16_f32 v228, v228, v228
    v_lshlrev_b32 v228, 16, v228
    v_rcp_f32 v228, v228
    s_nop 0
    v_mov_b32 v229, v228
    v_pk_mul_f32 v[192:193], v[192:193], v[228:229]
    v_pk_mul_f32 v[194:195], v[194:195], v[228:229]
    v_pk_mul_f32 v[196:197], v[196:197], v[228:229]
    v_pk_mul_f32 v[198:199], v[198:199], v[228:229]
    v_pk_mul_f32 v[200:201], v[200:201], v[228:229]
    v_pk_mul_f32 v[202:203], v[202:203], v[228:229]
    v_pk_mul_f32 v[204:205], v[204:205], v[228:229]
    v_pk_mul_f32 v[206:207], v[206:207], v[228:229]
    v_pk_mul_f32 v[208:209], v[208:209], v[228:229]
    v_pk_mul_f32 v[210:211], v[210:211], v[228:229]
    v_pk_mul_f32 v[212:213], v[212:213], v[228:229]
    v_pk_mul_f32 v[214:215], v[214:215], v[228:229]
    v_pk_mul_f32 v[216:217], v[216:217], v[228:229]
    v_pk_mul_f32 v[218:219], v[218:219], v[228:229]
    v_pk_mul_f32 v[220:221], v[220:221], v[228:229]
    v_pk_mul_f32 v[222:223], v[222:223], v[228:229]
    v_cvt_pk_bf16_f32 v64, v192, v193
    v_cvt_pk_bf16_f32 v65, v194, v195
    v_cvt_pk_bf16_f32 v66, v196, v197
    v_cvt_pk_bf16_f32 v67, v198, v199
    v_cvt_pk_bf16_f32 v68, v200, v201
    v_cvt_pk_bf16_f32 v69, v202, v203
    v_cvt_pk_bf16_f32 v70, v204, v205
    v_cvt_pk_bf16_f32 v71, v206, v207
    v_cvt_pk_bf16_f32 v72, v208, v209
    v_cvt_pk_bf16_f32 v73, v210, v211
    v_cvt_pk_bf16_f32 v74, v212, v213
    v_cvt_pk_bf16_f32 v75, v214, v215
    v_cvt_pk_bf16_f32 v76, v216, v217
    v_cvt_pk_bf16_f32 v77, v218, v219
    v_cvt_pk_bf16_f32 v78, v220, v221
    v_cvt_pk_bf16_f32 v79, v222, v223
    ds_write_b128 v21, v[64:67] offset:0
    ds_write_b128 v21, v[68:71] offset:8448
    ds_write_b128 v21, v[72:75] offset:16896
    ds_write_b128 v21, v[76:79] offset:25344
    s_waitcnt vmcnt(24)
    v_mov_b32 v224, 0
    v_dot2_f32_bf16 v224, v80, s25, v224
    v_dot2_f32_bf16 v224, v81, s25, v224
    v_dot2_f32_bf16 v224, v82, s25, v224
    v_dot2_f32_bf16 v224, v83, s25, v224
    v_dot2_f32_bf16 v224, v84, s25, v224
    v_dot2_f32_bf16 v224, v85, s25, v224
    v_dot2_f32_bf16 v224, v86, s25, v224
    v_dot2_f32_bf16 v224, v87, s25, v224
    v_dot2_f32_bf16 v224, v88, s25, v224
    v_dot2_f32_bf16 v224, v89, s25, v224
    v_dot2_f32_bf16 v224, v90, s25, v224
    v_dot2_f32_bf16 v224, v91, s25, v224
    v_dot2_f32_bf16 v224, v92, s25, v224
    v_dot2_f32_bf16 v224, v93, s25, v224
    v_dot2_f32_bf16 v224, v94, s25, v224
    v_dot2_f32_bf16 v224, v95, s25, v224
    s_nop 2
    s_nop 1
    v_add_f32_dpp v224, v224, v224 row_ror:8 row_mask:0xf bank_mask:0xf
    s_nop 1
    v_add_f32_dpp v224, v224, v224 row_ror:4 row_mask:0xf bank_mask:0xf
    s_nop 1
    v_add_f32_dpp v224, v224, v224 row_ror:2 row_mask:0xf bank_mask:0xf
    s_nop 1
    v_add_f32_dpp v224, v224, v224 row_ror:1 row_mask:0xf bank_mask:0xf
    v_mul_f32 v226, 0xbb000000, v224
    v_cvt_pk_bf16_f32 v226, v226, v226
    v_lshlrev_b32 v226, 16, v226
    v_mov_b32 v227, v226
    v_lshlrev_b32 v192, 16, v80
    v_and_b32 v193, 0xffff0000, v80
    v_lshlrev_b32 v194, 16, v81
    v_and_b32 v195, 0xffff0000, v81
    v_lshlrev_b32 v196, 16, v82
    v_and_b32 v197, 0xffff0000, v82
    v_lshlrev_b32 v198, 16, v83
    v_and_b32 v199, 0xffff0000, v83
    v_lshlrev_b32 v200, 16, v84
    v_and_b32 v201, 0xffff0000, v84
    v_lshlrev_b32 v202, 16, v85
    v_and_b32 v203, 0xffff0000, v85
    v_lshlrev_b32 v204, 16, v86
    v_and_b32 v205, 0xffff0000, v86
    v_lshlrev_b32 v206, 16, v87
    v_and_b32 v207, 0xffff0000, v87
    v_lshlrev_b32 v208, 16, v88
    v_and_b32 v209, 0xffff0000, v88
    v_lshlrev_b32 v210, 16, v89
    v_and_b32 v211, 0xffff0000, v89
    v_lshlrev_b32 v212, 16, v90
    v_and_b32 v213, 0xffff0000, v90
    v_lshlrev_b32 v214, 16, v91
    v_and_b32 v215, 0xffff0000, v91
    v_lshlrev_b32 v216, 16, v92
    v_and_b32 v217, 0xffff0000, v92
    v_lshlrev_b32 v218, 16, v93
    v_and_b32 v219, 0xffff0000, v93
    v_lshlrev_b32 v220, 16, v94
    v_and_b32 v221, 0xffff0000, v94
    v_lshlrev_b32 v222, 16, v95
    v_and_b32 v223, 0xffff0000, v95
    v_pk_add_f32 v[192:193], v[192:193], v[226:227]
    v_pk_add_f32 v[194:195], v[194:195], v[226:227]
    v_pk_add_f32 v[196:197], v[196:197], v[226:227]
    v_pk_add_f32 v[198:199], v[198:199], v[226:227]
    v_pk_add_f32 v[200:201], v[200:201], v[226:227]
    v_pk_add_f32 v[202:203], v[202:203], v[226:227]
    v_pk_add_f32 v[204:205], v[204:205], v[226:227]
    v_pk_add_f32 v[206:207], v[206:207], v[226:227]
    v_pk_add_f32 v[208:209], v[208:209], v[226:227]
    v_pk_add_f32 v[210:211], v[210:211], v[226:227]
    v_pk_add_f32 v[212:213], v[212:213], v[226:227]
    v_pk_add_f32 v[214:215], v[214:215], v[226:227]
    v_pk_add_f32 v[216:217], v[216:217], v[226:227]
    v_pk_add_f32 v[218:219], v[218:219], v[226:227]
    v_pk_add_f32 v[220:221], v[220:221], v[226:227]
    v_pk_add_f32 v[222:223], v[222:223], v[226:227]
    v_pk_mul_f32 v[228:229], v[192:193], v[192:193]
    v_pk_fma_f32 v[228:229], v[194:195], v[194:195], v[228:229]
    v_pk_fma_f32 v[228:229], v[196:197], v[196:197], v[228:229]
    v_pk_fma_f32 v[228:229], v[198:199], v[198:199], v[228:229]
    v_pk_fma_f32 v[228:229], v[200:201], v[200:201], v[228:229]
    v_pk_fma_f32 v[228:229], v[202:203], v[202:203], v[228:229]
    v_pk_fma_f32 v[228:229], v[204:205], v[204:205], v[228:229]
    v_pk_fma_f32 v[228:229], v[206:207], v[206:207], v[228:229]
    v_pk_fma_f32 v[228:229], v[208:209], v[208:209], v[228:229]
    v_pk_fma_f32 v[228:229], v[210:211], v[210:211], v[228:229]
    v_pk_fma_f32 v[228:229], v[212:213], v[212:213], v[228:229]
    v_pk_fma_f32 v[228:229], v[214:215], v[214:215], v[228:229]
    v_pk_fma_f32 v[228:229], v[216:217], v[216:217], v[228:229]
    v_pk_fma_f32 v[228:229], v[218:219], v[218:219], v[228:229]
    v_pk_fma_f32 v[228:229], v[220:221], v[220:221], v[228:229]
    v_pk_fma_f32 v[228:229], v[222:223], v[222:223], v[228:229]
    v_add_f32 v228, v228, v229
    s_nop 1
    v_add_f32_dpp v228, v228, v228 row_ror:8 row_mask:0xf bank_mask:0xf
    s_nop 1
    v_add_f32_dpp v228, v228, v228 row_ror:4 row_mask:0xf bank_mask:0xf
    s_nop 1
    v_add_f32_dpp v228, v228, v228 row_ror:2 row_mask:0xf bank_mask:0xf
    s_nop 1
    v_add_f32_dpp v228, v228, v228 row_ror:1 row_mask:0xf bank_mask:0xf
    v_mul_f32 v228, 0x3b000000, v228
    v_cvt_pk_bf16_f32 v228, v228, v228
    v_lshlrev_b32 v228, 16, v228
    v_add_f32 v228, 0x3727c5ac, v228
    v_cvt_pk_bf16_f32 v228, v228, v228
    v_lshlrev_b32 v228, 16, v228
    v_sqrt_f32 v228, v228
    s_nop 0
    v_cvt_pk_bf16_f32 v228, v228, v228
    v_lshlrev_b32 v228, 16, v228
    v_rcp_f32 v228, v228
    s_nop 0
    v_mov_b32 v229, v228
    v_pk_mul_f32 v[192:193], v[192:193], v[228:229]
    v_pk_mul_f32 v[194:195], v[194:195], v[228:229]
    v_pk_mul_f32 v[196:197], v[196:197], v[228:229]
    v_pk_mul_f32 v[198:199], v[198:199], v[228:229]
    v_pk_mul_f32 v[200:201], v[200:201], v[228:229]
    v_pk_mul_f32 v[202:203], v[202:203], v[228:229]
    v_pk_mul_f32 v[204:205], v[204:205], v[228:229]
    v_pk_mul_f32 v[206:207], v[206:207], v[228:229]
    v_pk_mul_f32 v[208:209], v[208:209], v[228:229]
    v_pk_mul_f32 v[210:211], v[210:211], v[228:229]
    v_pk_mul_f32 v[212:213], v[212:213], v[228:229]
    v_pk_mul_f32 v[214:215], v[214:215], v[228:229]
    v_pk_mul_f32 v[216:217], v[216:217], v[228:229]
    v_pk_mul_f32 v[218:219], v[218:219], v[228:229]
    v_pk_mul_f32 v[220:221], v[220:221], v[228:229]
    v_pk_mul_f32 v[222:223], v[222:223], v[228:229]
    v_cvt_pk_bf16_f32 v80, v192, v193
    v_cvt_pk_bf16_f32 v81, v194, v195
    v_cvt_pk_bf16_f32 v82, v196, v197
    v_cvt_pk_bf16_f32 v83, v198, v199
    v_cvt_pk_bf16_f32 v84, v200, v201
    v_cvt_pk_bf16_f32 v85, v202, v203
    v_cvt_pk_bf16_f32 v86, v204, v205
    v_cvt_pk_bf16_f32 v87, v206, v207
    v_cvt_pk_bf16_f32 v88, v208, v209
    v_cvt_pk_bf16_f32 v89, v210, v211
    v_cvt_pk_bf16_f32 v90, v212, v213
    v_cvt_pk_bf16_f32 v91, v214, v215
    v_cvt_pk_bf16_f32 v92, v216, v217
    v_cvt_pk_bf16_f32 v93, v218, v219
    v_cvt_pk_bf16_f32 v94, v220, v221
    v_cvt_pk_bf16_f32 v95, v222, v223
    ds_write_b128 v21, v[80:83] offset:64
    ds_write_b128 v21, v[84:87] offset:8512
    ds_write_b128 v21, v[88:91] offset:16960
    ds_write_b128 v21, v[92:95] offset:25408
    s_waitcnt vmcnt(20)
    v_mov_b32 v224, 0
    v_dot2_f32_bf16 v224, v96, s25, v224
    v_dot2_f32_bf16 v224, v97, s25, v224
    v_dot2_f32_bf16 v224, v98, s25, v224
    v_dot2_f32_bf16 v224, v99, s25, v224
    v_dot2_f32_bf16 v224, v100, s25, v224
    v_dot2_f32_bf16 v224, v101, s25, v224
    v_dot2_f32_bf16 v224, v102, s25, v224
    v_dot2_f32_bf16 v224, v103, s25, v224
    v_dot2_f32_bf16 v224, v104, s25, v224
    v_dot2_f32_bf16 v224, v105, s25, v224
    v_dot2_f32_bf16 v224, v106, s25, v224
    v_dot2_f32_bf16 v224, v107, s25, v224
    v_dot2_f32_bf16 v224, v108, s25, v224
    v_dot2_f32_bf16 v224, v109, s25, v224
    v_dot2_f32_bf16 v224, v110, s25, v224
    v_dot2_f32_bf16 v224, v111, s25, v224
    s_nop 2
    s_nop 1
    v_add_f32_dpp v224, v224, v224 row_ror:8 row_mask:0xf bank_mask:0xf
    s_nop 1
    v_add_f32_dpp v224, v224, v224 row_ror:4 row_mask:0xf bank_mask:0xf
    s_nop 1
    v_add_f32_dpp v224, v224, v224 row_ror:2 row_mask:0xf bank_mask:0xf
    s_nop 1
    v_add_f32_dpp v224, v224, v224 row_ror:1 row_mask:0xf bank_mask:0xf
    v_mul_f32 v226, 0xbb000000, v224
    v_cvt_pk_bf16_f32 v226, v226, v226
    v_lshlrev_b32 v226, 16, v226
    v_mov_b32 v227, v226
    v_lshlrev_b32 v192, 16, v96
    v_and_b32 v193, 0xffff0000, v96
    v_lshlrev_b32 v194, 16, v97
    v_and_b32 v195, 0xffff0000, v97
    v_lshlrev_b32 v196, 16, v98
    v_and_b32 v197, 0xffff0000, v98
    v_lshlrev_b32 v198, 16, v99
    v_and_b32 v199, 0xffff0000, v99
    v_lshlrev_b32 v200, 16, v100
    v_and_b32 v201, 0xffff0000, v100
    v_lshlrev_b32 v202, 16, v101
    v_and_b32 v203, 0xffff0000, v101
    v_lshlrev_b32 v204, 16, v102
    v_and_b32 v205, 0xffff0000, v102
    v_lshlrev_b32 v206, 16, v103
    v_and_b32 v207, 0xffff0000, v103
    v_lshlrev_b32 v208, 16, v104
    v_and_b32 v209, 0xffff0000, v104
    v_lshlrev_b32 v210, 16, v105
    v_and_b32 v211, 0xffff0000, v105
    v_lshlrev_b32 v212, 16, v106
    v_and_b32 v213, 0xffff0000, v106
    v_lshlrev_b32 v214, 16, v107
    v_and_b32 v215, 0xffff0000, v107
    v_lshlrev_b32 v216, 16, v108
    v_and_b32 v217, 0xffff0000, v108
    v_lshlrev_b32 v218, 16, v109
    v_and_b32 v219, 0xffff0000, v109
    v_lshlrev_b32 v220, 16, v110
    v_and_b32 v221, 0xffff0000, v110
    v_lshlrev_b32 v222, 16, v111
    v_and_b32 v223, 0xffff0000, v111
    v_pk_add_f32 v[192:193], v[192:193], v[226:227]
    v_pk_add_f32 v[194:195], v[194:195], v[226:227]
    v_pk_add_f32 v[196:197], v[196:197], v[226:227]
    v_pk_add_f32 v[198:199], v[198:199], v[226:227]
    v_pk_add_f32 v[200:201], v[200:201], v[226:227]
    v_pk_add_f32 v[202:203], v[202:203], v[226:227]
    v_pk_add_f32 v[204:205], v[204:205], v[226:227]
    v_pk_add_f32 v[206:207], v[206:207], v[226:227]
    v_pk_add_f32 v[208:209], v[208:209], v[226:227]
    v_pk_add_f32 v[210:211], v[210:211], v[226:227]
    v_pk_add_f32 v[212:213], v[212:213], v[226:227]
    v_pk_add_f32 v[214:215], v[214:215], v[226:227]
    v_pk_add_f32 v[216:217], v[216:217], v[226:227]
    v_pk_add_f32 v[218:219], v[218:219], v[226:227]
    v_pk_add_f32 v[220:221], v[220:221], v[226:227]
    v_pk_add_f32 v[222:223], v[222:223], v[226:227]
    v_pk_mul_f32 v[228:229], v[192:193], v[192:193]
    v_pk_fma_f32 v[228:229], v[194:195], v[194:195], v[228:229]
    v_pk_fma_f32 v[228:229], v[196:197], v[196:197], v[228:229]
    v_pk_fma_f32 v[228:229], v[198:199], v[198:199], v[228:229]
    v_pk_fma_f32 v[228:229], v[200:201], v[200:201], v[228:229]
    v_pk_fma_f32 v[228:229], v[202:203], v[202:203], v[228:229]
    v_pk_fma_f32 v[228:229], v[204:205], v[204:205], v[228:229]
    v_pk_fma_f32 v[228:229], v[206:207], v[206:207], v[228:229]
    v_pk_fma_f32 v[228:229], v[208:209], v[208:209], v[228:229]
    v_pk_fma_f32 v[228:229], v[210:211], v[210:211], v[228:229]
    v_pk_fma_f32 v[228:229], v[212:213], v[212:213], v[228:229]
    v_pk_fma_f32 v[228:229], v[214:215], v[214:215], v[228:229]
    v_pk_fma_f32 v[228:229], v[216:217], v[216:217], v[228:229]
    v_pk_fma_f32 v[228:229], v[218:219], v[218:219], v[228:229]
    v_pk_fma_f32 v[228:229], v[220:221], v[220:221], v[228:229]
    v_pk_fma_f32 v[228:229], v[222:223], v[222:223], v[228:229]
    v_add_f32 v228, v228, v229
    s_nop 1
    v_add_f32_dpp v228, v228, v228 row_ror:8 row_mask:0xf bank_mask:0xf
    s_nop 1
    v_add_f32_dpp v228, v228, v228 row_ror:4 row_mask:0xf bank_mask:0xf
    s_nop 1
    v_add_f32_dpp v228, v228, v228 row_ror:2 row_mask:0xf bank_mask:0xf
    s_nop 1
    v_add_f32_dpp v228, v228, v228 row_ror:1 row_mask:0xf bank_mask:0xf
    v_mul_f32 v228, 0x3b000000, v228
    v_cvt_pk_bf16_f32 v228, v228, v228
    v_lshlrev_b32 v228, 16, v228
    v_add_f32 v228, 0x3727c5ac, v228
    v_cvt_pk_bf16_f32 v228, v228, v228
    v_lshlrev_b32 v228, 16, v228
    v_sqrt_f32 v228, v228
    s_nop 0
    v_cvt_pk_bf16_f32 v228, v228, v228
    v_lshlrev_b32 v228, 16, v228
    v_rcp_f32 v228, v228
    s_nop 0
    v_mov_b32 v229, v228
    v_pk_mul_f32 v[192:193], v[192:193], v[228:229]
    v_pk_mul_f32 v[194:195], v[194:195], v[228:229]
    v_pk_mul_f32 v[196:197], v[196:197], v[228:229]
    v_pk_mul_f32 v[198:199], v[198:199], v[228:229]
    v_pk_mul_f32 v[200:201], v[200:201], v[228:229]
    v_pk_mul_f32 v[202:203], v[202:203], v[228:229]
    v_pk_mul_f32 v[204:205], v[204:205], v[228:229]
    v_pk_mul_f32 v[206:207], v[206:207], v[228:229]
    v_pk_mul_f32 v[208:209], v[208:209], v[228:229]
    v_pk_mul_f32 v[210:211], v[210:211], v[228:229]
    v_pk_mul_f32 v[212:213], v[212:213], v[228:229]
    v_pk_mul_f32 v[214:215], v[214:215], v[228:229]
    v_pk_mul_f32 v[216:217], v[216:217], v[228:229]
    v_pk_mul_f32 v[218:219], v[218:219], v[228:229]
    v_pk_mul_f32 v[220:221], v[220:221], v[228:229]
    v_pk_mul_f32 v[222:223], v[222:223], v[228:229]
    v_cvt_pk_bf16_f32 v96, v192, v193
    v_cvt_pk_bf16_f32 v97, v194, v195
    v_cvt_pk_bf16_f32 v98, v196, v197
    v_cvt_pk_bf16_f32 v99, v198, v199
    v_cvt_pk_bf16_f32 v100, v200, v201
    v_cvt_pk_bf16_f32 v101, v202, v203
    v_cvt_pk_bf16_f32 v102, v204, v205
    v_cvt_pk_bf16_f32 v103, v206, v207
    v_cvt_pk_bf16_f32 v104, v208, v209
    v_cvt_pk_bf16_f32 v105, v210, v211
    v_cvt_pk_bf16_f32 v106, v212, v213
    v_cvt_pk_bf16_f32 v107, v214, v215
    v_cvt_pk_bf16_f32 v108, v216, v217
    v_cvt_pk_bf16_f32 v109, v218, v219
    v_cvt_pk_bf16_f32 v110, v220, v221
    v_cvt_pk_bf16_f32 v111, v222, v223
    ds_write_b128 v21, v[96:99] offset:128
    ds_write_b128 v21, v[100:103] offset:8576
    ds_write_b128 v21, v[104:107] offset:17024
    ds_write_b128 v21, v[108:111] offset:25472
    s_waitcnt vmcnt(16)
    v_mov_b32 v224, 0
    v_dot2_f32_bf16 v224, v112, s25, v224
    v_dot2_f32_bf16 v224, v113, s25, v224
    v_dot2_f32_bf16 v224, v114, s25, v224
    v_dot2_f32_bf16 v224, v115, s25, v224
    v_dot2_f32_bf16 v224, v116, s25, v224
    v_dot2_f32_bf16 v224, v117, s25, v224
    v_dot2_f32_bf16 v224, v118, s25, v224
    v_dot2_f32_bf16 v224, v119, s25, v224
    v_dot2_f32_bf16 v224, v120, s25, v224
    v_dot2_f32_bf16 v224, v121, s25, v224
    v_dot2_f32_bf16 v224, v122, s25, v224
    v_dot2_f32_bf16 v224, v123, s25, v224
    v_dot2_f32_bf16 v224, v124, s25, v224
    v_dot2_f32_bf16 v224, v125, s25, v224
    v_dot2_f32_bf16 v224, v126, s25, v224
    v_dot2_f32_bf16 v224, v127, s25, v224
    s_nop 2
    s_nop 1
    v_add_f32_dpp v224, v224, v224 row_ror:8 row_mask:0xf bank_mask:0xf
    s_nop 1
    v_add_f32_dpp v224, v224, v224 row_ror:4 row_mask:0xf bank_mask:0xf
    s_nop 1
    v_add_f32_dpp v224, v224, v224 row_ror:2 row_mask:0xf bank_mask:0xf
    s_nop 1
    v_add_f32_dpp v224, v224, v224 row_ror:1 row_mask:0xf bank_mask:0xf
    v_mul_f32 v226, 0xbb000000, v224
    v_cvt_pk_bf16_f32 v226, v226, v226
    v_lshlrev_b32 v226, 16, v226
    v_mov_b32 v227, v226
    v_lshlrev_b32 v192, 16, v112
    v_and_b32 v193, 0xffff0000, v112
    v_lshlrev_b32 v194, 16, v113
    v_and_b32 v195, 0xffff0000, v113
    v_lshlrev_b32 v196, 16, v114
    v_and_b32 v197, 0xffff0000, v114
    v_lshlrev_b32 v198, 16, v115
    v_and_b32 v199, 0xffff0000, v115
    v_lshlrev_b32 v200, 16, v116
    v_and_b32 v201, 0xffff0000, v116
    v_lshlrev_b32 v202, 16, v117
    v_and_b32 v203, 0xffff0000, v117
    v_lshlrev_b32 v204, 16, v118
    v_and_b32 v205, 0xffff0000, v118
    v_lshlrev_b32 v206, 16, v119
    v_and_b32 v207, 0xffff0000, v119
    v_lshlrev_b32 v208, 16, v120
    v_and_b32 v209, 0xffff0000, v120
    v_lshlrev_b32 v210, 16, v121
    v_and_b32 v211, 0xffff0000, v121
    v_lshlrev_b32 v212, 16, v122
    v_and_b32 v213, 0xffff0000, v122
    v_lshlrev_b32 v214, 16, v123
    v_and_b32 v215, 0xffff0000, v123
    v_lshlrev_b32 v216, 16, v124
    v_and_b32 v217, 0xffff0000, v124
    v_lshlrev_b32 v218, 16, v125
    v_and_b32 v219, 0xffff0000, v125
    v_lshlrev_b32 v220, 16, v126
    v_and_b32 v221, 0xffff0000, v126
    v_lshlrev_b32 v222, 16, v127
    v_and_b32 v223, 0xffff0000, v127
    v_pk_add_f32 v[192:193], v[192:193], v[226:227]
    v_pk_add_f32 v[194:195], v[194:195], v[226:227]
    v_pk_add_f32 v[196:197], v[196:197], v[226:227]
    v_pk_add_f32 v[198:199], v[198:199], v[226:227]
    v_pk_add_f32 v[200:201], v[200:201], v[226:227]
    v_pk_add_f32 v[202:203], v[202:203], v[226:227]
    v_pk_add_f32 v[204:205], v[204:205], v[226:227]
    v_pk_add_f32 v[206:207], v[206:207], v[226:227]
    v_pk_add_f32 v[208:209], v[208:209], v[226:227]
    v_pk_add_f32 v[210:211], v[210:211], v[226:227]
    v_pk_add_f32 v[212:213], v[212:213], v[226:227]
    v_pk_add_f32 v[214:215], v[214:215], v[226:227]
    v_pk_add_f32 v[216:217], v[216:217], v[226:227]
    v_pk_add_f32 v[218:219], v[218:219], v[226:227]
    v_pk_add_f32 v[220:221], v[220:221], v[226:227]
    v_pk_add_f32 v[222:223], v[222:223], v[226:227]
    v_pk_mul_f32 v[228:229], v[192:193], v[192:193]
    v_pk_fma_f32 v[228:229], v[194:195], v[194:195], v[228:229]
    v_pk_fma_f32 v[228:229], v[196:197], v[196:197], v[228:229]
    v_pk_fma_f32 v[228:229], v[198:199], v[198:199], v[228:229]
    v_pk_fma_f32 v[228:229], v[200:201], v[200:201], v[228:229]
    v_pk_fma_f32 v[228:229], v[202:203], v[202:203], v[228:229]
    v_pk_fma_f32 v[228:229], v[204:205], v[204:205], v[228:229]
    v_pk_fma_f32 v[228:229], v[206:207], v[206:207], v[228:229]
    v_pk_fma_f32 v[228:229], v[208:209], v[208:209], v[228:229]
    v_pk_fma_f32 v[228:229], v[210:211], v[210:211], v[228:229]
    v_pk_fma_f32 v[228:229], v[212:213], v[212:213], v[228:229]
    v_pk_fma_f32 v[228:229], v[214:215], v[214:215], v[228:229]
    v_pk_fma_f32 v[228:229], v[216:217], v[216:217], v[228:229]
    v_pk_fma_f32 v[228:229], v[218:219], v[218:219], v[228:229]
    v_pk_fma_f32 v[228:229], v[220:221], v[220:221], v[228:229]
    v_pk_fma_f32 v[228:229], v[222:223], v[222:223], v[228:229]
    v_add_f32 v228, v228, v229
    s_nop 1
    v_add_f32_dpp v228, v228, v228 row_ror:8 row_mask:0xf bank_mask:0xf
    s_nop 1
    v_add_f32_dpp v228, v228, v228 row_ror:4 row_mask:0xf bank_mask:0xf
    s_nop 1
    v_add_f32_dpp v228, v228, v228 row_ror:2 row_mask:0xf bank_mask:0xf
    s_nop 1
    v_add_f32_dpp v228, v228, v228 row_ror:1 row_mask:0xf bank_mask:0xf
    v_mul_f32 v228, 0x3b000000, v228
    v_cvt_pk_bf16_f32 v228, v228, v228
    v_lshlrev_b32 v228, 16, v228
    v_add_f32 v228, 0x3727c5ac, v228
    v_cvt_pk_bf16_f32 v228, v228, v228
    v_lshlrev_b32 v228, 16, v228
    v_sqrt_f32 v228, v228
    s_nop 0
    v_cvt_pk_bf16_f32 v228, v228, v228
    v_lshlrev_b32 v228, 16, v228
    v_rcp_f32 v228, v228
    s_nop 0
    v_mov_b32 v229, v228
    v_pk_mul_f32 v[192:193], v[192:193], v[228:229]
    v_pk_mul_f32 v[194:195], v[194:195], v[228:229]
    v_pk_mul_f32 v[196:197], v[196:197], v[228:229]
    v_pk_mul_f32 v[198:199], v[198:199], v[228:229]
    v_pk_mul_f32 v[200:201], v[200:201], v[228:229]
    v_pk_mul_f32 v[202:203], v[202:203], v[228:229]
    v_pk_mul_f32 v[204:205], v[204:205], v[228:229]
    v_pk_mul_f32 v[206:207], v[206:207], v[228:229]
    v_pk_mul_f32 v[208:209], v[208:209], v[228:229]
    v_pk_mul_f32 v[210:211], v[210:211], v[228:229]
    v_pk_mul_f32 v[212:213], v[212:213], v[228:229]
    v_pk_mul_f32 v[214:215], v[214:215], v[228:229]
    v_pk_mul_f32 v[216:217], v[216:217], v[228:229]
    v_pk_mul_f32 v[218:219], v[218:219], v[228:229]
    v_pk_mul_f32 v[220:221], v[220:221], v[228:229]
    v_pk_mul_f32 v[222:223], v[222:223], v[228:229]
    v_cvt_pk_bf16_f32 v112, v192, v193
    v_cvt_pk_bf16_f32 v113, v194, v195
    v_cvt_pk_bf16_f32 v114, v196, v197
    v_cvt_pk_bf16_f32 v115, v198, v199
    v_cvt_pk_bf16_f32 v116, v200, v201
    v_cvt_pk_bf16_f32 v117, v202, v203
    v_cvt_pk_bf16_f32 v118, v204, v205
    v_cvt_pk_bf16_f32 v119, v206, v207
    v_cvt_pk_bf16_f32 v120, v208, v209
    v_cvt_pk_bf16_f32 v121, v210, v211
    v_cvt_pk_bf16_f32 v122, v212, v213
    v_cvt_pk_bf16_f32 v123, v214, v215
    v_cvt_pk_bf16_f32 v124, v216, v217
    v_cvt_pk_bf16_f32 v125, v218, v219
    v_cvt_pk_bf16_f32 v126, v220, v221
    v_cvt_pk_bf16_f32 v127, v222, v223
    ds_write_b128 v21, v[112:115] offset:192
    ds_write_b128 v21, v[116:119] offset:8640
    ds_write_b128 v21, v[120:123] offset:17088
    ds_write_b128 v21, v[124:127] offset:25536
L_w_st4:
    s_waitcnt vmcnt(12)
    v_mov_b32 v224, 0
    v_dot2_f32_bf16 v224, v128, s25, v224
    v_dot2_f32_bf16 v224, v129, s25, v224
    v_dot2_f32_bf16 v224, v130, s25, v224
    v_dot2_f32_bf16 v224, v131, s25, v224
    v_dot2_f32_bf16 v224, v132, s25, v224
    v_dot2_f32_bf16 v224, v133, s25, v224
    v_dot2_f32_bf16 v224, v134, s25, v224
    v_dot2_f32_bf16 v224, v135, s25, v224
    v_dot2_f32_bf16 v224, v136, s25, v224
    v_dot2_f32_bf16 v224, v137, s25, v224
    v_dot2_f32_bf16 v224, v138, s25, v224
    v_dot2_f32_bf16 v224, v139, s25, v224
    v_dot2_f32_bf16 v224, v140, s25, v224
    v_dot2_f32_bf16 v224, v141, s25, v224
    v_dot2_f32_bf16 v224, v142, s25, v224
    v_dot2_f32_bf16 v224, v143, s25, v224
    s_nop 2
    s_nop 1
    v_add_f32_dpp v224, v224, v224 row_ror:8 row_mask:0xf bank_mask:0xf
    s_nop 1
    v_add_f32_dpp v224, v224, v224 row_ror:4 row_mask:0xf bank_mask:0xf
    s_nop 1
    v_add_f32_dpp v224, v224, v224 row_ror:2 row_mask:0xf bank_mask:0xf
    s_nop 1
    v_add_f32_dpp v224, v224, v224 row_ror:1 row_mask:0xf bank_mask:0xf
    v_mul_f32 v226, 0xbb000000, v224
    v_cvt_pk_bf16_f32 v226, v226, v226
    v_lshlrev_b32 v226, 16, v226
    v_mov_b32 v227, v226
    v_lshlrev_b32 v192, 16, v128
    v_and_b32 v193, 0xffff0000, v128
    v_lshlrev_b32 v194, 16, v129
    v_and_b32 v195, 0xffff0000, v129
    v_lshlrev_b32 v196, 16, v130
    v_and_b32 v197, 0xffff0000, v130
    v_lshlrev_b32 v198, 16, v131
    v_and_b32 v199, 0xffff0000, v131
    v_lshlrev_b32 v200, 16, v132
    v_and_b32 v201, 0xffff0000, v132
    v_lshlrev_b32 v202, 16, v133
    v_and_b32 v203, 0xffff0000, v133
    v_lshlrev_b32 v204, 16, v134
    v_and_b32 v205, 0xffff0000, v134
    v_lshlrev_b32 v206, 16, v135
    v_and_b32 v207, 0xffff0000, v135
    v_lshlrev_b32 v208, 16, v136
    v_and_b32 v209, 0xffff0000, v136
    v_lshlrev_b32 v210, 16, v137
    v_and_b32 v211, 0xffff0000, v137
    v_lshlrev_b32 v212, 16, v138
    v_and_b32 v213, 0xffff0000, v138
    v_lshlrev_b32 v214, 16, v139
    v_and_b32 v215, 0xffff0000, v139
    v_lshlrev_b32 v216, 16, v140
    v_and_b32 v217, 0xffff0000, v140
    v_lshlrev_b32 v218, 16, v141
    v_and_b32 v219, 0xffff0000, v141
    v_lshlrev_b32 v220, 16, v142
    v_and_b32 v221, 0xffff0000, v142
    v_lshlrev_b32 v222, 16, v143
    v_and_b32 v223, 0xffff0000, v143
    v_pk_add_f32 v[192:193], v[192:193], v[226:227]
    v_pk_add_f32 v[194:195], v[194:195], v[226:227]
    v_pk_add_f32 v[196:197], v[196:197], v[226:227]
    v_pk_add_f32 v[198:199], v[198:199], v[226:227]
    v_pk_add_f32 v[200:201], v[200:201], v[226:227]
    v_pk_add_f32 v[202:203], v[202:203], v[226:227]
    v_pk_add_f32 v[204:205], v[204:205], v[226:227]
    v_pk_add_f32 v[206:207], v[206:207], v[226:227]
    v_pk_add_f32 v[208:209], v[208:209], v[226:227]
    v_pk_add_f32 v[210:211], v[210:211], v[226:227]
    v_pk_add_f32 v[212:213], v[212:213], v[226:227]
    v_pk_add_f32 v[214:215], v[214:215], v[226:227]
    v_pk_add_f32 v[216:217], v[216:217], v[226:227]
    v_pk_add_f32 v[218:219], v[218:219], v[226:227]
    v_pk_add_f32 v[220:221], v[220:221], v[226:227]
    v_pk_add_f32 v[222:223], v[222:223], v[226:227]
    v_pk_mul_f32 v[228:229], v[192:193], v[192:193]
    v_pk_fma_f32 v[228:229], v[194:195], v[194:195], v[228:229]
    v_pk_fma_f32 v[228:229], v[196:197], v[196:197], v[228:229]
    v_pk_fma_f32 v[228:229], v[198:199], v[198:199], v[228:229]
    v_pk_fma_f32 v[228:229], v[200:201], v[200:201], v[228:229]
    v_pk_fma_f32 v[228:229], v[202:203], v[202:203], v[228:229]
    v_pk_fma_f32 v[228:229], v[204:205], v[204:205], v[228:229]
    v_pk_fma_f32 v[228:229], v[206:207], v[206:207], v[228:229]
    v_pk_fma_f32 v[228:229], v[208:209], v[208:209], v[228:229]
    v_pk_fma_f32 v[228:229], v[210:211], v[210:211], v[228:229]
    v_pk_fma_f32 v[228:229], v[212:213], v[212:213], v[228:229]
    v_pk_fma_f32 v[228:229], v[214:215], v[214:215], v[228:229]
    v_pk_fma_f32 v[228:229], v[216:217], v[216:217], v[228:229]
    v_pk_fma_f32 v[228:229], v[218:219], v[218:219], v[228:229]
    v_pk_fma_f32 v[228:229], v[220:221], v[220:221], v[228:229]
    v_pk_fma_f32 v[228:229], v[222:223], v[222:223], v[228:229]
    v_add_f32 v228, v228, v229
    s_nop 1
    v_add_f32_dpp v228, v228, v228 row_ror:8 row_mask:0xf bank_mask:0xf
    s_nop 1
    v_add_f32_dpp v228, v228, v228 row_ror:4 row_mask:0xf bank_mask:0xf
    s_nop 1
    v_add_f32_dpp v228, v228, v228 row_ror:2 row_mask:0xf bank_mask:0xf
    s_nop 1
    v_add_f32_dpp v228, v228, v228 row_ror:1 row_mask:0xf bank_mask:0xf
    v_mul_f32 v228, 0x3b000000, v228
    v_cvt_pk_bf16_f32 v228, v228, v228
    v_lshlrev_b32 v228, 16, v228
    v_add_f32 v228, 0x3727c5ac, v228
    v_cvt_pk_bf16_f32 v228, v228, v228
    v_lshlrev_b32 v228, 16, v228
    v_sqrt_f32 v228, v228
    s_nop 0
    v_cvt_pk_bf16_f32 v228, v228, v228
    v_lshlrev_b32 v228, 16, v228
    v_rcp_f32 v228, v228
    s_nop 0
    v_mov_b32 v229, v228
    v_pk_mul_f32 v[192:193], v[192:193], v[228:229]
    v_pk_mul_f32 v[194:195], v[194:195], v[228:229]
    v_pk_mul_f32 v[196:197], v[196:197], v[228:229]
    v_pk_mul_f32 v[198:199], v[198:199], v[228:229]
    v_pk_mul_f32 v[200:201], v[200:201], v[228:229]
    v_pk_mul_f32 v[202:203], v[202:203], v[228:229]
    v_pk_mul_f32 v[204:205], v[204:205], v[228:229]
    v_pk_mul_f32 v[206:207], v[206:207], v[228:229]
    v_pk_mul_f32 v[208:209], v[208:209], v[228:229]
    v_pk_mul_f32 v[210:211], v[210:211], v[228:229]
    v_pk_mul_f32 v[212:213], v[212:213], v[228:229]
    v_pk_mul_f32 v[214:215], v[214:215], v[228:229]
    v_pk_mul_f32 v[216:217], v[216:217], v[228:229]
    v_pk_mul_f32 v[218:219], v[218:219], v[228:229]
    v_pk_mul_f32 v[220:221], v[220:221], v[228:229]
    v_pk_mul_f32 v[222:223], v[222:223], v[228:229]
    v_cvt_pk_bf16_f32 v128, v192, v193
    v_cvt_pk_bf16_f32 v129, v194, v195
    v_cvt_pk_bf16_f32 v130, v196, v197
    v_cvt_pk_bf16_f32 v131, v198, v199
    v_cvt_pk_bf16_f32 v132, v200, v201
    v_cvt_pk_bf16_f32 v133, v202, v203
    v_cvt_pk_bf16_f32 v134, v204, v205
    v_cvt_pk_bf16_f32 v135, v206, v207
    v_cvt_pk_bf16_f32 v136, v208, v209
    v_cvt_pk_bf16_f32 v137, v210, v211
    v_cvt_pk_bf16_f32 v138, v212, v213
    v_cvt_pk_bf16_f32 v139, v214, v215
    v_cvt_pk_bf16_f32 v140, v216, v217
    v_cvt_pk_bf16_f32 v141, v218, v219
    v_cvt_pk_bf16_f32 v142, v220, v221
    v_cvt_pk_bf16_f32 v143, v222, v223
    ds_write_b128 v21, v[128:131] offset:256
    ds_write_b128 v21, v[132:135] offset:8704
    ds_write_b128 v21, v[136:139] offset:17152
    ds_write_b128 v21, v[140:143] offset:25600
    s_waitcnt vmcnt(8)
    v_mov_b32 v224, 0
    v_dot2_f32_bf16 v224, v144, s25, v224
    v_dot2_f32_bf16 v224, v145, s25, v224
    v_dot2_f32_bf16 v224, v146, s25, v224
    v_dot2_f32_bf16 v224, v147, s25, v224
    v_dot2_f32_bf16 v224, v148, s25, v224
    v_dot2_f32_bf16 v224, v149, s25, v224
    v_dot2_f32_bf16 v224, v150, s25, v224
    v_dot2_f32_bf16 v224, v151, s25, v224
    v_dot2_f32_bf16 v224, v152, s25, v224
    v_dot2_f32_bf16 v224, v153, s25, v224
    v_dot2_f32_bf16 v224, v154, s25, v224
    v_dot2_f32_bf16 v224, v155, s25, v224
    v_dot2_f32_bf16 v224, v156, s25, v224
    v_dot2_f32_bf16 v224, v157, s25, v224
    v_dot2_f32_bf16 v224, v158, s25, v224
    v_dot2_f32_bf16 v224, v159, s25, v224
    s_nop 2
    s_nop 1
    v_add_f32_dpp v224, v224, v224 row_ror:8 row_mask:0xf bank_mask:0xf
    s_nop 1
    v_add_f32_dpp v224, v224, v224 row_ror:4 row_mask:0xf bank_mask:0xf
    s_nop 1
    v_add_f32_dpp v224, v224, v224 row_ror:2 row_mask:0xf bank_mask:0xf
    s_nop 1
    v_add_f32_dpp v224, v224, v224 row_ror:1 row_mask:0xf bank_mask:0xf
    v_mul_f32 v226, 0xbb000000, v224
    v_cvt_pk_bf16_f32 v226, v226, v226
    v_lshlrev_b32 v226, 16, v226
    v_mov_b32 v227, v226
    v_lshlrev_b32 v192, 16, v144
    v_and_b32 v193, 0xffff0000, v144
    v_lshlrev_b32 v194, 16, v145
    v_and_b32 v195, 0xffff0000, v145
    v_lshlrev_b32 v196, 16, v146
    v_and_b32 v197, 0xffff0000, v146
    v_lshlrev_b32 v198, 16, v147
    v_and_b32 v199, 0xffff0000, v147
    v_lshlrev_b32 v200, 16, v148
    v_and_b32 v201, 0xffff0000, v148
    v_lshlrev_b32 v202, 16, v149
    v_and_b32 v203, 0xffff0000, v149
    v_lshlrev_b32 v204, 16, v150
    v_and_b32 v205, 0xffff0000, v150
    v_lshlrev_b32 v206, 16, v151
    v_and_b32 v207, 0xffff0000, v151
    v_lshlrev_b32 v208, 16, v152
    v_and_b32 v209, 0xffff0000, v152
    v_lshlrev_b32 v210, 16, v153
    v_and_b32 v211, 0xffff0000, v153
    v_lshlrev_b32 v212, 16, v154
    v_and_b32 v213, 0xffff0000, v154
    v_lshlrev_b32 v214, 16, v155
    v_and_b32 v215, 0xffff0000, v155
    v_lshlrev_b32 v216, 16, v156
    v_and_b32 v217, 0xffff0000, v156
    v_lshlrev_b32 v218, 16, v157
    v_and_b32 v219, 0xffff0000, v157
    v_lshlrev_b32 v220, 16, v158
    v_and_b32 v221, 0xffff0000, v158
    v_lshlrev_b32 v222, 16, v159
    v_and_b32 v223, 0xffff0000, v159
    v_pk_add_f32 v[192:193], v[192:193], v[226:227]
    v_pk_add_f32 v[194:195], v[194:195], v[226:227]
    v_pk_add_f32 v[196:197], v[196:197], v[226:227]
    v_pk_add_f32 v[198:199], v[198:199], v[226:227]
    v_pk_add_f32 v[200:201], v[200:201], v[226:227]
    v_pk_add_f32 v[202:203], v[202:203], v[226:227]
    v_pk_add_f32 v[204:205], v[204:205], v[226:227]
    v_pk_add_f32 v[206:207], v[206:207], v[226:227]
    v_pk_add_f32 v[208:209], v[208:209], v[226:227]
    v_pk_add_f32 v[210:211], v[210:211], v[226:227]
    v_pk_add_f32 v[212:213], v[212:213], v[226:227]
    v_pk_add_f32 v[214:215], v[214:215], v[226:227]
    v_pk_add_f32 v[216:217], v[216:217], v[226:227]
    v_pk_add_f32 v[218:219], v[218:219], v[226:227]
    v_pk_add_f32 v[220:221], v[220:221], v[226:227]
    v_pk_add_f32 v[222:223], v[222:223], v[226:227]
    v_pk_mul_f32 v[228:229], v[192:193], v[192:193]
    v_pk_fma_f32 v[228:229], v[194:195], v[194:195], v[228:229]
    v_pk_fma_f32 v[228:229], v[196:197], v[196:197], v[228:229]
    v_pk_fma_f32 v[228:229], v[198:199], v[198:199], v[228:229]
    v_pk_fma_f32 v[228:229], v[200:201], v[200:201], v[228:229]
    v_pk_fma_f32 v[228:229], v[202:203], v[202:203], v[228:229]
    v_pk_fma_f32 v[228:229], v[204:205], v[204:205], v[228:229]
    v_pk_fma_f32 v[228:229], v[206:207], v[206:207], v[228:229]
    v_pk_fma_f32 v[228:229], v[208:209], v[208:209], v[228:229]
    v_pk_fma_f32 v[228:229], v[210:211], v[210:211], v[228:229]
    v_pk_fma_f32 v[228:229], v[212:213], v[212:213], v[228:229]
    v_pk_fma_f32 v[228:229], v[214:215], v[214:215], v[228:229]
    v_pk_fma_f32 v[228:229], v[216:217], v[216:217], v[228:229]
    v_pk_fma_f32 v[228:229], v[218:219], v[218:219], v[228:229]
    v_pk_fma_f32 v[228:229], v[220:221], v[220:221], v[228:229]
    v_pk_fma_f32 v[228:229], v[222:223], v[222:223], v[228:229]
    v_add_f32 v228, v228, v229
    s_nop 1
    v_add_f32_dpp v228, v228, v228 row_ror:8 row_mask:0xf bank_mask:0xf
    s_nop 1
    v_add_f32_dpp v228, v228, v228 row_ror:4 row_mask:0xf bank_mask:0xf
    s_nop 1
    v_add_f32_dpp v228, v228, v228 row_ror:2 row_mask:0xf bank_mask:0xf
    s_nop 1
    v_add_f32_dpp v228, v228, v228 row_ror:1 row_mask:0xf bank_mask:0xf
    v_mul_f32 v228, 0x3b000000, v228
    v_cvt_pk_bf16_f32 v228, v228, v228
    v_lshlrev_b32 v228, 16, v228
    v_add_f32 v228, 0x3727c5ac, v228
    v_cvt_pk_bf16_f32 v228, v228, v228
    v_lshlrev_b32 v228, 16, v228
    v_sqrt_f32 v228, v228
    s_nop 0
    v_cvt_pk_bf16_f32 v228, v228, v228
    v_lshlrev_b32 v228, 16, v228
    v_rcp_f32 v228, v228
    s_nop 0
    v_mov_b32 v229, v228
    v_pk_mul_f32 v[192:193], v[192:193], v[228:229]
    v_pk_mul_f32 v[194:195], v[194:195], v[228:229]
    v_pk_mul_f32 v[196:197], v[196:197], v[228:229]
    v_pk_mul_f32 v[198:199], v[198:199], v[228:229]
    v_pk_mul_f32 v[200:201], v[200:201], v[228:229]
    v_pk_mul_f32 v[202:203], v[202:203], v[228:229]
    v_pk_mul_f32 v[204:205], v[204:205], v[228:229]
    v_pk_mul_f32 v[206:207], v[206:207], v[228:229]
    v_pk_mul_f32 v[208:209], v[208:209], v[228:229]
    v_pk_mul_f32 v[210:211], v[210:211], v[228:229]
    v_pk_mul_f32 v[212:213], v[212:213], v[228:229]
    v_pk_mul_f32 v[214:215], v[214:215], v[228:229]
    v_pk_mul_f32 v[216:217], v[216:217], v[228:229]
    v_pk_mul_f32 v[218:219], v[218:219], v[228:229]
    v_pk_mul_f32 v[220:221], v[220:221], v[228:229]
    v_pk_mul_f32 v[222:223], v[222:223], v[228:229]
    v_cvt_pk_bf16_f32 v144, v192, v193
    v_cvt_pk_bf16_f32 v145, v194, v195
    v_cvt_pk_bf16_f32 v146, v196, v197
    v_cvt_pk_bf16_f32 v147, v198, v199
    v_cvt_pk_bf16_f32 v148, v200, v201
    v_cvt_pk_bf16_f32 v149, v202, v203
    v_cvt_pk_bf16_f32 v150, v204, v205
    v_cvt_pk_bf16_f32 v151, v206, v207
    v_cvt_pk_bf16_f32 v152, v208, v209
    v_cvt_pk_bf16_f32 v153, v210, v211
    v_cvt_pk_bf16_f32 v154, v212, v213
    v_cvt_pk_bf16_f32 v155, v214, v215
    v_cvt_pk_bf16_f32 v156, v216, v217
    v_cvt_pk_bf16_f32 v157, v218, v219
    v_cvt_pk_bf16_f32 v158, v220, v221
    v_cvt_pk_bf16_f32 v159, v222, v223
    ds_write_b128 v21, v[144:147] offset:320
    ds_write_b128 v21, v[148:151] offset:8768
    ds_write_b128 v21, v[152:155] offset:17216
    ds_write_b128 v21, v[156:159] offset:25664
    s_waitcnt vmcnt(4)
    v_mov_b32 v224, 0
    v_dot2_f32_bf16 v224, v160, s25, v224
    v_dot2_f32_bf16 v224, v161, s25, v224
    v_dot2_f32_bf16 v224, v162, s25, v224
    v_dot2_f32_bf16 v224, v163, s25, v224
    v_dot2_f32_bf16 v224, v164, s25, v224
    v_dot2_f32_bf16 v224, v165, s25, v224
    v_dot2_f32_bf16 v224, v166, s25, v224
    v_dot2_f32_bf16 v224, v167, s25, v224
    v_dot2_f32_bf16 v224, v168, s25, v224
    v_dot2_f32_bf16 v224, v169, s25, v224
    v_dot2_f32_bf16 v224, v170, s25, v224
    v_dot2_f32_bf16 v224, v171, s25, v224
    v_dot2_f32_bf16 v224, v172, s25, v224
    v_dot2_f32_bf16 v224, v173, s25, v224
    v_dot2_f32_bf16 v224, v174, s25, v224
    v_dot2_f32_bf16 v224, v175, s25, v224
    s_nop 2
    s_nop 1
    v_add_f32_dpp v224, v224, v224 row_ror:8 row_mask:0xf bank_mask:0xf
    s_nop 1
    v_add_f32_dpp v224, v224, v224 row_ror:4 row_mask:0xf bank_mask:0xf
    s_nop 1
    v_add_f32_dpp v224, v224, v224 row_ror:2 row_mask:0xf bank_mask:0xf
    s_nop 1
    v_add_f32_dpp v224, v224, v224 row_ror:1 row_mask:0xf bank_mask:0xf
    v_mul_f32 v226, 0xbb000000, v224
    v_cvt_pk_bf16_f32 v226, v226, v226
    v_lshlrev_b32 v226, 16, v226
    v_mov_b32 v227, v226
    v_lshlrev_b32 v192, 16, v160
    v_and_b32 v193, 0xffff0000, v160
    v_lshlrev_b32 v194, 16, v161
    v_and_b32 v195, 0xffff0000, v161
    v_lshlrev_b32 v196, 16, v162
    v_and_b32 v197, 0xffff0000, v162
    v_lshlrev_b32 v198, 16, v163
    v_and_b32 v199, 0xffff0000, v163
    v_lshlrev_b32 v200, 16, v164
    v_and_b32 v201, 0xffff0000, v164
    v_lshlrev_b32 v202, 16, v165
    v_and_b32 v203, 0xffff0000, v165
    v_lshlrev_b32 v204, 16, v166
    v_and_b32 v205, 0xffff0000, v166
    v_lshlrev_b32 v206, 16, v167
    v_and_b32 v207, 0xffff0000, v167
    v_lshlrev_b32 v208, 16, v168
    v_and_b32 v209, 0xffff0000, v168
    v_lshlrev_b32 v210, 16, v169
    v_and_b32 v211, 0xffff0000, v169
    v_lshlrev_b32 v212, 16, v170
    v_and_b32 v213, 0xffff0000, v170
    v_lshlrev_b32 v214, 16, v171
    v_and_b32 v215, 0xffff0000, v171
    v_lshlrev_b32 v216, 16, v172
    v_and_b32 v217, 0xffff0000, v172
    v_lshlrev_b32 v218, 16, v173
    v_and_b32 v219, 0xffff0000, v173
    v_lshlrev_b32 v220, 16, v174
    v_and_b32 v221, 0xffff0000, v174
    v_lshlrev_b32 v222, 16, v175
    v_and_b32 v223, 0xffff0000, v175
    v_pk_add_f32 v[192:193], v[192:193], v[226:227]
    v_pk_add_f32 v[194:195], v[194:195], v[226:227]
    v_pk_add_f32 v[196:197], v[196:197], v[226:227]
    v_pk_add_f32 v[198:199], v[198:199], v[226:227]
    v_pk_add_f32 v[200:201], v[200:201], v[226:227]
    v_pk_add_f32 v[202:203], v[202:203], v[226:227]
    v_pk_add_f32 v[204:205], v[204:205], v[226:227]
    v_pk_add_f32 v[206:207], v[206:207], v[226:227]
    v_pk_add_f32 v[208:209], v[208:209], v[226:227]
    v_pk_add_f32 v[210:211], v[210:211], v[226:227]
    v_pk_add_f32 v[212:213], v[212:213], v[226:227]
    v_pk_add_f32 v[214:215], v[214:215], v[226:227]
    v_pk_add_f32 v[216:217], v[216:217], v[226:227]
    v_pk_add_f32 v[218:219], v[218:219], v[226:227]
    v_pk_add_f32 v[220:221], v[220:221], v[226:227]
    v_pk_add_f32 v[222:223], v[222:223], v[226:227]
    v_pk_mul_f32 v[228:229], v[192:193], v[192:193]
    v_pk_fma_f32 v[228:229], v[194:195], v[194:195], v[228:229]
    v_pk_fma_f32 v[228:229], v[196:197], v[196:197], v[228:229]
    v_pk_fma_f32 v[228:229], v[198:199], v[198:199], v[228:229]
    v_pk_fma_f32 v[228:229], v[200:201], v[200:201], v[228:229]
    v_pk_fma_f32 v[228:229], v[202:203], v[202:203], v[228:229]
    v_pk_fma_f32 v[228:229], v[204:205], v[204:205], v[228:229]
    v_pk_fma_f32 v[228:229], v[206:207], v[206:207], v[228:229]
    v_pk_fma_f32 v[228:229], v[208:209], v[208:209], v[228:229]
    v_pk_fma_f32 v[228:229], v[210:211], v[210:211], v[228:229]
    v_pk_fma_f32 v[228:229], v[212:213], v[212:213], v[228:229]
    v_pk_fma_f32 v[228:229], v[214:215], v[214:215], v[228:229]
    v_pk_fma_f32 v[228:229], v[216:217], v[216:217], v[228:229]
    v_pk_fma_f32 v[228:229], v[218:219], v[218:219], v[228:229]
    v_pk_fma_f32 v[228:229], v[220:221], v[220:221], v[228:229]
    v_pk_fma_f32 v[228:229], v[222:223], v[222:223], v[228:229]
    v_add_f32 v228, v228, v229
    s_nop 1
    v_add_f32_dpp v228, v228, v228 row_ror:8 row_mask:0xf bank_mask:0xf
    s_nop 1
    v_add_f32_dpp v228, v228, v228 row_ror:4 row_mask:0xf bank_mask:0xf
    s_nop 1
    v_add_f32_dpp v228, v228, v228 row_ror:2 row_mask:0xf bank_mask:0xf
    s_nop 1
    v_add_f32_dpp v228, v228, v228 row_ror:1 row_mask:0xf bank_mask:0xf
    v_mul_f32 v228, 0x3b000000, v228
    v_cvt_pk_bf16_f32 v228, v228, v228
    v_lshlrev_b32 v228, 16, v228
    v_add_f32 v228, 0x3727c5ac, v228
    v_cvt_pk_bf16_f32 v228, v228, v228
    v_lshlrev_b32 v228, 16, v228
    v_sqrt_f32 v228, v228
    s_nop 0
    v_cvt_pk_bf16_f32 v228, v228, v228
    v_lshlrev_b32 v228, 16, v228
    v_rcp_f32 v228, v228
    s_nop 0
    v_mov_b32 v229, v228
    v_pk_mul_f32 v[192:193], v[192:193], v[228:229]
    v_pk_mul_f32 v[194:195], v[194:195], v[228:229]
    v_pk_mul_f32 v[196:197], v[196:197], v[228:229]
    v_pk_mul_f32 v[198:199], v[198:199], v[228:229]
    v_pk_mul_f32 v[200:201], v[200:201], v[228:229]
    v_pk_mul_f32 v[202:203], v[202:203], v[228:229]
    v_pk_mul_f32 v[204:205], v[204:205], v[228:229]
    v_pk_mul_f32 v[206:207], v[206:207], v[228:229]
    v_pk_mul_f32 v[208:209], v[208:209], v[228:229]
    v_pk_mul_f32 v[210:211], v[210:211], v[228:229]
    v_pk_mul_f32 v[212:213], v[212:213], v[228:229]
    v_pk_mul_f32 v[214:215], v[214:215], v[228:229]
    v_pk_mul_f32 v[216:217], v[216:217], v[228:229]
    v_pk_mul_f32 v[218:219], v[218:219], v[228:229]
    v_pk_mul_f32 v[220:221], v[220:221], v[228:229]
    v_pk_mul_f32 v[222:223], v[222:223], v[228:229]
    v_cvt_pk_bf16_f32 v160, v192, v193
    v_cvt_pk_bf16_f32 v161, v194, v195
    v_cvt_pk_bf16_f32 v162, v196, v197
    v_cvt_pk_bf16_f32 v163, v198, v199
    v_cvt_pk_bf16_f32 v164, v200, v201
    v_cvt_pk_bf16_f32 v165, v202, v203
    v_cvt_pk_bf16_f32 v166, v204, v205
    v_cvt_pk_bf16_f32 v167, v206, v207
    v_cvt_pk_bf16_f32 v168, v208, v209
    v_cvt_pk_bf16_f32 v169, v210, v211
    v_cvt_pk_bf16_f32 v170, v212, v213
    v_cvt_pk_bf16_f32 v171, v214, v215
    v_cvt_pk_bf16_f32 v172, v216, v217
    v_cvt_pk_bf16_f32 v173, v218, v219
    v_cvt_pk_bf16_f32 v174, v220, v221
    v_cvt_pk_bf16_f32 v175, v222, v223
    ds_write_b128 v21, v[160:163] offset:384
    ds_write_b128 v21, v[164:167] offset:8832
    ds_write_b128 v21, v[168:171] offset:17280
    ds_write_b128 v21, v[172:175] offset:25728
    s_waitcnt vmcnt(0)
    v_mov_b32 v224, 0
    v_dot2_f32_bf16 v224, v176, s25, v224
    v_dot2_f32_bf16 v224, v177, s25, v224
    v_dot2_f32_bf16 v224, v178, s25, v224
    v_dot2_f32_bf16 v224, v179, s25, v224
    v_dot2_f32_bf16 v224, v180, s25, v224
    v_dot2_f32_bf16 v224, v181, s25, v224
    v_dot2_f32_bf16 v224, v182, s25, v224
    v_dot2_f32_bf16 v224, v183, s25, v224
    v_dot2_f32_bf16 v224, v184, s25, v224
    v_dot2_f32_bf16 v224, v185, s25, v224
    v_dot2_f32_bf16 v224, v186, s25, v224
    v_dot2_f32_bf16 v224, v187, s25, v224
    v_dot2_f32_bf16 v224, v188, s25, v224
    v_dot2_f32_bf16 v224, v189, s25, v224
    v_dot2_f32_bf16 v224, v190, s25, v224
    v_dot2_f32_bf16 v224, v191, s25, v224
    s_nop 2
    s_nop 1
    v_add_f32_dpp v224, v224, v224 row_ror:8 row_mask:0xf bank_mask:0xf
    s_nop 1
    v_add_f32_dpp v224, v224, v224 row_ror:4 row_mask:0xf bank_mask:0xf
    s_nop 1
    v_add_f32_dpp v224, v224, v224 row_ror:2 row_mask:0xf bank_mask:0xf
    s_nop 1
    v_add_f32_dpp v224, v224, v224 row_ror:1 row_mask:0xf bank_mask:0xf
    v_mul_f32 v226, 0xbb000000, v224
    v_cvt_pk_bf16_f32 v226, v226, v226
    v_lshlrev_b32 v226, 16, v226
    v_mov_b32 v227, v226
    v_lshlrev_b32 v192, 16, v176
    v_and_b32 v193, 0xffff0000, v176
    v_lshlrev_b32 v194, 16, v177
    v_and_b32 v195, 0xffff0000, v177
    v_lshlrev_b32 v196, 16, v178
    v_and_b32 v197, 0xffff0000, v178
    v_lshlrev_b32 v198, 16, v179
    v_and_b32 v199, 0xffff0000, v179
    v_lshlrev_b32 v200, 16, v180
    v_and_b32 v201, 0xffff0000, v180
    v_lshlrev_b32 v202, 16, v181
    v_and_b32 v203, 0xffff0000, v181
    v_lshlrev_b32 v204, 16, v182
    v_and_b32 v205, 0xffff0000, v182
    v_lshlrev_b32 v206, 16, v183
    v_and_b32 v207, 0xffff0000, v183
    v_lshlrev_b32 v208, 16, v184
    v_and_b32 v209, 0xffff0000, v184
    v_lshlrev_b32 v210, 16, v185
    v_and_b32 v211, 0xffff0000, v185
    v_lshlrev_b32 v212, 16, v186
    v_and_b32 v213, 0xffff0000, v186
    v_lshlrev_b32 v214, 16, v187
    v_and_b32 v215, 0xffff0000, v187
    v_lshlrev_b32 v216, 16, v188
    v_and_b32 v217, 0xffff0000, v188
    v_lshlrev_b32 v218, 16, v189
    v_and_b32 v219, 0xffff0000, v189
    v_lshlrev_b32 v220, 16, v190
    v_and_b32 v221, 0xffff0000, v190
    v_lshlrev_b32 v222, 16, v191
    v_and_b32 v223, 0xffff0000, v191
    v_pk_add_f32 v[192:193], v[192:193], v[226:227]
    v_pk_add_f32 v[194:195], v[194:195], v[226:227]
    v_pk_add_f32 v[196:197], v[196:197], v[226:227]
    v_pk_add_f32 v[198:199], v[198:199], v[226:227]
    v_pk_add_f32 v[200:201], v[200:201], v[226:227]
    v_pk_add_f32 v[202:203], v[202:203], v[226:227]
    v_pk_add_f32 v[204:205], v[204:205], v[226:227]
    v_pk_add_f32 v[206:207], v[206:207], v[226:227]
    v_pk_add_f32 v[208:209], v[208:209], v[226:227]
    v_pk_add_f32 v[210:211], v[210:211], v[226:227]
    v_pk_add_f32 v[212:213], v[212:213], v[226:227]
    v_pk_add_f32 v[214:215], v[214:215], v[226:227]
    v_pk_add_f32 v[216:217], v[216:217], v[226:227]
    v_pk_add_f32 v[218:219], v[218:219], v[226:227]
    v_pk_add_f32 v[220:221], v[220:221], v[226:227]
    v_pk_add_f32 v[222:223], v[222:223], v[226:227]
    v_pk_mul_f32 v[228:229], v[192:193], v[192:193]
    v_pk_fma_f32 v[228:229], v[194:195], v[194:195], v[228:229]
    v_pk_fma_f32 v[228:229], v[196:197], v[196:197], v[228:229]
    v_pk_fma_f32 v[228:229], v[198:199], v[198:199], v[228:229]
    v_pk_fma_f32 v[228:229], v[200:201], v[200:201], v[228:229]
    v_pk_fma_f32 v[228:229], v[202:203], v[202:203], v[228:229]
    v_pk_fma_f32 v[228:229], v[204:205], v[204:205], v[228:229]
    v_pk_fma_f32 v[228:229], v[206:207], v[206:207], v[228:229]
    v_pk_fma_f32 v[228:229], v[208:209], v[208:209], v[228:229]
    v_pk_fma_f32 v[228:229], v[210:211], v[210:211], v[228:229]
    v_pk_fma_f32 v[228:229], v[212:213], v[212:213], v[228:229]
    v_pk_fma_f32 v[228:229], v[214:215], v[214:215], v[228:229]
    v_pk_fma_f32 v[228:229], v[216:217], v[216:217], v[228:229]
    v_pk_fma_f32 v[228:229], v[218:219], v[218:219], v[228:229]
    v_pk_fma_f32 v[228:229], v[220:221], v[220:221], v[228:229]
    v_pk_fma_f32 v[228:229], v[222:223], v[222:223], v[228:229]
    v_add_f32 v228, v228, v229
    s_nop 1
    v_add_f32_dpp v228, v228, v228 row_ror:8 row_mask:0xf bank_mask:0xf
    s_nop 1
    v_add_f32_dpp v228, v228, v228 row_ror:4 row_mask:0xf bank_mask:0xf
    s_nop 1
    v_add_f32_dpp v228, v228, v228 row_ror:2 row_mask:0xf bank_mask:0xf
    s_nop 1
    v_add_f32_dpp v228, v228, v228 row_ror:1 row_mask:0xf bank_mask:0xf
    v_mul_f32 v228, 0x3b000000, v228
    v_cvt_pk_bf16_f32 v228, v228, v228
    v_lshlrev_b32 v228, 16, v228
    v_add_f32 v228, 0x3727c5ac, v228
    v_cvt_pk_bf16_f32 v228, v228, v228
    v_lshlrev_b32 v228, 16, v228
    v_sqrt_f32 v228, v228
    s_nop 0
    v_cvt_pk_bf16_f32 v228, v228, v228
    v_lshlrev_b32 v228, 16, v228
    v_rcp_f32 v228, v228
    s_nop 0
    v_mov_b32 v229, v228
    v_pk_mul_f32 v[192:193], v[192:193], v[228:229]
    v_pk_mul_f32 v[194:195], v[194:195], v[228:229]
    v_pk_mul_f32 v[196:197], v[196:197], v[228:229]
    v_pk_mul_f32 v[198:199], v[198:199], v[228:229]
    v_pk_mul_f32 v[200:201], v[200:201], v[228:229]
    v_pk_mul_f32 v[202:203], v[202:203], v[228:229]
    v_pk_mul_f32 v[204:205], v[204:205], v[228:229]
    v_pk_mul_f32 v[206:207], v[206:207], v[228:229]
    v_pk_mul_f32 v[208:209], v[208:209], v[228:229]
    v_pk_mul_f32 v[210:211], v[210:211], v[228:229]
    v_pk_mul_f32 v[212:213], v[212:213], v[228:229]
    v_pk_mul_f32 v[214:215], v[214:215], v[228:229]
    v_pk_mul_f32 v[216:217], v[216:217], v[228:229]
    v_pk_mul_f32 v[218:219], v[218:219], v[228:229]
    v_pk_mul_f32 v[220:221], v[220:221], v[228:229]
    v_pk_mul_f32 v[222:223], v[222:223], v[228:229]
    v_cvt_pk_bf16_f32 v176, v192, v193
    v_cvt_pk_bf16_f32 v177, v194, v195
    v_cvt_pk_bf16_f32 v178, v196, v197
    v_cvt_pk_bf16_f32 v179, v198, v199
    v_cvt_pk_bf16_f32 v180, v200, v201
    v_cvt_pk_bf16_f32 v181, v202, v203
    v_cvt_pk_bf16_f32 v182, v204, v205
    v_cvt_pk_bf16_f32 v183, v206, v207
    v_cvt_pk_bf16_f32 v184, v208, v209
    v_cvt_pk_bf16_f32 v185, v210, v211
    v_cvt_pk_bf16_f32 v186, v212, v213
    v_cvt_pk_bf16_f32 v187, v214, v215
    v_cvt_pk_bf16_f32 v188, v216, v217
    v_cvt_pk_bf16_f32 v189, v218, v219
    v_cvt_pk_bf16_f32 v190, v220, v221
    v_cvt_pk_bf16_f32 v191, v222, v223
    ds_write_b128 v21, v[176:179] offset:448
    ds_write_b128 v21, v[180:183] offset:8896
    ds_write_b128 v21, v[184:187] offset:17344
    ds_write_b128 v21, v[188:191] offset:25792
    s_waitcnt lgkmcnt(0)
    s_barrier
L_w_tile:
    s_add_u32 s7, s27, s4
    s_lshr_b32 s28, s7, 5
    s_and_b32 s7, s7, 31
    s_lshl_b32 s22, s7, 8
    s_lshl_b32 s26, s7, 13
    s_lshl_b32 s20, s5, 19
    s_add_u32 s26, s26, s20
    s_lshl_b32 s30, s7, 6
    s_lshl_b32 s20, s5, 11
    s_add_u32 s30, s30, s20
    s_lshl_b32 s20, s28, 4
    s_add_u32 s30, s30, s20
    s_add_u32 s30, s30, 60817408
    s_cmp_eq_u32 s28, 1
    s_cbranch_scc1 L_w_v
    s_cmp_eq_u32 s28, 2
    s_cbranch_scc1 L_w_q
    s_mov_b32 s16, s38
    s_and_b32 s17, s39, 0xffff
    s_mov_b32 s18, 4194304
    s_mov_b32 s19, 0x00020000
    s_add_u32 s26, s26, 16777216
    s_branch L_w_kq
L_w_q:
    s_mov_b32 s16, s36
    s_and_b32 s17, s37, 0xffff
    s_mov_b32 s18, 4194304
    s_mov_b32 s19, 0x00020000
    s_add_u32 s26, s26, 0
L_w_kq:
    v_add_u32 v8, 0, v12
    v_add_u32 v9, 33792, v12
    v_add_u32 v10, 67584, v12
    v_add_u32 v11, 101376, v12
    s_cmp_eq_u32 s52, 2
    s_cbranch_scc1 L_w_k2
    buffer_load_dwordx4 v[24:27], v16, s[16:19], s22 offen
    buffer_load_dwordx4 v[28:31], v17, s[16:19], s22 offen
    buffer_load_dwordx4 v[32:35], v18, s[16:19], s22 offen
    buffer_load_dwordx4 v[36:39], v19, s[16:19], s22 offen
    s_add_u32 s22, s22, 131072
    buffer_load_dwordx4 v[40:43], v16, s[16:19], s22 offen
    buffer_load_dwordx4 v[44:47], v17, s[16:19], s22 offen
    buffer_load_dwordx4 v[48:51], v18, s[16:19], s22 offen
    buffer_load_dwordx4 v[52:55], v19, s[16:19], s22 offen
    s_add_u32 s22, s22, 131072
    buffer_load_dwordx4 v[56:59], v16, s[16:19], s22 offen
    buffer_load_dwordx4 v[60:63], v17, s[16:19], s22 offen
    buffer_load_dwordx4 v[64:67], v18, s[16:19], s22 offen
    buffer_load_dwordx4 v[68:71], v19, s[16:19], s22 offen
    s_add_u32 s22, s22, 131072
    buffer_load_dwordx4 v[72:75], v16, s[16:19], s22 offen
    buffer_load_dwordx4 v[76:79], v17, s[16:19], s22 offen
    buffer_load_dwordx4 v[80:83], v18, s[16:19], s22 offen
    buffer_load_dwordx4 v[84:87], v19, s[16:19], s22 offen
    s_add_u32 s22, s22, 131072
    ds_read_b128 v[120:123], v8 offset:0
    ds_read_b128 v[124:127], v9 offset:0
    ds_read_b128 v[128:131], v10 offset:0
    ds_read_b128 v[132:135], v11 offset:0
    s_waitcnt vmcnt(12)
    v_permlane16_swap_b32 v24, v26
    v_permlane16_swap_b32 v25, v27
    v_permlane16_swap_b32 v28, v30
    v_permlane16_swap_b32 v29, v31
    v_permlane16_swap_b32 v32, v34
    v_permlane16_swap_b32 v33, v35
    v_permlane16_swap_b32 v36, v38
    v_permlane16_swap_b32 v37, v39
    v_perm_b32 v88, v26, v24, s23
    v_perm_b32 v89, v30, v28, s23
    v_perm_b32 v90, v34, v32, s23
    v_perm_b32 v91, v38, v36, s23
    v_perm_b32 v92, v26, v24, s24
    v_perm_b32 v93, v30, v28, s24
    v_perm_b32 v94, v34, v32, s24
    v_perm_b32 v95, v38, v36, s24
    v_perm_b32 v96, v27, v25, s23
    v_perm_b32 v97, v31, v29, s23
    v_perm_b32 v98, v35, v33, s23
    v_perm_b32 v99, v39, v37, s23
    v_perm_b32 v100, v27, v25, s24
    v_perm_b32 v101, v31, v29, s24
    v_perm_b32 v102, v35, v33, s24
    v_perm_b32 v103, v39, v37, s24
    s_waitcnt lgkmcnt(0)
    v_mfma_f32_32x32x16_bf16 a[0:15], v[88:91], v[120:123], 0
    ds_read_b128 v[136:139], v8 offset:1056
    ds_read_b128 v[140:143], v9 offset:1056
    ds_read_b128 v[144:147], v10 offset:1056
    v_mfma_f32_32x32x16_bf16 a[64:79], v[88:91], v[124:127], 0
    ds_read_b128 v[148:151], v11 offset:1056
    buffer_load_dwordx4 v[24:27], v16, s[16:19], s22 offen
    buffer_load_dwordx4 v[28:31], v17, s[16:19], s22 offen
    v_mfma_f32_32x32x16_bf16 a[128:143], v[88:91], v[128:131], 0
    buffer_load_dwordx4 v[32:35], v18, s[16:19], s22 offen
    buffer_load_dwordx4 v[36:39], v19, s[16:19], s22 offen
    s_add_u32 s22, s22, 131072
    v_mfma_f32_32x32x16_bf16 a[192:207], v[88:91], v[132:135], 0
    s_waitcnt vmcnt(12)
    v_permlane16_swap_b32 v40, v42
    v_permlane16_swap_b32 v41, v43
    v_mfma_f32_32x32x16_bf16 a[16:31], v[92:95], v[120:123], 0
    v_permlane16_swap_b32 v44, v46
    v_permlane16_swap_b32 v45, v47
    v_permlane16_swap_b32 v48, v50
    v_mfma_f32_32x32x16_bf16 a[80:95], v[92:95], v[124:127], 0
    v_permlane16_swap_b32 v49, v51
    v_permlane16_swap_b32 v52, v54
    v_permlane16_swap_b32 v53, v55
    v_mfma_f32_32x32x16_bf16 a[144:159], v[92:95], v[128:131], 0
    v_perm_b32 v104, v42, v40, s23
    v_perm_b32 v105, v46, v44, s23
    v_perm_b32 v106, v50, v48, s23
    v_mfma_f32_32x32x16_bf16 a[208:223], v[92:95], v[132:135], 0
    v_perm_b32 v107, v54, v52, s23
    v_perm_b32 v108, v42, v40, s24
    v_perm_b32 v109, v46, v44, s24
    v_mfma_f32_32x32x16_bf16 a[32:47], v[96:99], v[120:123], 0
    v_perm_b32 v110, v50, v48, s24
    v_perm_b32 v111, v54, v52, s24
    v_perm_b32 v112, v43, v41, s23
    v_mfma_f32_32x32x16_bf16 a[96:111], v[96:99], v[124:127], 0
    v_perm_b32 v113, v47, v45, s23
    v_perm_b32 v114, v51, v49, s23
    v_perm_b32 v115, v55, v53, s23
    v_mfma_f32_32x32x16_bf16 a[160:175], v[96:99], v[128:131], 0
    v_perm_b32 v116, v43, v41, s24
    v_perm_b32 v117, v47, v45, s24
    v_perm_b32 v118, v51, v49, s24
    v_mfma_f32_32x32x16_bf16 a[224:239], v[96:99], v[132:135], 0
    v_perm_b32 v119, v55, v53, s24
    s_waitcnt lgkmcnt(0)
    v_mfma_f32_32x32x16_bf16 a[48:63], v[100:103], v[120:123], 0
    v_mfma_f32_32x32x16_bf16 a[112:127], v[100:103], v[124:127], 0
    v_mfma_f32_32x32x16_bf16 a[176:191], v[100:103], v[128:131], 0
    v_mfma_f32_32x32x16_bf16 a[240:255], v[100:103], v[132:135], 0
    s_nop 0
    v_mfma_f32_32x32x16_bf16 a[0:15], v[104:107], v[136:139], a[0:15]
    ds_read_b128 v[120:123], v8 offset:2112
    ds_read_b128 v[124:127], v9 offset:2112
    ds_read_b128 v[128:131], v10 offset:2112
    v_mfma_f32_32x32x16_bf16 a[64:79], v[104:107], v[140:143], a[64:79]
    ds_read_b128 v[132:135], v11 offset:2112
    buffer_load_dwordx4 v[40:43], v16, s[16:19], s22 offen
    buffer_load_dwordx4 v[44:47], v17, s[16:19], s22 offen
    v_mfma_f32_32x32x16_bf16 a[128:143], v[104:107], v[144:147], a[128:143]
    buffer_load_dwordx4 v[48:51], v18, s[16:19], s22 offen
    buffer_load_dwordx4 v[52:55], v19, s[16:19], s22 offen
    s_add_u32 s22, s22, 131072
    v_mfma_f32_32x32x16_bf16 a[192:207], v[104:107], v[148:151], a[192:207]
    s_waitcnt vmcnt(12)
    v_permlane16_swap_b32 v56, v58
    v_permlane16_swap_b32 v57, v59
    v_mfma_f32_32x32x16_bf16 a[16:31], v[108:111], v[136:139], a[16:31]
    v_permlane16_swap_b32 v60, v62
    v_permlane16_swap_b32 v61, v63
    v_permlane16_swap_b32 v64, v66
    v_mfma_f32_32x32x16_bf16 a[80:95], v[108:111], v[140:143], a[80:95]
    v_permlane16_swap_b32 v65, v67
    v_permlane16_swap_b32 v68, v70
    v_permlane16_swap_b32 v69, v71
    v_mfma_f32_32x32x16_bf16 a[144:159], v[108:111], v[144:147], a[144:159]
    v_perm_b32 v88, v58, v56, s23
    v_perm_b32 v89, v62, v60, s23
    v_perm_b32 v90, v66, v64, s23
    v_mfma_f32_32x32x16_bf16 a[208:223], v[108:111], v[148:151], a[208:223]
    v_perm_b32 v91, v70, v68, s23
    v_perm_b32 v92, v58, v56, s24
    v_perm_b32 v93, v62, v60, s24
    v_mfma_f32_32x32x16_bf16 a[32:47], v[112:115], v[136:139], a[32:47]
    v_perm_b32 v94, v66, v64, s24
    v_perm_b32 v95, v70, v68, s24
    v_perm_b32 v96, v59, v57, s23
    v_mfma_f32_32x32x16_bf16 a[96:111], v[112:115], v[140:143], a[96:111]
    v_perm_b32 v97, v63, v61, s23
    v_perm_b32 v98, v67, v65, s23
    v_perm_b32 v99, v71, v69, s23
    v_mfma_f32_32x32x16_bf16 a[160:175], v[112:115], v[144:147], a[160:175]
    v_perm_b32 v100, v59, v57, s24
    v_perm_b32 v101, v63, v61, s24
    v_perm_b32 v102, v67, v65, s24
    v_mfma_f32_32x32x16_bf16 a[224:239], v[112:115], v[148:151], a[224:239]
    v_perm_b32 v103, v71, v69, s24
    s_waitcnt lgkmcnt(0)
    v_mfma_f32_32x32x16_bf16 a[48:63], v[116:119], v[136:139], a[48:63]
    v_mfma_f32_32x32x16_bf16 a[112:127], v[116:119], v[140:143], a[112:127]
    v_mfma_f32_32x32x16_bf16 a[176:191], v[116:119], v[144:147], a[176:191]
    v_mfma_f32_32x32x16_bf16 a[240:255], v[116:119], v[148:151], a[240:255]
    s_nop 0
    v_mfma_f32_32x32x16_bf16 a[0:15], v[88:91], v[120:123], a[0:15]
    ds_read_b128 v[136:139], v8 offset:3168
    ds_read_b128 v[140:143], v9 offset:3168
    ds_read_b128 v[144:147], v10 offset:3168
    v_mfma_f32_32x32x16_bf16 a[64:79], v[88:91], v[124:127], a[64:79]
    ds_read_b128 v[148:151], v11 offset:3168
    buffer_load_dwordx4 v[56:59], v16, s[16:19], s22 offen
    buffer_load_dwordx4 v[60:63], v17, s[16:19], s22 offen
    v_mfma_f32_32x32x16_bf16 a[128:143], v[88:91], v[128:131], a[128:143]
    buffer_load_dwordx4 v[64:67], v18, s[16:19], s22 offen
    buffer_load_dwordx4 v[68:71], v19, s[16:19], s22 offen
    s_add_u32 s22, s22, 131072
    v_mfma_f32_32x32x16_bf16 a[192:207], v[88:91], v[132:135], a[192:207]
    s_waitcnt vmcnt(12)
    v_permlane16_swap_b32 v72, v74
    v_permlane16_swap_b32 v73, v75
    v_mfma_f32_32x32x16_bf16 a[16:31], v[92:95], v[120:123], a[16:31]
    v_permlane16_swap_b32 v76, v78
    v_permlane16_swap_b32 v77, v79
    v_permlane16_swap_b32 v80, v82
    v_mfma_f32_32x32x16_bf16 a[80:95], v[92:95], v[124:127], a[80:95]
    v_permlane16_swap_b32 v81, v83
    v_permlane16_swap_b32 v84, v86
    v_permlane16_swap_b32 v85, v87
    v_mfma_f32_32x32x16_bf16 a[144:159], v[92:95], v[128:131], a[144:159]
    v_perm_b32 v104, v74, v72, s23
    v_perm_b32 v105, v78, v76, s23
    v_perm_b32 v106, v82, v80, s23
    v_mfma_f32_32x32x16_bf16 a[208:223], v[92:95], v[132:135], a[208:223]
    v_perm_b32 v107, v86, v84, s23
    v_perm_b32 v108, v74, v72, s24
    v_perm_b32 v109, v78, v76, s24
    v_mfma_f32_32x32x16_bf16 a[32:47], v[96:99], v[120:123], a[32:47]
    v_perm_b32 v110, v82, v80, s24
    v_perm_b32 v111, v86, v84, s24
    v_perm_b32 v112, v75, v73, s23
    v_mfma_f32_32x32x16_bf16 a[96:111], v[96:99], v[124:127], a[96:111]
    v_perm_b32 v113, v79, v77, s23
    v_perm_b32 v114, v83, v81, s23
    v_perm_b32 v115, v87, v85, s23
    v_mfma_f32_32x32x16_bf16 a[160:175], v[96:99], v[128:131], a[160:175]
    v_perm_b32 v116, v75, v73, s24
    v_perm_b32 v117, v79, v77, s24
    v_perm_b32 v118, v83, v81, s24
    v_mfma_f32_32x32x16_bf16 a[224:239], v[96:99], v[132:135], a[224:239]
    v_perm_b32 v119, v87, v85, s24
    s_waitcnt lgkmcnt(0)
    v_mfma_f32_32x32x16_bf16 a[48:63], v[100:103], v[120:123], a[48:63]
    v_mfma_f32_32x32x16_bf16 a[112:127], v[100:103], v[124:127], a[112:127]
    v_mfma_f32_32x32x16_bf16 a[176:191], v[100:103], v[128:131], a[176:191]
    v_mfma_f32_32x32x16_bf16 a[240:255], v[100:103], v[132:135], a[240:255]
    s_nop 0
    v_mfma_f32_32x32x16_bf16 a[0:15], v[104:107], v[136:139], a[0:15]
    ds_read_b128 v[120:123], v8 offset:4224
    ds_read_b128 v[124:127], v9 offset:4224
    ds_read_b128 v[128:131], v10 offset:4224
    v_mfma_f32_32x32x16_bf16 a[64:79], v[104:107], v[140:143], a[64:79]
    ds_read_b128 v[132:135], v11 offset:4224
    buffer_load_dwordx4 v[72:75], v16, s[16:19], s22 offen
    buffer_load_dwordx4 v[76:79], v17, s[16:19], s22 offen
    v_mfma_f32_32x32x16_bf16 a[128:143], v[104:107], v[144:147], a[128:143]
    buffer_load_dwordx4 v[80:83], v18, s[16:19], s22 offen
    buffer_load_dwordx4 v[84:87], v19, s[16:19], s22 offen
    s_add_u32 s22, s22, 131072
    v_mfma_f32_32x32x16_bf16 a[192:207], v[104:107], v[148:151], a[192:207]
    s_waitcnt vmcnt(12)
    v_permlane16_swap_b32 v24, v26
    v_permlane16_swap_b32 v25, v27
    v_mfma_f32_32x32x16_bf16 a[16:31], v[108:111], v[136:139], a[16:31]
    v_permlane16_swap_b32 v28, v30
    v_permlane16_swap_b32 v29, v31
    v_permlane16_swap_b32 v32, v34
    v_mfma_f32_32x32x16_bf16 a[80:95], v[108:111], v[140:143], a[80:95]
    v_permlane16_swap_b32 v33, v35
    v_permlane16_swap_b32 v36, v38
    v_permlane16_swap_b32 v37, v39
    v_mfma_f32_32x32x16_bf16 a[144:159], v[108:111], v[144:147], a[144:159]
    v_perm_b32 v88, v26, v24, s23
    v_perm_b32 v89, v30, v28, s23
    v_perm_b32 v90, v34, v32, s23
    v_mfma_f32_32x32x16_bf16 a[208:223], v[108:111], v[148:151], a[208:223]
    v_perm_b32 v91, v38, v36, s23
    v_perm_b32 v92, v26, v24, s24
    v_perm_b32 v93, v30, v28, s24
    v_mfma_f32_32x32x16_bf16 a[32:47], v[112:115], v[136:139], a[32:47]
    v_perm_b32 v94, v34, v32, s24
    v_perm_b32 v95, v38, v36, s24
    v_perm_b32 v96, v27, v25, s23
    v_mfma_f32_32x32x16_bf16 a[96:111], v[112:115], v[140:143], a[96:111]
    v_perm_b32 v97, v31, v29, s23
    v_perm_b32 v98, v35, v33, s23
    v_perm_b32 v99, v39, v37, s23
    v_mfma_f32_32x32x16_bf16 a[160:175], v[112:115], v[144:147], a[160:175]
    v_perm_b32 v100, v27, v25, s24
    v_perm_b32 v101, v31, v29, s24
    v_perm_b32 v102, v35, v33, s24
    v_mfma_f32_32x32x16_bf16 a[224:239], v[112:115], v[148:151], a[224:239]
    v_perm_b32 v103, v39, v37, s24
    s_waitcnt lgkmcnt(0)
    v_mfma_f32_32x32x16_bf16 a[48:63], v[116:119], v[136:139], a[48:63]
    v_mfma_f32_32x32x16_bf16 a[112:127], v[116:119], v[140:143], a[112:127]
    v_mfma_f32_32x32x16_bf16 a[176:191], v[116:119], v[144:147], a[176:191]
    v_mfma_f32_32x32x16_bf16 a[240:255], v[116:119], v[148:151], a[240:255]
    s_nop 0
    s_mov_b32 s21, 7
L_gk_9:
    v_add_u32 v8, 4224, v8
    v_add_u32 v9, 4224, v9
    v_add_u32 v10, 4224, v10
    v_add_u32 v11, 4224, v11
    v_mfma_f32_32x32x16_bf16 a[0:15], v[88:91], v[120:123], a[0:15]
    ds_read_b128 v[136:139], v8 offset:1056
    ds_read_b128 v[140:143], v9 offset:1056
    ds_read_b128 v[144:147], v10 offset:1056
    v_mfma_f32_32x32x16_bf16 a[64:79], v[88:91], v[124:127], a[64:79]
    ds_read_b128 v[148:151], v11 offset:1056
    buffer_load_dwordx4 v[24:27], v16, s[16:19], s22 offen
    buffer_load_dwordx4 v[28:31], v17, s[16:19], s22 offen
    v_mfma_f32_32x32x16_bf16 a[128:143], v[88:91], v[128:131], a[128:143]
    buffer_load_dwordx4 v[32:35], v18, s[16:19], s22 offen
    buffer_load_dwordx4 v[36:39], v19, s[16:19], s22 offen
    s_add_u32 s22, s22, 131072
    v_mfma_f32_32x32x16_bf16 a[192:207], v[88:91], v[132:135], a[192:207]
    s_waitcnt vmcnt(12)
    v_permlane16_swap_b32 v40, v42
    v_permlane16_swap_b32 v41, v43
    v_mfma_f32_32x32x16_bf16 a[16:31], v[92:95], v[120:123], a[16:31]
    v_permlane16_swap_b32 v44, v46
    v_permlane16_swap_b32 v45, v47
    v_permlane16_swap_b32 v48, v50
    v_mfma_f32_32x32x16_bf16 a[80:95], v[92:95], v[124:127], a[80:95]
    v_permlane16_swap_b32 v49, v51
    v_permlane16_swap_b32 v52, v54
    v_permlane16_swap_b32 v53, v55
    v_mfma_f32_32x32x16_bf16 a[144:159], v[92:95], v[128:131], a[144:159]
    v_perm_b32 v104, v42, v40, s23
    v_perm_b32 v105, v46, v44, s23
    v_perm_b32 v106, v50, v48, s23
    v_mfma_f32_32x32x16_bf16 a[208:223], v[92:95], v[132:135], a[208:223]
    v_perm_b32 v107, v54, v52, s23
    v_perm_b32 v108, v42, v40, s24
    v_perm_b32 v109, v46, v44, s24
    v_mfma_f32_32x32x16_bf16 a[32:47], v[96:99], v[120:123], a[32:47]
    v_perm_b32 v110, v50, v48, s24
    v_perm_b32 v111, v54, v52, s24
    v_perm_b32 v112, v43, v41, s23
    v_mfma_f32_32x32x16_bf16 a[96:111], v[96:99], v[124:127], a[96:111]
    v_perm_b32 v113, v47, v45, s23
    v_perm_b32 v114, v51, v49, s23
    v_perm_b32 v115, v55, v53, s23
    v_mfma_f32_32x32x16_bf16 a[160:175], v[96:99], v[128:131], a[160:175]
    v_perm_b32 v116, v43, v41, s24
    v_perm_b32 v117, v47, v45, s24
    v_perm_b32 v118, v51, v49, s24
    v_mfma_f32_32x32x16_bf16 a[224:239], v[96:99], v[132:135], a[224:239]
    v_perm_b32 v119, v55, v53, s24
    s_waitcnt lgkmcnt(0)
    v_mfma_f32_32x32x16_bf16 a[48:63], v[100:103], v[120:123], a[48:63]
    v_mfma_f32_32x32x16_bf16 a[112:127], v[100:103], v[124:127], a[112:127]
    v_mfma_f32_32x32x16_bf16 a[176:191], v[100:103], v[128:131], a[176:191]
    v_mfma_f32_32x32x16_bf16 a[240:255], v[100:103], v[132:135], a[240:255]
    s_nop 0
    v_mfma_f32_32x32x16_bf16 a[0:15], v[104:107], v[136:139], a[0:15]
    ds_read_b128 v[120:123], v8 offset:2112
    ds_read_b128 v[124:127], v9 offset:2112
    ds_read_b128 v[128:131], v10 offset:2112
    v_mfma_f32_32x32x16_bf16 a[64:79], v[104:107], v[140:143], a[64:79]
    ds_read_b128 v[132:135], v11 offset:2112
    buffer_load_dwordx4 v[40:43], v16, s[16:19], s22 offen
    buffer_load_dwordx4 v[44:47], v17, s[16:19], s22 offen
    v_mfma_f32_32x32x16_bf16 a[128:143], v[104:107], v[144:147], a[128:143]
    buffer_load_dwordx4 v[48:51], v18, s[16:19], s22 offen
    buffer_load_dwordx4 v[52:55], v19, s[16:19], s22 offen
    s_add_u32 s22, s22, 131072
    v_mfma_f32_32x32x16_bf16 a[192:207], v[104:107], v[148:151], a[192:207]
    s_waitcnt vmcnt(12)
    v_permlane16_swap_b32 v56, v58
    v_permlane16_swap_b32 v57, v59
    v_mfma_f32_32x32x16_bf16 a[16:31], v[108:111], v[136:139], a[16:31]
    v_permlane16_swap_b32 v60, v62
    v_permlane16_swap_b32 v61, v63
    v_permlane16_swap_b32 v64, v66
    v_mfma_f32_32x32x16_bf16 a[80:95], v[108:111], v[140:143], a[80:95]
    v_permlane16_swap_b32 v65, v67
    v_permlane16_swap_b32 v68, v70
    v_permlane16_swap_b32 v69, v71
    v_mfma_f32_32x32x16_bf16 a[144:159], v[108:111], v[144:147], a[144:159]
    v_perm_b32 v88, v58, v56, s23
    v_perm_b32 v89, v62, v60, s23
    v_perm_b32 v90, v66, v64, s23
    v_mfma_f32_32x32x16_bf16 a[208:223], v[108:111], v[148:151], a[208:223]
    v_perm_b32 v91, v70, v68, s23
    v_perm_b32 v92, v58, v56, s24
    v_perm_b32 v93, v62, v60, s24
    v_mfma_f32_32x32x16_bf16 a[32:47], v[112:115], v[136:139], a[32:47]
    v_perm_b32 v94, v66, v64, s24
    v_perm_b32 v95, v70, v68, s24
    v_perm_b32 v96, v59, v57, s23
    v_mfma_f32_32x32x16_bf16 a[96:111], v[112:115], v[140:143], a[96:111]
    v_perm_b32 v97, v63, v61, s23
    v_perm_b32 v98, v67, v65, s23
    v_perm_b32 v99, v71, v69, s23
    v_mfma_f32_32x32x16_bf16 a[160:175], v[112:115], v[144:147], a[160:175]
    v_perm_b32 v100, v59, v57, s24
    v_perm_b32 v101, v63, v61, s24
    v_perm_b32 v102, v67, v65, s24
    v_mfma_f32_32x32x16_bf16 a[224:239], v[112:115], v[148:151], a[224:239]
    v_perm_b32 v103, v71, v69, s24
    s_waitcnt lgkmcnt(0)
    v_mfma_f32_32x32x16_bf16 a[48:63], v[116:119], v[136:139], a[48:63]
    v_mfma_f32_32x32x16_bf16 a[112:127], v[116:119], v[140:143], a[112:127]
    v_mfma_f32_32x32x16_bf16 a[176:191], v[116:119], v[144:147], a[176:191]
    v_mfma_f32_32x32x16_bf16 a[240:255], v[116:119], v[148:151], a[240:255]
    s_nop 0
    v_mfma_f32_32x32x16_bf16 a[0:15], v[88:91], v[120:123], a[0:15]
    ds_read_b128 v[136:139], v8 offset:3168
    ds_read_b128 v[140:143], v9 offset:3168
    ds_read_b128 v[144:147], v10 offset:3168
    v_mfma_f32_32x32x16_bf16 a[64:79], v[88:91], v[124:127], a[64:79]
    ds_read_b128 v[148:151], v11 offset:3168
    buffer_load_dwordx4 v[56:59], v16, s[16:19], s22 offen
    buffer_load_dwordx4 v[60:63], v17, s[16:19], s22 offen
    v_mfma_f32_32x32x16_bf16 a[128:143], v[88:91], v[128:131], a[128:143]
    buffer_load_dwordx4 v[64:67], v18, s[16:19], s22 offen
    buffer_load_dwordx4 v[68:71], v19, s[16:19], s22 offen
    s_add_u32 s22, s22, 131072
    v_mfma_f32_32x32x16_bf16 a[192:207], v[88:91], v[132:135], a[192:207]
    s_waitcnt vmcnt(12)
    v_permlane16_swap_b32 v72, v74
    v_permlane16_swap_b32 v73, v75
    v_mfma_f32_32x32x16_bf16 a[16:31], v[92:95], v[120:123], a[16:31]
    v_permlane16_swap_b32 v76, v78
    v_permlane16_swap_b32 v77, v79
    v_permlane16_swap_b32 v80, v82
    v_mfma_f32_32x32x16_bf16 a[80:95], v[92:95], v[124:127], a[80:95]
    v_permlane16_swap_b32 v81, v83
    v_permlane16_swap_b32 v84, v86
    v_permlane16_swap_b32 v85, v87
    v_mfma_f32_32x32x16_bf16 a[144:159], v[92:95], v[128:131], a[144:159]
    v_perm_b32 v104, v74, v72, s23
    v_perm_b32 v105, v78, v76, s23
    v_perm_b32 v106, v82, v80, s23
    v_mfma_f32_32x32x16_bf16 a[208:223], v[92:95], v[132:135], a[208:223]
    v_perm_b32 v107, v86, v84, s23
    v_perm_b32 v108, v74, v72, s24
    v_perm_b32 v109, v78, v76, s24
    v_mfma_f32_32x32x16_bf16 a[32:47], v[96:99], v[120:123], a[32:47]
    v_perm_b32 v110, v82, v80, s24
    v_perm_b32 v111, v86, v84, s24
    v_perm_b32 v112, v75, v73, s23
    v_mfma_f32_32x32x16_bf16 a[96:111], v[96:99], v[124:127], a[96:111]
    v_perm_b32 v113, v79, v77, s23
    v_perm_b32 v114, v83, v81, s23
    v_perm_b32 v115, v87, v85, s23
    v_mfma_f32_32x32x16_bf16 a[160:175], v[96:99], v[128:131], a[160:175]
    v_perm_b32 v116, v75, v73, s24
    v_perm_b32 v117, v79, v77, s24
    v_perm_b32 v118, v83, v81, s24
    v_mfma_f32_32x32x16_bf16 a[224:239], v[96:99], v[132:135], a[224:239]
    v_perm_b32 v119, v87, v85, s24
    s_waitcnt lgkmcnt(0)
    v_mfma_f32_32x32x16_bf16 a[48:63], v[100:103], v[120:123], a[48:63]
    v_mfma_f32_32x32x16_bf16 a[112:127], v[100:103], v[124:127], a[112:127]
    v_mfma_f32_32x32x16_bf16 a[176:191], v[100:103], v[128:131], a[176:191]
    v_mfma_f32_32x32x16_bf16 a[240:255], v[100:103], v[132:135], a[240:255]
    s_nop 0
    v_mfma_f32_32x32x16_bf16 a[0:15], v[104:107], v[136:139], a[0:15]
    ds_read_b128 v[120:123], v8 offset:4224
    ds_read_b128 v[124:127], v9 offset:4224
    ds_read_b128 v[128:131], v10 offset:4224
    v_mfma_f32_32x32x16_bf16 a[64:79], v[104:107], v[140:143], a[64:79]
    ds_read_b128 v[132:135], v11 offset:4224
    buffer_load_dwordx4 v[72:75], v16, s[16:19], s22 offen
    buffer_load_dwordx4 v[76:79], v17, s[16:19], s22 offen
    v_mfma_f32_32x32x16_bf16 a[128:143], v[104:107], v[144:147], a[128:143]
    buffer_load_dwordx4 v[80:83], v18, s[16:19], s22 offen
    buffer_load_dwordx4 v[84:87], v19, s[16:19], s22 offen
    s_add_u32 s22, s22, 131072
    v_mfma_f32_32x32x16_bf16 a[192:207], v[104:107], v[148:151], a[192:207]
    s_waitcnt vmcnt(12)
    v_permlane16_swap_b32 v24, v26
    v_permlane16_swap_b32 v25, v27
    v_mfma_f32_32x32x16_bf16 a[16:31], v[108:111], v[136:139], a[16:31]
    v_permlane16_swap_b32 v28, v30
    v_permlane16_swap_b32 v29, v31
    v_permlane16_swap_b32 v32, v34
    v_mfma_f32_32x32x16_bf16 a[80:95], v[108:111], v[140:143], a[80:95]
    v_permlane16_swap_b32 v33, v35
    v_permlane16_swap_b32 v36, v38
    v_permlane16_swap_b32 v37, v39
    v_mfma_f32_32x32x16_bf16 a[144:159], v[108:111], v[144:147], a[144:159]
    v_perm_b32 v88, v26, v24, s23
    v_perm_b32 v89, v30, v28, s23
    v_perm_b32 v90, v34, v32, s23
    v_mfma_f32_32x32x16_bf16 a[208:223], v[108:111], v[148:151], a[208:223]
    v_perm_b32 v91, v38, v36, s23
    v_perm_b32 v92, v26, v24, s24
    v_perm_b32 v93, v30, v28, s24
    v_mfma_f32_32x32x16_bf16 a[32:47], v[112:115], v[136:139], a[32:47]
    v_perm_b32 v94, v34, v32, s24
    v_perm_b32 v95, v38, v36, s24
    v_perm_b32 v96, v27, v25, s23
    v_mfma_f32_32x32x16_bf16 a[96:111], v[112:115], v[140:143], a[96:111]
    v_perm_b32 v97, v31, v29, s23
    v_perm_b32 v98, v35, v33, s23
    v_perm_b32 v99, v39, v37, s23
    v_mfma_f32_32x32x16_bf16 a[160:175], v[112:115], v[144:147], a[160:175]
    v_perm_b32 v100, v27, v25, s24
    v_perm_b32 v101, v31, v29, s24
    v_perm_b32 v102, v35, v33, s24
    v_mfma_f32_32x32x16_bf16 a[224:239], v[112:115], v[148:151], a[224:239]
    v_perm_b32 v103, v39, v37, s24
    s_waitcnt lgkmcnt(0)
    v_mfma_f32_32x32x16_bf16 a[48:63], v[116:119], v[136:139], a[48:63]
    v_mfma_f32_32x32x16_bf16 a[112:127], v[116:119], v[140:143], a[112:127]
    v_mfma_f32_32x32x16_bf16 a[176:191], v[116:119], v[144:147], a[176:191]
    v_mfma_f32_32x32x16_bf16 a[240:255], v[116:119], v[148:151], a[240:255]
    s_nop 0
    s_sub_u32 s21, s21, 1
    s_cmp_lg_u32 s21, 0
    s_cbranch_scc1 L_gk_9
    s_nop 7
    s_nop 7
    s_branch L_w_ke
L_w_k2:
    buffer_load_dwordx4 v[24:27], v16, s[16:19], s22 offen
    buffer_load_dwordx4 v[28:31], v17, s[16:19], s22 offen
    buffer_load_dwordx4 v[32:35], v18, s[16:19], s22 offen
    buffer_load_dwordx4 v[36:39], v19, s[16:19], s22 offen
    s_add_u32 s22, s22, 131072
    buffer_load_dwordx4 v[40:43], v16, s[16:19], s22 offen
    buffer_load_dwordx4 v[44:47], v17, s[16:19], s22 offen
    buffer_load_dwordx4 v[48:51], v18, s[16:19], s22 offen
    buffer_load_dwordx4 v[52:55], v19, s[16:19], s22 offen
    s_add_u32 s22, s22, 131072
    buffer_load_dwordx4 v[56:59], v16, s[16:19], s22 offen
    buffer_load_dwordx4 v[60:63], v17, s[16:19], s22 offen
    buffer_load_dwordx4 v[64:67], v18, s[16:19], s22 offen
    buffer_load_dwordx4 v[68:71], v19, s[16:19], s22 offen
    s_add_u32 s22, s22, 131072
    buffer_load_dwordx4 v[72:75], v16, s[16:19], s22 offen
    buffer_load_dwordx4 v[76:79], v17, s[16:19], s22 offen
    buffer_load_dwordx4 v[80:83], v18, s[16:19], s22 offen
    buffer_load_dwordx4 v[84:87], v19, s[16:19], s22 offen
    s_add_u32 s22, s22, 131072
    ds_read_b128 v[120:123], v8 offset:0
    ds_read_b128 v[124:127], v9 offset:0
    s_waitcnt vmcnt(12)
    v_permlane16_swap_b32 v24, v26
    v_permlane16_swap_b32 v25, v27
    v_permlane16_swap_b32 v28, v30
    v_permlane16_swap_b32 v29, v31
    v_permlane16_swap_b32 v32, v34
    v_permlane16_swap_b32 v33, v35
    v_permlane16_swap_b32 v36, v38
    v_permlane16_swap_b32 v37, v39
    v_perm_b32 v88, v26, v24, s23
    v_perm_b32 v89, v30, v28, s23
    v_perm_b32 v90, v34, v32, s23
    v_perm_b32 v91, v38, v36, s23
    v_perm_b32 v92, v26, v24, s24
    v_perm_b32 v93, v30, v28, s24
    v_perm_b32 v94, v34, v32, s24
    v_perm_b32 v95, v38, v36, s24
    v_perm_b32 v96, v27, v25, s23
    v_perm_b32 v97, v31, v29, s23
    v_perm_b32 v98, v35, v33, s23
    v_perm_b32 v99, v39, v37, s23
    v_perm_b32 v100, v27, v25, s24
    v_perm_b32 v101, v31, v29, s24
    v_perm_b32 v102, v35, v33, s24
    v_perm_b32 v103, v39, v37, s24
    s_waitcnt lgkmcnt(0)
    v_mfma_f32_32x32x16_bf16 a[0:15], v[88:91], v[120:123], 0
    ds_read_b128 v[136:139], v8 offset:1056
    ds_read_b128 v[140:143], v9 offset:1056
    buffer_load_dwordx4 v[24:27], v16, s[16:19], s22 offen
    buffer_load_dwordx4 v[28:31], v17, s[16:19], s22 offen
    buffer_load_dwordx4 v[32:35], v18, s[16:19], s22 offen
    v_mfma_f32_32x32x16_bf16 a[64:79], v[88:91], v[124:127], 0
    buffer_load_dwordx4 v[36:39], v19, s[16:19], s22 offen
    s_add_u32 s22, s22, 131072
    s_waitcnt vmcnt(12)
    v_permlane16_swap_b32 v40, v42
    v_permlane16_swap_b32 v41, v43
    v_mfma_f32_32x32x16_bf16 a[16:31], v[92:95], v[120:123], 0
    v_permlane16_swap_b32 v44, v46
    v_permlane16_swap_b32 v45, v47
    v_permlane16_swap_b32 v48, v50
    v_permlane16_swap_b32 v49, v51
    v_permlane16_swap_b32 v52, v54
    v_mfma_f32_32x32x16_bf16 a[80:95], v[92:95], v[124:127], 0
    v_permlane16_swap_b32 v53, v55
    v_perm_b32 v104, v42, v40, s23
    v_perm_b32 v105, v46, v44, s23
    v_perm_b32 v106, v50, v48, s23
    v_perm_b32 v107, v54, v52, s23
    v_mfma_f32_32x32x16_bf16 a[32:47], v[96:99], v[120:123], 0
    v_perm_b32 v108, v42, v40, s24
    v_perm_b32 v109, v46, v44, s24
    v_perm_b32 v110, v50, v48, s24
    v_perm_b32 v111, v54, v52, s24
    v_perm_b32 v112, v43, v41, s23
    v_mfma_f32_32x32x16_bf16 a[96:111], v[96:99], v[124:127], 0
    v_perm_b32 v113, v47, v45, s23
    v_perm_b32 v114, v51, v49, s23
    v_perm_b32 v115, v55, v53, s23
    v_perm_b32 v116, v43, v41, s24
    v_perm_b32 v117, v47, v45, s24
    v_mfma_f32_32x32x16_bf16 a[48:63], v[100:103], v[120:123], 0
    v_perm_b32 v118, v51, v49, s24
    v_perm_b32 v119, v55, v53, s24
    s_waitcnt lgkmcnt(0)
    v_mfma_f32_32x32x16_bf16 a[112:127], v[100:103], v[124:127], 0
    s_nop 0
    v_mfma_f32_32x32x16_bf16 a[0:15], v[104:107], v[136:139], a[0:15]
    ds_read_b128 v[120:123], v8 offset:2112
    ds_read_b128 v[124:127], v9 offset:2112
    buffer_load_dwordx4 v[40:43], v16, s[16:19], s22 offen
    buffer_load_dwordx4 v[44:47], v17, s[16:19], s22 offen
    buffer_load_dwordx4 v[48:51], v18, s[16:19], s22 offen
    v_mfma_f32_32x32x16_bf16 a[64:79], v[104:107], v[140:143], a[64:79]
    buffer_load_dwordx4 v[52:55], v19, s[16:19], s22 offen
    s_add_u32 s22, s22, 131072
    s_waitcnt vmcnt(12)
    v_permlane16_swap_b32 v56, v58
    v_permlane16_swap_b32 v57, v59
    v_mfma_f32_32x32x16_bf16 a[16:31], v[108:111], v[136:139], a[16:31]
    v_permlane16_swap_b32 v60, v62
    v_permlane16_swap_b32 v61, v63
    v_permlane16_swap_b32 v64, v66
    v_permlane16_swap_b32 v65, v67
    v_permlane16_swap_b32 v68, v70
    v_mfma_f32_32x32x16_bf16 a[80:95], v[108:111], v[140:143], a[80:95]
    v_permlane16_swap_b32 v69, v71
    v_perm_b32 v88, v58, v56, s23
    v_perm_b32 v89, v62, v60, s23
    v_perm_b32 v90, v66, v64, s23
    v_perm_b32 v91, v70, v68, s23
    v_mfma_f32_32x32x16_bf16 a[32:47], v[112:115], v[136:139], a[32:47]
    v_perm_b32 v92, v58, v56, s24
    v_perm_b32 v93, v62, v60, s24
    v_perm_b32 v94, v66, v64, s24
    v_perm_b32 v95, v70, v68, s24
    v_perm_b32 v96, v59, v57, s23
    v_mfma_f32_32x32x16_bf16 a[96:111], v[112:115], v[140:143], a[96:111]
    v_perm_b32 v97, v63, v61, s23
    v_perm_b32 v98, v67, v65, s23
    v_perm_b32 v99, v71, v69, s23
    v_perm_b32 v100, v59, v57, s24
    v_perm_b32 v101, v63, v61, s24
    v_mfma_f32_32x32x16_bf16 a[48:63], v[116:119], v[136:139], a[48:63]
    v_perm_b32 v102, v67, v65, s24
    v_perm_b32 v103, v71, v69, s24
    s_waitcnt lgkmcnt(0)
    v_mfma_f32_32x32x16_bf16 a[112:127], v[116:119], v[140:143], a[112:127]
    s_nop 0
    v_mfma_f32_32x32x16_bf16 a[0:15], v[88:91], v[120:123], a[0:15]
    ds_read_b128 v[136:139], v8 offset:3168
    ds_read_b128 v[140:143], v9 offset:3168
    buffer_load_dwordx4 v[56:59], v16, s[16:19], s22 offen
    buffer_load_dwordx4 v[60:63], v17, s[16:19], s22 offen
    buffer_load_dwordx4 v[64:67], v18, s[16:19], s22 offen
    v_mfma_f32_32x32x16_bf16 a[64:79], v[88:91], v[124:127], a[64:79]
    buffer_load_dwordx4 v[68:71], v19, s[16:19], s22 offen
    s_add_u32 s22, s22, 131072
    s_waitcnt vmcnt(12)
    v_permlane16_swap_b32 v72, v74
    v_permlane16_swap_b32 v73, v75
    v_mfma_f32_32x32x16_bf16 a[16:31], v[92:95], v[120:123], a[16:31]
    v_permlane16_swap_b32 v76, v78
    v_permlane16_swap_b32 v77, v79
    v_permlane16_swap_b32 v80, v82
    v_permlane16_swap_b32 v81, v83
    v_permlane16_swap_b32 v84, v86
    v_mfma_f32_32x32x16_bf16 a[80:95], v[92:95], v[124:127], a[80:95]
    v_permlane16_swap_b32 v85, v87
    v_perm_b32 v104, v74, v72, s23
    v_perm_b32 v105, v78, v76, s23
    v_perm_b32 v106, v82, v80, s23
    v_perm_b32 v107, v86, v84, s23
    v_mfma_f32_32x32x16_bf16 a[32:47], v[96:99], v[120:123], a[32:47]
    v_perm_b32 v108, v74, v72, s24
    v_perm_b32 v109, v78, v76, s24
    v_perm_b32 v110, v82, v80, s24
    v_perm_b32 v111, v86, v84, s24
    v_perm_b32 v112, v75, v73, s23
    v_mfma_f32_32x32x16_bf16 a[96:111], v[96:99], v[124:127], a[96:111]
    v_perm_b32 v113, v79, v77, s23
    v_perm_b32 v114, v83, v81, s23
    v_perm_b32 v115, v87, v85, s23
    v_perm_b32 v116, v75, v73, s24
    v_perm_b32 v117, v79, v77, s24
    v_mfma_f32_32x32x16_bf16 a[48:63], v[100:103], v[120:123], a[48:63]
    v_perm_b32 v118, v83, v81, s24
    v_perm_b32 v119, v87, v85, s24
    s_waitcnt lgkmcnt(0)
    v_mfma_f32_32x32x16_bf16 a[112:127], v[100:103], v[124:127], a[112:127]
    s_nop 0
    v_mfma_f32_32x32x16_bf16 a[0:15], v[104:107], v[136:139], a[0:15]
    ds_read_b128 v[120:123], v8 offset:4224
    ds_read_b128 v[124:127], v9 offset:4224
    buffer_load_dwordx4 v[72:75], v16, s[16:19], s22 offen
    buffer_load_dwordx4 v[76:79], v17, s[16:19], s22 offen
    buffer_load_dwordx4 v[80:83], v18, s[16:19], s22 offen
    v_mfma_f32_32x32x16_bf16 a[64:79], v[104:107], v[140:143], a[64:79]
    buffer_load_dwordx4 v[84:87], v19, s[16:19], s22 offen
    s_add_u32 s22, s22, 131072
    s_waitcnt vmcnt(12)
    v_permlane16_swap_b32 v24, v26
    v_permlane16_swap_b32 v25, v27
    v_mfma_f32_32x32x16_bf16 a[16:31], v[108:111], v[136:139], a[16:31]
    v_permlane16_swap_b32 v28, v30
    v_permlane16_swap_b32 v29, v31
    v_permlane16_swap_b32 v32, v34
    v_permlane16_swap_b32 v33, v35
    v_permlane16_swap_b32 v36, v38
    v_mfma_f32_32x32x16_bf16 a[80:95], v[108:111], v[140:143], a[80:95]
    v_permlane16_swap_b32 v37, v39
    v_perm_b32 v88, v26, v24, s23
    v_perm_b32 v89, v30, v28, s23
    v_perm_b32 v90, v34, v32, s23
    v_perm_b32 v91, v38, v36, s23
    v_mfma_f32_32x32x16_bf16 a[32:47], v[112:115], v[136:139], a[32:47]
    v_perm_b32 v92, v26, v24, s24
    v_perm_b32 v93, v30, v28, s24
    v_perm_b32 v94, v34, v32, s24
    v_perm_b32 v95, v38, v36, s24
    v_perm_b32 v96, v27, v25, s23
    v_mfma_f32_32x32x16_bf16 a[96:111], v[112:115], v[140:143], a[96:111]
    v_perm_b32 v97, v31, v29, s23
    v_perm_b32 v98, v35, v33, s23
    v_perm_b32 v99, v39, v37, s23
    v_perm_b32 v100, v27, v25, s24
    v_perm_b32 v101, v31, v29, s24
    v_mfma_f32_32x32x16_bf16 a[48:63], v[116:119], v[136:139], a[48:63]
    v_perm_b32 v102, v35, v33, s24
    v_perm_b32 v103, v39, v37, s24
    s_waitcnt lgkmcnt(0)
    v_mfma_f32_32x32x16_bf16 a[112:127], v[116:119], v[140:143], a[112:127]
    s_nop 0
    s_mov_b32 s21, 7
L_gk2_10:
    v_add_u32 v8, 4224, v8
    v_add_u32 v9, 4224, v9
    v_mfma_f32_32x32x16_bf16 a[0:15], v[88:91], v[120:123], a[0:15]
    ds_read_b128 v[136:139], v8 offset:1056
    ds_read_b128 v[140:143], v9 offset:1056
    buffer_load_dwordx4 v[24:27], v16, s[16:19], s22 offen
    buffer_load_dwordx4 v[28:31], v17, s[16:19], s22 offen
    buffer_load_dwordx4 v[32:35], v18, s[16:19], s22 offen
    v_mfma_f32_32x32x16_bf16 a[64:79], v[88:91], v[124:127], a[64:79]
    buffer_load_dwordx4 v[36:39], v19, s[16:19], s22 offen
    s_add_u32 s22, s22, 131072
    s_waitcnt vmcnt(12)
    v_permlane16_swap_b32 v40, v42
    v_permlane16_swap_b32 v41, v43
    v_mfma_f32_32x32x16_bf16 a[16:31], v[92:95], v[120:123], a[16:31]
    v_permlane16_swap_b32 v44, v46
    v_permlane16_swap_b32 v45, v47
    v_permlane16_swap_b32 v48, v50
    v_permlane16_swap_b32 v49, v51
    v_permlane16_swap_b32 v52, v54
    v_mfma_f32_32x32x16_bf16 a[80:95], v[92:95], v[124:127], a[80:95]
    v_permlane16_swap_b32 v53, v55
    v_perm_b32 v104, v42, v40, s23
    v_perm_b32 v105, v46, v44, s23
    v_perm_b32 v106, v50, v48, s23
    v_perm_b32 v107, v54, v52, s23
    v_mfma_f32_32x32x16_bf16 a[32:47], v[96:99], v[120:123], a[32:47]
    v_perm_b32 v108, v42, v40, s24
    v_perm_b32 v109, v46, v44, s24
    v_perm_b32 v110, v50, v48, s24
    v_perm_b32 v111, v54, v52, s24
    v_perm_b32 v112, v43, v41, s23
    v_mfma_f32_32x32x16_bf16 a[96:111], v[96:99], v[124:127], a[96:111]
    v_perm_b32 v113, v47, v45, s23
    v_perm_b32 v114, v51, v49, s23
    v_perm_b32 v115, v55, v53, s23
    v_perm_b32 v116, v43, v41, s24
    v_perm_b32 v117, v47, v45, s24
    v_mfma_f32_32x32x16_bf16 a[48:63], v[100:103], v[120:123], a[48:63]
    v_perm_b32 v118, v51, v49, s24
    v_perm_b32 v119, v55, v53, s24
    s_waitcnt lgkmcnt(0)
    v_mfma_f32_32x32x16_bf16 a[112:127], v[100:103], v[124:127], a[112:127]
    s_nop 0
    v_mfma_f32_32x32x16_bf16 a[0:15], v[104:107], v[136:139], a[0:15]
    ds_read_b128 v[120:123], v8 offset:2112
    ds_read_b128 v[124:127], v9 offset:2112
    buffer_load_dwordx4 v[40:43], v16, s[16:19], s22 offen
    buffer_load_dwordx4 v[44:47], v17, s[16:19], s22 offen
    buffer_load_dwordx4 v[48:51], v18, s[16:19], s22 offen
    v_mfma_f32_32x32x16_bf16 a[64:79], v[104:107], v[140:143], a[64:79]
    buffer_load_dwordx4 v[52:55], v19, s[16:19], s22 offen
    s_add_u32 s22, s22, 131072
    s_waitcnt vmcnt(12)
    v_permlane16_swap_b32 v56, v58
    v_permlane16_swap_b32 v57, v59
    v_mfma_f32_32x32x16_bf16 a[16:31], v[108:111], v[136:139], a[16:31]
    v_permlane16_swap_b32 v60, v62
    v_permlane16_swap_b32 v61, v63
    v_permlane16_swap_b32 v64, v66
    v_permlane16_swap_b32 v65, v67
    v_permlane16_swap_b32 v68, v70
    v_mfma_f32_32x32x16_bf16 a[80:95], v[108:111], v[140:143], a[80:95]
    v_permlane16_swap_b32 v69, v71
    v_perm_b32 v88, v58, v56, s23
    v_perm_b32 v89, v62, v60, s23
    v_perm_b32 v90, v66, v64, s23
    v_perm_b32 v91, v70, v68, s23
    v_mfma_f32_32x32x16_bf16 a[32:47], v[112:115], v[136:139], a[32:47]
    v_perm_b32 v92, v58, v56, s24
    v_perm_b32 v93, v62, v60, s24
    v_perm_b32 v94, v66, v64, s24
    v_perm_b32 v95, v70, v68, s24
    v_perm_b32 v96, v59, v57, s23
    v_mfma_f32_32x32x16_bf16 a[96:111], v[112:115], v[140:143], a[96:111]
    v_perm_b32 v97, v63, v61, s23
    v_perm_b32 v98, v67, v65, s23
    v_perm_b32 v99, v71, v69, s23
    v_perm_b32 v100, v59, v57, s24
    v_perm_b32 v101, v63, v61, s24
    v_mfma_f32_32x32x16_bf16 a[48:63], v[116:119], v[136:139], a[48:63]
    v_perm_b32 v102, v67, v65, s24
    v_perm_b32 v103, v71, v69, s24
    s_waitcnt lgkmcnt(0)
    v_mfma_f32_32x32x16_bf16 a[112:127], v[116:119], v[140:143], a[112:127]
    s_nop 0
    v_mfma_f32_32x32x16_bf16 a[0:15], v[88:91], v[120:123], a[0:15]
    ds_read_b128 v[136:139], v8 offset:3168
    ds_read_b128 v[140:143], v9 offset:3168
    buffer_load_dwordx4 v[56:59], v16, s[16:19], s22 offen
    buffer_load_dwordx4 v[60:63], v17, s[16:19], s22 offen
    buffer_load_dwordx4 v[64:67], v18, s[16:19], s22 offen
    v_mfma_f32_32x32x16_bf16 a[64:79], v[88:91], v[124:127], a[64:79]
    buffer_load_dwordx4 v[68:71], v19, s[16:19], s22 offen
    s_add_u32 s22, s22, 131072
    s_waitcnt vmcnt(12)
    v_permlane16_swap_b32 v72, v74
    v_permlane16_swap_b32 v73, v75
    v_mfma_f32_32x32x16_bf16 a[16:31], v[92:95], v[120:123], a[16:31]
    v_permlane16_swap_b32 v76, v78
    v_permlane16_swap_b32 v77, v79
    v_permlane16_swap_b32 v80, v82
    v_permlane16_swap_b32 v81, v83
    v_permlane16_swap_b32 v84, v86
    v_mfma_f32_32x32x16_bf16 a[80:95], v[92:95], v[124:127], a[80:95]
    v_permlane16_swap_b32 v85, v87
    v_perm_b32 v104, v74, v72, s23
    v_perm_b32 v105, v78, v76, s23
    v_perm_b32 v106, v82, v80, s23
    v_perm_b32 v107, v86, v84, s23
    v_mfma_f32_32x32x16_bf16 a[32:47], v[96:99], v[120:123], a[32:47]
    v_perm_b32 v108, v74, v72, s24
    v_perm_b32 v109, v78, v76, s24
    v_perm_b32 v110, v82, v80, s24
    v_perm_b32 v111, v86, v84, s24
    v_perm_b32 v112, v75, v73, s23
    v_mfma_f32_32x32x16_bf16 a[96:111], v[96:99], v[124:127], a[96:111]
    v_perm_b32 v113, v79, v77, s23
    v_perm_b32 v114, v83, v81, s23
    v_perm_b32 v115, v87, v85, s23
    v_perm_b32 v116, v75, v73, s24
    v_perm_b32 v117, v79, v77, s24
    v_mfma_f32_32x32x16_bf16 a[48:63], v[100:103], v[120:123], a[48:63]
    v_perm_b32 v118, v83, v81, s24
    v_perm_b32 v119, v87, v85, s24
    s_waitcnt lgkmcnt(0)
    v_mfma_f32_32x32x16_bf16 a[112:127], v[100:103], v[124:127], a[112:127]
    s_nop 0
    v_mfma_f32_32x32x16_bf16 a[0:15], v[104:107], v[136:139], a[0:15]
    ds_read_b128 v[120:123], v8 offset:4224
    ds_read_b128 v[124:127], v9 offset:4224
    buffer_load_dwordx4 v[72:75], v16, s[16:19], s22 offen
    buffer_load_dwordx4 v[76:79], v17, s[16:19], s22 offen
    buffer_load_dwordx4 v[80:83], v18, s[16:19], s22 offen
    v_mfma_f32_32x32x16_bf16 a[64:79], v[104:107], v[140:143], a[64:79]
    buffer_load_dwordx4 v[84:87], v19, s[16:19], s22 offen
    s_add_u32 s22, s22, 131072
    s_waitcnt vmcnt(12)
    v_permlane16_swap_b32 v24, v26
    v_permlane16_swap_b32 v25, v27
    v_mfma_f32_32x32x16_bf16 a[16:31], v[108:111], v[136:139], a[16:31]
    v_permlane16_swap_b32 v28, v30
    v_permlane16_swap_b32 v29, v31
    v_permlane16_swap_b32 v32, v34
    v_permlane16_swap_b32 v33, v35
    v_permlane16_swap_b32 v36, v38
    v_mfma_f32_32x32x16_bf16 a[80:95], v[108:111], v[140:143], a[80:95]
    v_permlane16_swap_b32 v37, v39
    v_perm_b32 v88, v26, v24, s23
    v_perm_b32 v89, v30, v28, s23
    v_perm_b32 v90, v34, v32, s23
    v_perm_b32 v91, v38, v36, s23
    v_mfma_f32_32x32x16_bf16 a[32:47], v[112:115], v[136:139], a[32:47]
    v_perm_b32 v92, v26, v24, s24
    v_perm_b32 v93, v30, v28, s24
    v_perm_b32 v94, v34, v32, s24
    v_perm_b32 v95, v38, v36, s24
    v_perm_b32 v96, v27, v25, s23
    v_mfma_f32_32x32x16_bf16 a[96:111], v[112:115], v[140:143], a[96:111]
    v_perm_b32 v97, v31, v29, s23
    v_perm_b32 v98, v35, v33, s23
    v_perm_b32 v99, v39, v37, s23
    v_perm_b32 v100, v27, v25, s24
    v_perm_b32 v101, v31, v29, s24
    v_mfma_f32_32x32x16_bf16 a[48:63], v[116:119], v[136:139], a[48:63]
    v_perm_b32 v102, v35, v33, s24
    v_perm_b32 v103, v39, v37, s24
    s_waitcnt lgkmcnt(0)
    v_mfma_f32_32x32x16_bf16 a[112:127], v[116:119], v[140:143], a[112:127]
    s_nop 0
    s_sub_u32 s21, s21, 1
    s_cmp_lg_u32 s21, 0
    s_cbranch_scc1 L_gk2_10
    s_nop 7
    s_nop 7
L_w_ke:
    v_accvgpr_read_b32 v224, a0
    v_accvgpr_read_b32 v225, a16
    v_accvgpr_read_b32 v226, a32
    v_accvgpr_read_b32 v227, a48
    v_accvgpr_read_b32 v228, a8
    v_accvgpr_read_b32 v229, a24
    v_accvgpr_read_b32 v230, a40
    v_accvgpr_read_b32 v231, a56
    v_cvt_pk_bf16_f32 v232, v224, v225
    v_cvt_pk_bf16_f32 v233, v226, v227
    v_cvt_pk_bf16_f32 v234, v228, v229
    v_cvt_pk_bf16_f32 v235, v230, v231
    buffer_store_dwordx4 v[232:235], v5, s[8:11], s26 offen offset:0 sc1
    v_accvgpr_read_b32 v236, a1
    v_accvgpr_read_b32 v237, a17
    v_accvgpr_read_b32 v238, a33
    v_accvgpr_read_b32 v239, a49
    v_accvgpr_read_b32 v240, a9
    v_accvgpr_read_b32 v241, a25
    v_accvgpr_read_b32 v242, a41
    v_accvgpr_read_b32 v243, a57
    v_cvt_pk_bf16_f32 v244, v236, v237
    v_cvt_pk_bf16_f32 v245, v238, v239
    v_cvt_pk_bf16_f32 v246, v240, v241
    v_cvt_pk_bf16_f32 v247, v242, v243
    buffer_store_dwordx4 v[244:247], v5, s[8:11], s26 offen offset:256 sc1
    v_accvgpr_read_b32 v224, a2
    v_accvgpr_read_b32 v225, a18
    v_accvgpr_read_b32 v226, a34
    v_accvgpr_read_b32 v227, a50
    v_accvgpr_read_b32 v228, a10
    v_accvgpr_read_b32 v229, a26
    v_accvgpr_read_b32 v230, a42
    v_accvgpr_read_b32 v231, a58
    v_cvt_pk_bf16_f32 v232, v224, v225
    v_cvt_pk_bf16_f32 v233, v226, v227
    v_cvt_pk_bf16_f32 v234, v228, v229
    v_cvt_pk_bf16_f32 v235, v230, v231
    buffer_store_dwordx4 v[232:235], v5, s[8:11], s26 offen offset:512 sc1
    v_accvgpr_read_b32 v236, a3
    v_accvgpr_read_b32 v237, a19
    v_accvgpr_read_b32 v238, a35
    v_accvgpr_read_b32 v239, a51
    v_accvgpr_read_b32 v240, a11
    v_accvgpr_read_b32 v241, a27
    v_accvgpr_read_b32 v242, a43
    v_accvgpr_read_b32 v243, a59
    v_cvt_pk_bf16_f32 v244, v236, v237
    v_cvt_pk_bf16_f32 v245, v238, v239
    v_cvt_pk_bf16_f32 v246, v240, v241
    v_cvt_pk_bf16_f32 v247, v242, v243
    buffer_store_dwordx4 v[244:247], v5, s[8:11], s26 offen offset:768 sc1
    v_accvgpr_read_b32 v224, a4
    v_accvgpr_read_b32 v225, a20
    v_accvgpr_read_b32 v226, a36
    v_accvgpr_read_b32 v227, a52
    v_accvgpr_read_b32 v228, a12
    v_accvgpr_read_b32 v229, a28
    v_accvgpr_read_b32 v230, a44
    v_accvgpr_read_b32 v231, a60
    v_cvt_pk_bf16_f32 v232, v224, v225
    v_cvt_pk_bf16_f32 v233, v226, v227
    v_cvt_pk_bf16_f32 v234, v228, v229
    v_cvt_pk_bf16_f32 v235, v230, v231
    buffer_store_dwordx4 v[232:235], v5, s[8:11], s26 offen offset:2048 sc1
    v_accvgpr_read_b32 v236, a5
    v_accvgpr_read_b32 v237, a21
    v_accvgpr_read_b32 v238, a37
    v_accvgpr_read_b32 v239, a53
    v_accvgpr_read_b32 v240, a13
    v_accvgpr_read_b32 v241, a29
    v_accvgpr_read_b32 v242, a45
    v_accvgpr_read_b32 v243, a61
    v_cvt_pk_bf16_f32 v244, v236, v237
    v_cvt_pk_bf16_f32 v245, v238, v239
    v_cvt_pk_bf16_f32 v246, v240, v241
    v_cvt_pk_bf16_f32 v247, v242, v243
    buffer_store_dwordx4 v[244:247], v5, s[8:11], s26 offen offset:2304 sc1
    v_accvgpr_read_b32 v224, a6
    v_accvgpr_read_b32 v225, a22
    v_accvgpr_read_b32 v226, a38
    v_accvgpr_read_b32 v227, a54
    v_accvgpr_read_b32 v228, a14
    v_accvgpr_read_b32 v229, a30
    v_accvgpr_read_b32 v230, a46
    v_accvgpr_read_b32 v231, a62
    v_cvt_pk_bf16_f32 v232, v224, v225
    v_cvt_pk_bf16_f32 v233, v226, v227
    v_cvt_pk_bf16_f32 v234, v228, v229
    v_cvt_pk_bf16_f32 v235, v230, v231
    buffer_store_dwordx4 v[232:235], v5, s[8:11], s26 offen offset:2560 sc1
    v_accvgpr_read_b32 v236, a7
    v_accvgpr_read_b32 v237, a23
    v_accvgpr_read_b32 v238, a39
    v_accvgpr_read_b32 v239, a55
    v_accvgpr_read_b32 v240, a15
    v_accvgpr_read_b32 v241, a31
    v_accvgpr_read_b32 v242, a47
    v_accvgpr_read_b32 v243, a63
    v_cvt_pk_bf16_f32 v244, v236, v237
    v_cvt_pk_bf16_f32 v245, v238, v239
    v_cvt_pk_bf16_f32 v246, v240, v241
    v_cvt_pk_bf16_f32 v247, v242, v243
    buffer_store_dwordx4 v[244:247], v5, s[8:11], s26 offen offset:2816 sc1
    s_add_u32 s26, s26, 262144
    v_accvgpr_read_b32 v224, a64
    v_accvgpr_read_b32 v225, a80
    v_accvgpr_read_b32 v226, a96
    v_accvgpr_read_b32 v227, a112
    v_accvgpr_read_b32 v228, a72
    v_accvgpr_read_b32 v229, a88
    v_accvgpr_read_b32 v230, a104
    v_accvgpr_read_b32 v231, a120
    v_cvt_pk_bf16_f32 v232, v224, v225
    v_cvt_pk_bf16_f32 v233, v226, v227
    v_cvt_pk_bf16_f32 v234, v228, v229
    v_cvt_pk_bf16_f32 v235, v230, v231
    buffer_store_dwordx4 v[232:235], v5, s[8:11], s26 offen offset:0 sc1
    v_accvgpr_read_b32 v236, a65
    v_accvgpr_read_b32 v237, a81
    v_accvgpr_read_b32 v238, a97
    v_accvgpr_read_b32 v239, a113
    v_accvgpr_read_b32 v240, a73
    v_accvgpr_read_b32 v241, a89
    v_accvgpr_read_b32 v242, a105
    v_accvgpr_read_b32 v243, a121
    v_cvt_pk_bf16_f32 v244, v236, v237
    v_cvt_pk_bf16_f32 v245, v238, v239
    v_cvt_pk_bf16_f32 v246, v240, v241
    v_cvt_pk_bf16_f32 v247, v242, v243
    buffer_store_dwordx4 v[244:247], v5, s[8:11], s26 offen offset:256 sc1
    v_accvgpr_read_b32 v224, a66
    v_accvgpr_read_b32 v225, a82
    v_accvgpr_read_b32 v226, a98
    v_accvgpr_read_b32 v227, a114
    v_accvgpr_read_b32 v228, a74
    v_accvgpr_read_b32 v229, a90
    v_accvgpr_read_b32 v230, a106
    v_accvgpr_read_b32 v231, a122
    v_cvt_pk_bf16_f32 v232, v224, v225
    v_cvt_pk_bf16_f32 v233, v226, v227
    v_cvt_pk_bf16_f32 v234, v228, v229
    v_cvt_pk_bf16_f32 v235, v230, v231
    buffer_store_dwordx4 v[232:235], v5, s[8:11], s26 offen offset:512 sc1
    v_accvgpr_read_b32 v236, a67
    v_accvgpr_read_b32 v237, a83
    v_accvgpr_read_b32 v238, a99
    v_accvgpr_read_b32 v239, a115
    v_accvgpr_read_b32 v240, a75
    v_accvgpr_read_b32 v241, a91
    v_accvgpr_read_b32 v242, a107
    v_accvgpr_read_b32 v243, a123
    v_cvt_pk_bf16_f32 v244, v236, v237
    v_cvt_pk_bf16_f32 v245, v238, v239
    v_cvt_pk_bf16_f32 v246, v240, v241
    v_cvt_pk_bf16_f32 v247, v242, v243
    buffer_store_dwordx4 v[244:247], v5, s[8:11], s26 offen offset:768 sc1
    v_accvgpr_read_b32 v224, a68
    v_accvgpr_read_b32 v225, a84
    v_accvgpr_read_b32 v226, a100
    v_accvgpr_read_b32 v227, a116
    v_accvgpr_read_b32 v228, a76
    v_accvgpr_read_b32 v229, a92
    v_accvgpr_read_b32 v230, a108
    v_accvgpr_read_b32 v231, a124
    v_cvt_pk_bf16_f32 v232, v224, v225
    v_cvt_pk_bf16_f32 v233, v226, v227
    v_cvt_pk_bf16_f32 v234, v228, v229
    v_cvt_pk_bf16_f32 v235, v230, v231
    buffer_store_dwordx4 v[232:235], v5, s[8:11], s26 offen offset:2048 sc1
    v_accvgpr_read_b32 v236, a69
    v_accvgpr_read_b32 v237, a85
    v_accvgpr_read_b32 v238, a101
    v_accvgpr_read_b32 v239, a117
    v_accvgpr_read_b32 v240, a77
    v_accvgpr_read_b32 v241, a93
    v_accvgpr_read_b32 v242, a109
    v_accvgpr_read_b32 v243, a125
    v_cvt_pk_bf16_f32 v244, v236, v237
    v_cvt_pk_bf16_f32 v245, v238, v239
    v_cvt_pk_bf16_f32 v246, v240, v241
    v_cvt_pk_bf16_f32 v247, v242, v243
    buffer_store_dwordx4 v[244:247], v5, s[8:11], s26 offen offset:2304 sc1
    v_accvgpr_read_b32 v224, a70
    v_accvgpr_read_b32 v225, a86
    v_accvgpr_read_b32 v226, a102
    v_accvgpr_read_b32 v227, a118
    v_accvgpr_read_b32 v228, a78
    v_accvgpr_read_b32 v229, a94
    v_accvgpr_read_b32 v230, a110
    v_accvgpr_read_b32 v231, a126
    v_cvt_pk_bf16_f32 v232, v224, v225
    v_cvt_pk_bf16_f32 v233, v226, v227
    v_cvt_pk_bf16_f32 v234, v228, v229
    v_cvt_pk_bf16_f32 v235, v230, v231
    buffer_store_dwordx4 v[232:235], v5, s[8:11], s26 offen offset:2560 sc1
    v_accvgpr_read_b32 v236, a71
    v_accvgpr_read_b32 v237, a87
    v_accvgpr_read_b32 v238, a103
    v_accvgpr_read_b32 v239, a119
    v_accvgpr_read_b32 v240, a79
    v_accvgpr_read_b32 v241, a95
    v_accvgpr_read_b32 v242, a111
    v_accvgpr_read_b32 v243, a127
    v_cvt_pk_bf16_f32 v244, v236, v237
    v_cvt_pk_bf16_f32 v245, v238, v239
    v_cvt_pk_bf16_f32 v246, v240, v241
    v_cvt_pk_bf16_f32 v247, v242, v243
    buffer_store_dwordx4 v[244:247], v5, s[8:11], s26 offen offset:2816 sc1
    s_add_u32 s26, s26, 262144
    s_cmp_eq_u32 s52, 2
    s_cbranch_scc1 L_w_fin
    v_accvgpr_read_b32 v224, a128
    v_accvgpr_read_b32 v225, a144
    v_accvgpr_read_b32 v226, a160
    v_accvgpr_read_b32 v227, a176
    v_accvgpr_read_b32 v228, a136
    v_accvgpr_read_b32 v229, a152
    v_accvgpr_read_b32 v230, a168
    v_accvgpr_read_b32 v231, a184
    v_cvt_pk_bf16_f32 v232, v224, v225
    v_cvt_pk_bf16_f32 v233, v226, v227
    v_cvt_pk_bf16_f32 v234, v228, v229
    v_cvt_pk_bf16_f32 v235, v230, v231
    buffer_store_dwordx4 v[232:235], v5, s[8:11], s26 offen offset:0 sc1
    v_accvgpr_read_b32 v236, a129
    v_accvgpr_read_b32 v237, a145
    v_accvgpr_read_b32 v238, a161
    v_accvgpr_read_b32 v239, a177
    v_accvgpr_read_b32 v240, a137
    v_accvgpr_read_b32 v241, a153
    v_accvgpr_read_b32 v242, a169
    v_accvgpr_read_b32 v243, a185
    v_cvt_pk_bf16_f32 v244, v236, v237
    v_cvt_pk_bf16_f32 v245, v238, v239
    v_cvt_pk_bf16_f32 v246, v240, v241
    v_cvt_pk_bf16_f32 v247, v242, v243
    buffer_store_dwordx4 v[244:247], v5, s[8:11], s26 offen offset:256 sc1
    v_accvgpr_read_b32 v224, a130
    v_accvgpr_read_b32 v225, a146
    v_accvgpr_read_b32 v226, a162
    v_accvgpr_read_b32 v227, a178
    v_accvgpr_read_b32 v228, a138
    v_accvgpr_read_b32 v229, a154
    v_accvgpr_read_b32 v230, a170
    v_accvgpr_read_b32 v231, a186
    v_cvt_pk_bf16_f32 v232, v224, v225
    v_cvt_pk_bf16_f32 v233, v226, v227
    v_cvt_pk_bf16_f32 v234, v228, v229
    v_cvt_pk_bf16_f32 v235, v230, v231
    buffer_store_dwordx4 v[232:235], v5, s[8:11], s26 offen offset:512 sc1
    v_accvgpr_read_b32 v236, a131
    v_accvgpr_read_b32 v237, a147
    v_accvgpr_read_b32 v238, a163
    v_accvgpr_read_b32 v239, a179
    v_accvgpr_read_b32 v240, a139
    v_accvgpr_read_b32 v241, a155
    v_accvgpr_read_b32 v242, a171
    v_accvgpr_read_b32 v243, a187
    v_cvt_pk_bf16_f32 v244, v236, v237
    v_cvt_pk_bf16_f32 v245, v238, v239
    v_cvt_pk_bf16_f32 v246, v240, v241
    v_cvt_pk_bf16_f32 v247, v242, v243
    buffer_store_dwordx4 v[244:247], v5, s[8:11], s26 offen offset:768 sc1
    v_accvgpr_read_b32 v224, a132
    v_accvgpr_read_b32 v225, a148
    v_accvgpr_read_b32 v226, a164
    v_accvgpr_read_b32 v227, a180
    v_accvgpr_read_b32 v228, a140
    v_accvgpr_read_b32 v229, a156
    v_accvgpr_read_b32 v230, a172
    v_accvgpr_read_b32 v231, a188
    v_cvt_pk_bf16_f32 v232, v224, v225
    v_cvt_pk_bf16_f32 v233, v226, v227
    v_cvt_pk_bf16_f32 v234, v228, v229
    v_cvt_pk_bf16_f32 v235, v230, v231
    buffer_store_dwordx4 v[232:235], v5, s[8:11], s26 offen offset:2048 sc1
    v_accvgpr_read_b32 v236, a133
    v_accvgpr_read_b32 v237, a149
    v_accvgpr_read_b32 v238, a165
    v_accvgpr_read_b32 v239, a181
    v_accvgpr_read_b32 v240, a141
    v_accvgpr_read_b32 v241, a157
    v_accvgpr_read_b32 v242, a173
    v_accvgpr_read_b32 v243, a189
    v_cvt_pk_bf16_f32 v244, v236, v237
    v_cvt_pk_bf16_f32 v245, v238, v239
    v_cvt_pk_bf16_f32 v246, v240, v241
    v_cvt_pk_bf16_f32 v247, v242, v243
    buffer_store_dwordx4 v[244:247], v5, s[8:11], s26 offen offset:2304 sc1
    v_accvgpr_read_b32 v224, a134
    v_accvgpr_read_b32 v225, a150
    v_accvgpr_read_b32 v226, a166
    v_accvgpr_read_b32 v227, a182
    v_accvgpr_read_b32 v228, a142
    v_accvgpr_read_b32 v229, a158
    v_accvgpr_read_b32 v230, a174
    v_accvgpr_read_b32 v231, a190
    v_cvt_pk_bf16_f32 v232, v224, v225
    v_cvt_pk_bf16_f32 v233, v226, v227
    v_cvt_pk_bf16_f32 v234, v228, v229
    v_cvt_pk_bf16_f32 v235, v230, v231
    buffer_store_dwordx4 v[232:235], v5, s[8:11], s26 offen offset:2560 sc1
    v_accvgpr_read_b32 v236, a135
    v_accvgpr_read_b32 v237, a151
    v_accvgpr_read_b32 v238, a167
    v_accvgpr_read_b32 v239, a183
    v_accvgpr_read_b32 v240, a143
    v_accvgpr_read_b32 v241, a159
    v_accvgpr_read_b32 v242, a175
    v_accvgpr_read_b32 v243, a191
    v_cvt_pk_bf16_f32 v244, v236, v237
    v_cvt_pk_bf16_f32 v245, v238, v239
    v_cvt_pk_bf16_f32 v246, v240, v241
    v_cvt_pk_bf16_f32 v247, v242, v243
    buffer_store_dwordx4 v[244:247], v5, s[8:11], s26 offen offset:2816 sc1
    s_add_u32 s26, s26, 262144
    v_accvgpr_read_b32 v224, a192
    v_accvgpr_read_b32 v225, a208
    v_accvgpr_read_b32 v226, a224
    v_accvgpr_read_b32 v227, a240
    v_accvgpr_read_b32 v228, a200
    v_accvgpr_read_b32 v229, a216
    v_accvgpr_read_b32 v230, a232
    v_accvgpr_read_b32 v231, a248
    v_cvt_pk_bf16_f32 v232, v224, v225
    v_cvt_pk_bf16_f32 v233, v226, v227
    v_cvt_pk_bf16_f32 v234, v228, v229
    v_cvt_pk_bf16_f32 v235, v230, v231
    buffer_store_dwordx4 v[232:235], v5, s[8:11], s26 offen offset:0 sc1
    v_accvgpr_read_b32 v236, a193
    v_accvgpr_read_b32 v237, a209
    v_accvgpr_read_b32 v238, a225
    v_accvgpr_read_b32 v239, a241
    v_accvgpr_read_b32 v240, a201
    v_accvgpr_read_b32 v241, a217
    v_accvgpr_read_b32 v242, a233
    v_accvgpr_read_b32 v243, a249
    v_cvt_pk_bf16_f32 v244, v236, v237
    v_cvt_pk_bf16_f32 v245, v238, v239
    v_cvt_pk_bf16_f32 v246, v240, v241
    v_cvt_pk_bf16_f32 v247, v242, v243
    buffer_store_dwordx4 v[244:247], v5, s[8:11], s26 offen offset:256 sc1
    v_accvgpr_read_b32 v224, a194
    v_accvgpr_read_b32 v225, a210
    v_accvgpr_read_b32 v226, a226
    v_accvgpr_read_b32 v227, a242
    v_accvgpr_read_b32 v228, a202
    v_accvgpr_read_b32 v229, a218
    v_accvgpr_read_b32 v230, a234
    v_accvgpr_read_b32 v231, a250
    v_cvt_pk_bf16_f32 v232, v224, v225
    v_cvt_pk_bf16_f32 v233, v226, v227
    v_cvt_pk_bf16_f32 v234, v228, v229
    v_cvt_pk_bf16_f32 v235, v230, v231
    buffer_store_dwordx4 v[232:235], v5, s[8:11], s26 offen offset:512 sc1
    v_accvgpr_read_b32 v236, a195
    v_accvgpr_read_b32 v237, a211
    v_accvgpr_read_b32 v238, a227
    v_accvgpr_read_b32 v239, a243
    v_accvgpr_read_b32 v240, a203
    v_accvgpr_read_b32 v241, a219
    v_accvgpr_read_b32 v242, a235
    v_accvgpr_read_b32 v243, a251
    v_cvt_pk_bf16_f32 v244, v236, v237
    v_cvt_pk_bf16_f32 v245, v238, v239
    v_cvt_pk_bf16_f32 v246, v240, v241
    v_cvt_pk_bf16_f32 v247, v242, v243
    buffer_store_dwordx4 v[244:247], v5, s[8:11], s26 offen offset:768 sc1
    v_accvgpr_read_b32 v224, a196
    v_accvgpr_read_b32 v225, a212
    v_accvgpr_read_b32 v226, a228
    v_accvgpr_read_b32 v227, a244
    v_accvgpr_read_b32 v228, a204
    v_accvgpr_read_b32 v229, a220
    v_accvgpr_read_b32 v230, a236
    v_accvgpr_read_b32 v231, a252
    v_cvt_pk_bf16_f32 v232, v224, v225
    v_cvt_pk_bf16_f32 v233, v226, v227
    v_cvt_pk_bf16_f32 v234, v228, v229
    v_cvt_pk_bf16_f32 v235, v230, v231
    buffer_store_dwordx4 v[232:235], v5, s[8:11], s26 offen offset:2048 sc1
    v_accvgpr_read_b32 v236, a197
    v_accvgpr_read_b32 v237, a213
    v_accvgpr_read_b32 v238, a229
    v_accvgpr_read_b32 v239, a245
    v_accvgpr_read_b32 v240, a205
    v_accvgpr_read_b32 v241, a221
    v_accvgpr_read_b32 v242, a237
    v_accvgpr_read_b32 v243, a253
    v_cvt_pk_bf16_f32 v244, v236, v237
    v_cvt_pk_bf16_f32 v245, v238, v239
    v_cvt_pk_bf16_f32 v246, v240, v241
    v_cvt_pk_bf16_f32 v247, v242, v243
    buffer_store_dwordx4 v[244:247], v5, s[8:11], s26 offen offset:2304 sc1
    v_accvgpr_read_b32 v224, a198
    v_accvgpr_read_b32 v225, a214
    v_accvgpr_read_b32 v226, a230
    v_accvgpr_read_b32 v227, a246
    v_accvgpr_read_b32 v228, a206
    v_accvgpr_read_b32 v229, a222
    v_accvgpr_read_b32 v230, a238
    v_accvgpr_read_b32 v231, a254
    v_cvt_pk_bf16_f32 v232, v224, v225
    v_cvt_pk_bf16_f32 v233, v226, v227
    v_cvt_pk_bf16_f32 v234, v228, v229
    v_cvt_pk_bf16_f32 v235, v230, v231
    buffer_store_dwordx4 v[232:235], v5, s[8:11], s26 offen offset:2560 sc1
    v_accvgpr_read_b32 v236, a199
    v_accvgpr_read_b32 v237, a215
    v_accvgpr_read_b32 v238, a231
    v_accvgpr_read_b32 v239, a247
    v_accvgpr_read_b32 v240, a207
    v_accvgpr_read_b32 v241, a223
    v_accvgpr_read_b32 v242, a239
    v_accvgpr_read_b32 v243, a255
    v_cvt_pk_bf16_f32 v244, v236, v237
    v_cvt_pk_bf16_f32 v245, v238, v239
    v_cvt_pk_bf16_f32 v246, v240, v241
    v_cvt_pk_bf16_f32 v247, v242, v243
    buffer_store_dwordx4 v[244:247], v5, s[8:11], s26 offen offset:2816 sc1
    s_add_u32 s26, s26, 262144
    s_branch L_w_fin
L_w_v:
    s_mov_b32 s16, s40
    s_and_b32 s17, s41, 0xffff
    s_mov_b32 s18, 4194304
    s_mov_b32 s19, 0x00020000
    s_add_u32 s26, s26, 33554432
    v_add_u32 v8, 0, v13
    v_add_u32 v9, 33792, v13
    v_add_u32 v10, 67584, v13
    v_add_u32 v11, 101376, v13
    s_cmp_eq_u32 s52, 2
    s_cbranch_scc1 L_w_v2
    buffer_load_dwordx4 v[24:27], v16, s[16:19], s22 offen
    buffer_load_dwordx4 v[28:31], v17, s[16:19], s22 offen
    buffer_load_dwordx4 v[32:35], v18, s[16:19], s22 offen
    buffer_load_dwordx4 v[36:39], v19, s[16:19], s22 offen
    s_add_u32 s22, s22, 131072
    buffer_load_dwordx4 v[40:43], v16, s[16:19], s22 offen
    buffer_load_dwordx4 v[44:47], v17, s[16:19], s22 offen
    buffer_load_dwordx4 v[48:51], v18, s[16:19], s22 offen
    buffer_load_dwordx4 v[52:55], v19, s[16:19], s22 offen
    s_add_u32 s22, s22, 131072
    buffer_load_dwordx4 v[56:59], v16, s[16:19], s22 offen
    buffer_load_dwordx4 v[60:63], v17, s[16:19], s22 offen
    buffer_load_dwordx4 v[64:67], v18, s[16:19], s22 offen
    buffer_load_dwordx4 v[68:71], v19, s[16:19], s22 offen
    s_add_u32 s22, s22, 131072
    buffer_load_dwordx4 v[72:75], v16, s[16:19], s22 offen
    buffer_load_dwordx4 v[76:79], v17, s[16:19], s22 offen
    buffer_load_dwordx4 v[80:83], v18, s[16:19], s22 offen
    buffer_load_dwordx4 v[84:87], v19, s[16:19], s22 offen
    s_add_u32 s22, s22, 131072
    ds_read_b128 v[120:123], v8 offset:0
    ds_read_b128 v[124:127], v9 offset:0
    ds_read_b128 v[128:131], v10 offset:0
    ds_read_b128 v[132:135], v11 offset:0
    s_waitcnt vmcnt(12)
    v_permlane16_swap_b32 v24, v26
    v_permlane16_swap_b32 v25, v27
    v_permlane16_swap_b32 v28, v30
    v_permlane16_swap_b32 v29, v31
    v_permlane16_swap_b32 v32, v34
    v_permlane16_swap_b32 v33, v35
    v_permlane16_swap_b32 v36, v38
    v_permlane16_swap_b32 v37, v39
    v_perm_b32 v88, v26, v24, s23
    v_perm_b32 v89, v30, v28, s23
    v_perm_b32 v90, v34, v32, s23
    v_perm_b32 v91, v38, v36, s23
    v_perm_b32 v92, v26, v24, s24
    v_perm_b32 v93, v30, v28, s24
    v_perm_b32 v94, v34, v32, s24
    v_perm_b32 v95, v38, v36, s24
    v_perm_b32 v96, v27, v25, s23
    v_perm_b32 v97, v31, v29, s23
    v_perm_b32 v98, v35, v33, s23
    v_perm_b32 v99, v39, v37, s23
    v_perm_b32 v100, v27, v25, s24
    v_perm_b32 v101, v31, v29, s24
    v_perm_b32 v102, v35, v33, s24
    v_perm_b32 v103, v39, v37, s24
    s_waitcnt lgkmcnt(0)
    v_mfma_f32_32x32x16_bf16 a[0:15], v[120:123], v[88:91], 0
    ds_read_b128 v[136:139], v8 offset:1056
    ds_read_b128 v[140:143], v9 offset:1056
    ds_read_b128 v[144:147], v10 offset:1056
    v_mfma_f32_32x32x16_bf16 a[64:79], v[124:127], v[88:91], 0
    ds_read_b128 v[148:151], v11 offset:1056
    buffer_load_dwordx4 v[24:27], v16, s[16:19], s22 offen
    buffer_load_dwordx4 v[28:31], v17, s[16:19], s22 offen
    v_mfma_f32_32x32x16_bf16 a[128:143], v[128:131], v[88:91], 0
    buffer_load_dwordx4 v[32:35], v18, s[16:19], s22 offen
    buffer_load_dwordx4 v[36:39], v19, s[16:19], s22 offen
    s_add_u32 s22, s22, 131072
    v_mfma_f32_32x32x16_bf16 a[192:207], v[132:135], v[88:91], 0
    s_waitcnt vmcnt(12)
    v_permlane16_swap_b32 v40, v42
    v_permlane16_swap_b32 v41, v43
    v_mfma_f32_32x32x16_bf16 a[16:31], v[120:123], v[92:95], 0
    v_permlane16_swap_b32 v44, v46
    v_permlane16_swap_b32 v45, v47
    v_permlane16_swap_b32 v48, v50
    v_mfma_f32_32x32x16_bf16 a[80:95], v[124:127], v[92:95], 0
    v_permlane16_swap_b32 v49, v51
    v_permlane16_swap_b32 v52, v54
    v_permlane16_swap_b32 v53, v55
    v_mfma_f32_32x32x16_bf16 a[144:159], v[128:131], v[92:95], 0
    v_perm_b32 v104, v42, v40, s23
    v_perm_b32 v105, v46, v44, s23
    v_perm_b32 v106, v50, v48, s23
    v_mfma_f32_32x32x16_bf16 a[208:223], v[132:135], v[92:95], 0
    v_perm_b32 v107, v54, v52, s23
    v_perm_b32 v108, v42, v40, s24
    v_perm_b32 v109, v46, v44, s24
    v_mfma_f32_32x32x16_bf16 a[32:47], v[120:123], v[96:99], 0
    v_perm_b32 v110, v50, v48, s24
    v_perm_b32 v111, v54, v52, s24
    v_perm_b32 v112, v43, v41, s23
    v_mfma_f32_32x32x16_bf16 a[96:111], v[124:127], v[96:99], 0
    v_perm_b32 v113, v47, v45, s23
    v_perm_b32 v114, v51, v49, s23
    v_perm_b32 v115, v55, v53, s23
    v_mfma_f32_32x32x16_bf16 a[160:175], v[128:131], v[96:99], 0
    v_perm_b32 v116, v43, v41, s24
    v_perm_b32 v117, v47, v45, s24
    v_perm_b32 v118, v51, v49, s24
    v_mfma_f32_32x32x16_bf16 a[224:239], v[132:135], v[96:99], 0
    v_perm_b32 v119, v55, v53, s24
    s_waitcnt lgkmcnt(0)
    v_mfma_f32_32x32x16_bf16 a[48:63], v[120:123], v[100:103], 0
    v_mfma_f32_32x32x16_bf16 a[112:127], v[124:127], v[100:103], 0
    v_mfma_f32_32x32x16_bf16 a[176:191], v[128:131], v[100:103], 0
    v_mfma_f32_32x32x16_bf16 a[240:255], v[132:135], v[100:103], 0
    s_nop 0
    v_mfma_f32_32x32x16_bf16 a[0:15], v[136:139], v[104:107], a[0:15]
    ds_read_b128 v[120:123], v8 offset:2112
    ds_read_b128 v[124:127], v9 offset:2112
    ds_read_b128 v[128:131], v10 offset:2112
    v_mfma_f32_32x32x16_bf16 a[64:79], v[140:143], v[104:107], a[64:79]
    ds_read_b128 v[132:135], v11 offset:2112
    buffer_load_dwordx4 v[40:43], v16, s[16:19], s22 offen
    buffer_load_dwordx4 v[44:47], v17, s[16:19], s22 offen
    v_mfma_f32_32x32x16_bf16 a[128:143], v[144:147], v[104:107], a[128:143]
    buffer_load_dwordx4 v[48:51], v18, s[16:19], s22 offen
    buffer_load_dwordx4 v[52:55], v19, s[16:19], s22 offen
    s_add_u32 s22, s22, 131072
    v_mfma_f32_32x32x16_bf16 a[192:207], v[148:151], v[104:107], a[192:207]
    s_waitcnt vmcnt(12)
    v_permlane16_swap_b32 v56, v58
    v_permlane16_swap_b32 v57, v59
    v_mfma_f32_32x32x16_bf16 a[16:31], v[136:139], v[108:111], a[16:31]
    v_permlane16_swap_b32 v60, v62
    v_permlane16_swap_b32 v61, v63
    v_permlane16_swap_b32 v64, v66
    v_mfma_f32_32x32x16_bf16 a[80:95], v[140:143], v[108:111], a[80:95]
    v_permlane16_swap_b32 v65, v67
    v_permlane16_swap_b32 v68, v70
    v_permlane16_swap_b32 v69, v71
    v_mfma_f32_32x32x16_bf16 a[144:159], v[144:147], v[108:111], a[144:159]
    v_perm_b32 v88, v58, v56, s23
    v_perm_b32 v89, v62, v60, s23
    v_perm_b32 v90, v66, v64, s23
    v_mfma_f32_32x32x16_bf16 a[208:223], v[148:151], v[108:111], a[208:223]
    v_perm_b32 v91, v70, v68, s23
    v_perm_b32 v92, v58, v56, s24
    v_perm_b32 v93, v62, v60, s24
    v_mfma_f32_32x32x16_bf16 a[32:47], v[136:139], v[112:115], a[32:47]
    v_perm_b32 v94, v66, v64, s24
    v_perm_b32 v95, v70, v68, s24
    v_perm_b32 v96, v59, v57, s23
    v_mfma_f32_32x32x16_bf16 a[96:111], v[140:143], v[112:115], a[96:111]
    v_perm_b32 v97, v63, v61, s23
    v_perm_b32 v98, v67, v65, s23
    v_perm_b32 v99, v71, v69, s23
    v_mfma_f32_32x32x16_bf16 a[160:175], v[144:147], v[112:115], a[160:175]
    v_perm_b32 v100, v59, v57, s24
    v_perm_b32 v101, v63, v61, s24
    v_perm_b32 v102, v67, v65, s24
    v_mfma_f32_32x32x16_bf16 a[224:239], v[148:151], v[112:115], a[224:239]
    v_perm_b32 v103, v71, v69, s24
    s_waitcnt lgkmcnt(0)
    v_mfma_f32_32x32x16_bf16 a[48:63], v[136:139], v[116:119], a[48:63]
    v_mfma_f32_32x32x16_bf16 a[112:127], v[140:143], v[116:119], a[112:127]
    v_mfma_f32_32x32x16_bf16 a[176:191], v[144:147], v[116:119], a[176:191]
    v_mfma_f32_32x32x16_bf16 a[240:255], v[148:151], v[116:119], a[240:255]
    s_nop 0
    v_mfma_f32_32x32x16_bf16 a[0:15], v[120:123], v[88:91], a[0:15]
    ds_read_b128 v[136:139], v8 offset:3168
    ds_read_b128 v[140:143], v9 offset:3168
    ds_read_b128 v[144:147], v10 offset:3168
    v_mfma_f32_32x32x16_bf16 a[64:79], v[124:127], v[88:91], a[64:79]
    ds_read_b128 v[148:151], v11 offset:3168
    buffer_load_dwordx4 v[56:59], v16, s[16:19], s22 offen
    buffer_load_dwordx4 v[60:63], v17, s[16:19], s22 offen
    v_mfma_f32_32x32x16_bf16 a[128:143], v[128:131], v[88:91], a[128:143]
    buffer_load_dwordx4 v[64:67], v18, s[16:19], s22 offen
    buffer_load_dwordx4 v[68:71], v19, s[16:19], s22 offen
    s_add_u32 s22, s22, 131072
    v_mfma_f32_32x32x16_bf16 a[192:207], v[132:135], v[88:91], a[192:207]
    s_waitcnt vmcnt(12)
    v_permlane16_swap_b32 v72, v74
    v_permlane16_swap_b32 v73, v75
    v_mfma_f32_32x32x16_bf16 a[16:31], v[120:123], v[92:95], a[16:31]
    v_permlane16_swap_b32 v76, v78
    v_permlane16_swap_b32 v77, v79
    v_permlane16_swap_b32 v80, v82
    v_mfma_f32_32x32x16_bf16 a[80:95], v[124:127], v[92:95], a[80:95]
    v_permlane16_swap_b32 v81, v83
    v_permlane16_swap_b32 v84, v86
    v_permlane16_swap_b32 v85, v87
    v_mfma_f32_32x32x16_bf16 a[144:159], v[128:131], v[92:95], a[144:159]
    v_perm_b32 v104, v74, v72, s23
    v_perm_b32 v105, v78, v76, s23
    v_perm_b32 v106, v82, v80, s23
    v_mfma_f32_32x32x16_bf16 a[208:223], v[132:135], v[92:95], a[208:223]
    v_perm_b32 v107, v86, v84, s23
    v_perm_b32 v108, v74, v72, s24
    v_perm_b32 v109, v78, v76, s24
    v_mfma_f32_32x32x16_bf16 a[32:47], v[120:123], v[96:99], a[32:47]
    v_perm_b32 v110, v82, v80, s24
    v_perm_b32 v111, v86, v84, s24
    v_perm_b32 v112, v75, v73, s23
    v_mfma_f32_32x32x16_bf16 a[96:111], v[124:127], v[96:99], a[96:111]
    v_perm_b32 v113, v79, v77, s23
    v_perm_b32 v114, v83, v81, s23
    v_perm_b32 v115, v87, v85, s23
    v_mfma_f32_32x32x16_bf16 a[160:175], v[128:131], v[96:99], a[160:175]
    v_perm_b32 v116, v75, v73, s24
    v_perm_b32 v117, v79, v77, s24
    v_perm_b32 v118, v83, v81, s24
    v_mfma_f32_32x32x16_bf16 a[224:239], v[132:135], v[96:99], a[224:239]
    v_perm_b32 v119, v87, v85, s24
    s_waitcnt lgkmcnt(0)
    v_mfma_f32_32x32x16_bf16 a[48:63], v[120:123], v[100:103], a[48:63]
    v_mfma_f32_32x32x16_bf16 a[112:127], v[124:127], v[100:103], a[112:127]
    v_mfma_f32_32x32x16_bf16 a[176:191], v[128:131], v[100:103], a[176:191]
    v_mfma_f32_32x32x16_bf16 a[240:255], v[132:135], v[100:103], a[240:255]
    s_nop 0
    v_mfma_f32_32x32x16_bf16 a[0:15], v[136:139], v[104:107], a[0:15]
    ds_read_b128 v[120:123], v8 offset:4224
    ds_read_b128 v[124:127], v9 offset:4224
    ds_read_b128 v[128:131], v10 offset:4224
    v_mfma_f32_32x32x16_bf16 a[64:79], v[140:143], v[104:107], a[64:79]
    ds_read_b128 v[132:135], v11 offset:4224
    buffer_load_dwordx4 v[72:75], v16, s[16:19], s22 offen
    buffer_load_dwordx4 v[76:79], v17, s[16:19], s22 offen
    v_mfma_f32_32x32x16_bf16 a[128:143], v[144:147], v[104:107], a[128:143]
    buffer_load_dwordx4 v[80:83], v18, s[16:19], s22 offen
    buffer_load_dwordx4 v[84:87], v19, s[16:19], s22 offen
    s_add_u32 s22, s22, 131072
    v_mfma_f32_32x32x16_bf16 a[192:207], v[148:151], v[104:107], a[192:207]
    s_waitcnt vmcnt(12)
    v_permlane16_swap_b32 v24, v26
    v_permlane16_swap_b32 v25, v27
    v_mfma_f32_32x32x16_bf16 a[16:31], v[136:139], v[108:111], a[16:31]
    v_permlane16_swap_b32 v28, v30
    v_permlane16_swap_b32 v29, v31
    v_permlane16_swap_b32 v32, v34
    v_mfma_f32_32x32x16_bf16 a[80:95], v[140:143], v[108:111], a[80:95]
    v_permlane16_swap_b32 v33, v35
    v_permlane16_swap_b32 v36, v38
    v_permlane16_swap_b32 v37, v39
    v_mfma_f32_32x32x16_bf16 a[144:159], v[144:147], v[108:111], a[144:159]
    v_perm_b32 v88, v26, v24, s23
    v_perm_b32 v89, v30, v28, s23
    v_perm_b32 v90, v34, v32, s23
    v_mfma_f32_32x32x16_bf16 a[208:223], v[148:151], v[108:111], a[208:223]
    v_perm_b32 v91, v38, v36, s23
    v_perm_b32 v92, v26, v24, s24
    v_perm_b32 v93, v30, v28, s24
    v_mfma_f32_32x32x16_bf16 a[32:47], v[136:139], v[112:115], a[32:47]
    v_perm_b32 v94, v34, v32, s24
    v_perm_b32 v95, v38, v36, s24
    v_perm_b32 v96, v27, v25, s23
    v_mfma_f32_32x32x16_bf16 a[96:111], v[140:143], v[112:115], a[96:111]
    v_perm_b32 v97, v31, v29, s23
    v_perm_b32 v98, v35, v33, s23
    v_perm_b32 v99, v39, v37, s23
    v_mfma_f32_32x32x16_bf16 a[160:175], v[144:147], v[112:115], a[160:175]
    v_perm_b32 v100, v27, v25, s24
    v_perm_b32 v101, v31, v29, s24
    v_perm_b32 v102, v35, v33, s24
    v_mfma_f32_32x32x16_bf16 a[224:239], v[148:151], v[112:115], a[224:239]
    v_perm_b32 v103, v39, v37, s24
    s_waitcnt lgkmcnt(0)
    v_mfma_f32_32x32x16_bf16 a[48:63], v[136:139], v[116:119], a[48:63]
    v_mfma_f32_32x32x16_bf16 a[112:127], v[140:143], v[116:119], a[112:127]
    v_mfma_f32_32x32x16_bf16 a[176:191], v[144:147], v[116:119], a[176:191]
    v_mfma_f32_32x32x16_bf16 a[240:255], v[148:151], v[116:119], a[240:255]
    s_nop 0
    s_mov_b32 s21, 7
L_gv_11:
    v_add_u32 v8, 4224, v8
    v_add_u32 v9, 4224, v9
    v_add_u32 v10, 4224, v10
    v_add_u32 v11, 4224, v11
    v_mfma_f32_32x32x16_bf16 a[0:15], v[120:123], v[88:91], a[0:15]
    ds_read_b128 v[136:139], v8 offset:1056
    ds_read_b128 v[140:143], v9 offset:1056
    ds_read_b128 v[144:147], v10 offset:1056
    v_mfma_f32_32x32x16_bf16 a[64:79], v[124:127], v[88:91], a[64:79]
    ds_read_b128 v[148:151], v11 offset:1056
    buffer_load_dwordx4 v[24:27], v16, s[16:19], s22 offen
    buffer_load_dwordx4 v[28:31], v17, s[16:19], s22 offen
    v_mfma_f32_32x32x16_bf16 a[128:143], v[128:131], v[88:91], a[128:143]
    buffer_load_dwordx4 v[32:35], v18, s[16:19], s22 offen
    buffer_load_dwordx4 v[36:39], v19, s[16:19], s22 offen
    s_add_u32 s22, s22, 131072
    v_mfma_f32_32x32x16_bf16 a[192:207], v[132:135], v[88:91], a[192:207]
    s_waitcnt vmcnt(12)
    v_permlane16_swap_b32 v40, v42
    v_permlane16_swap_b32 v41, v43
    v_mfma_f32_32x32x16_bf16 a[16:31], v[120:123], v[92:95], a[16:31]
    v_permlane16_swap_b32 v44, v46
    v_permlane16_swap_b32 v45, v47
    v_permlane16_swap_b32 v48, v50
    v_mfma_f32_32x32x16_bf16 a[80:95], v[124:127], v[92:95], a[80:95]
    v_permlane16_swap_b32 v49, v51
    v_permlane16_swap_b32 v52, v54
    v_permlane16_swap_b32 v53, v55
    v_mfma_f32_32x32x16_bf16 a[144:159], v[128:131], v[92:95], a[144:159]
    v_perm_b32 v104, v42, v40, s23
    v_perm_b32 v105, v46, v44, s23
    v_perm_b32 v106, v50, v48, s23
    v_mfma_f32_32x32x16_bf16 a[208:223], v[132:135], v[92:95], a[208:223]
    v_perm_b32 v107, v54, v52, s23
    v_perm_b32 v108, v42, v40, s24
    v_perm_b32 v109, v46, v44, s24
    v_mfma_f32_32x32x16_bf16 a[32:47], v[120:123], v[96:99], a[32:47]
    v_perm_b32 v110, v50, v48, s24
    v_perm_b32 v111, v54, v52, s24
    v_perm_b32 v112, v43, v41, s23
    v_mfma_f32_32x32x16_bf16 a[96:111], v[124:127], v[96:99], a[96:111]
    v_perm_b32 v113, v47, v45, s23
    v_perm_b32 v114, v51, v49, s23
    v_perm_b32 v115, v55, v53, s23
    v_mfma_f32_32x32x16_bf16 a[160:175], v[128:131], v[96:99], a[160:175]
    v_perm_b32 v116, v43, v41, s24
    v_perm_b32 v117, v47, v45, s24
    v_perm_b32 v118, v51, v49, s24
    v_mfma_f32_32x32x16_bf16 a[224:239], v[132:135], v[96:99], a[224:239]
    v_perm_b32 v119, v55, v53, s24
    s_waitcnt lgkmcnt(0)
    v_mfma_f32_32x32x16_bf16 a[48:63], v[120:123], v[100:103], a[48:63]
    v_mfma_f32_32x32x16_bf16 a[112:127], v[124:127], v[100:103], a[112:127]
    v_mfma_f32_32x32x16_bf16 a[176:191], v[128:131], v[100:103], a[176:191]
    v_mfma_f32_32x32x16_bf16 a[240:255], v[132:135], v[100:103], a[240:255]
    s_nop 0
    v_mfma_f32_32x32x16_bf16 a[0:15], v[136:139], v[104:107], a[0:15]
    ds_read_b128 v[120:123], v8 offset:2112
    ds_read_b128 v[124:127], v9 offset:2112
    ds_read_b128 v[128:131], v10 offset:2112
    v_mfma_f32_32x32x16_bf16 a[64:79], v[140:143], v[104:107], a[64:79]
    ds_read_b128 v[132:135], v11 offset:2112
    buffer_load_dwordx4 v[40:43], v16, s[16:19], s22 offen
    buffer_load_dwordx4 v[44:47], v17, s[16:19], s22 offen
    v_mfma_f32_32x32x16_bf16 a[128:143], v[144:147], v[104:107], a[128:143]
    buffer_load_dwordx4 v[48:51], v18, s[16:19], s22 offen
    buffer_load_dwordx4 v[52:55], v19, s[16:19], s22 offen
    s_add_u32 s22, s22, 131072
    v_mfma_f32_32x32x16_bf16 a[192:207], v[148:151], v[104:107], a[192:207]
    s_waitcnt vmcnt(12)
    v_permlane16_swap_b32 v56, v58
    v_permlane16_swap_b32 v57, v59
    v_mfma_f32_32x32x16_bf16 a[16:31], v[136:139], v[108:111], a[16:31]
    v_permlane16_swap_b32 v60, v62
    v_permlane16_swap_b32 v61, v63
    v_permlane16_swap_b32 v64, v66
    v_mfma_f32_32x32x16_bf16 a[80:95], v[140:143], v[108:111], a[80:95]
    v_permlane16_swap_b32 v65, v67
    v_permlane16_swap_b32 v68, v70
    v_permlane16_swap_b32 v69, v71
    v_mfma_f32_32x32x16_bf16 a[144:159], v[144:147], v[108:111], a[144:159]
    v_perm_b32 v88, v58, v56, s23
    v_perm_b32 v89, v62, v60, s23
    v_perm_b32 v90, v66, v64, s23
    v_mfma_f32_32x32x16_bf16 a[208:223], v[148:151], v[108:111], a[208:223]
    v_perm_b32 v91, v70, v68, s23
    v_perm_b32 v92, v58, v56, s24
    v_perm_b32 v93, v62, v60, s24
    v_mfma_f32_32x32x16_bf16 a[32:47], v[136:139], v[112:115], a[32:47]
    v_perm_b32 v94, v66, v64, s24
    v_perm_b32 v95, v70, v68, s24
    v_perm_b32 v96, v59, v57, s23
    v_mfma_f32_32x32x16_bf16 a[96:111], v[140:143], v[112:115], a[96:111]
    v_perm_b32 v97, v63, v61, s23
    v_perm_b32 v98, v67, v65, s23
    v_perm_b32 v99, v71, v69, s23
    v_mfma_f32_32x32x16_bf16 a[160:175], v[144:147], v[112:115], a[160:175]
    v_perm_b32 v100, v59, v57, s24
    v_perm_b32 v101, v63, v61, s24
    v_perm_b32 v102, v67, v65, s24
    v_mfma_f32_32x32x16_bf16 a[224:239], v[148:151], v[112:115], a[224:239]
    v_perm_b32 v103, v71, v69, s24
    s_waitcnt lgkmcnt(0)
    v_mfma_f32_32x32x16_bf16 a[48:63], v[136:139], v[116:119], a[48:63]
    v_mfma_f32_32x32x16_bf16 a[112:127], v[140:143], v[116:119], a[112:127]
    v_mfma_f32_32x32x16_bf16 a[176:191], v[144:147], v[116:119], a[176:191]
    v_mfma_f32_32x32x16_bf16 a[240:255], v[148:151], v[116:119], a[240:255]
    s_nop 0
    v_mfma_f32_32x32x16_bf16 a[0:15], v[120:123], v[88:91], a[0:15]
    ds_read_b128 v[136:139], v8 offset:3168
    ds_read_b128 v[140:143], v9 offset:3168
    ds_read_b128 v[144:147], v10 offset:3168
    v_mfma_f32_32x32x16_bf16 a[64:79], v[124:127], v[88:91], a[64:79]
    ds_read_b128 v[148:151], v11 offset:3168
    buffer_load_dwordx4 v[56:59], v16, s[16:19], s22 offen
    buffer_load_dwordx4 v[60:63], v17, s[16:19], s22 offen
    v_mfma_f32_32x32x16_bf16 a[128:143], v[128:131], v[88:91], a[128:143]
    buffer_load_dwordx4 v[64:67], v18, s[16:19], s22 offen
    buffer_load_dwordx4 v[68:71], v19, s[16:19], s22 offen
    s_add_u32 s22, s22, 131072
    v_mfma_f32_32x32x16_bf16 a[192:207], v[132:135], v[88:91], a[192:207]
    s_waitcnt vmcnt(12)
    v_permlane16_swap_b32 v72, v74
    v_permlane16_swap_b32 v73, v75
    v_mfma_f32_32x32x16_bf16 a[16:31], v[120:123], v[92:95], a[16:31]
    v_permlane16_swap_b32 v76, v78
    v_permlane16_swap_b32 v77, v79
    v_permlane16_swap_b32 v80, v82
    v_mfma_f32_32x32x16_bf16 a[80:95], v[124:127], v[92:95], a[80:95]
    v_permlane16_swap_b32 v81, v83
    v_permlane16_swap_b32 v84, v86
    v_permlane16_swap_b32 v85, v87
    v_mfma_f32_32x32x16_bf16 a[144:159], v[128:131], v[92:95], a[144:159]
    v_perm_b32 v104, v74, v72, s23
    v_perm_b32 v105, v78, v76, s23
    v_perm_b32 v106, v82, v80, s23
    v_mfma_f32_32x32x16_bf16 a[208:223], v[132:135], v[92:95], a[208:223]
    v_perm_b32 v107, v86, v84, s23
    v_perm_b32 v108, v74, v72, s24
    v_perm_b32 v109, v78, v76, s24
    v_mfma_f32_32x32x16_bf16 a[32:47], v[120:123], v[96:99], a[32:47]
    v_perm_b32 v110, v82, v80, s24
    v_perm_b32 v111, v86, v84, s24
    v_perm_b32 v112, v75, v73, s23
    v_mfma_f32_32x32x16_bf16 a[96:111], v[124:127], v[96:99], a[96:111]
    v_perm_b32 v113, v79, v77, s23
    v_perm_b32 v114, v83, v81, s23
    v_perm_b32 v115, v87, v85, s23
    v_mfma_f32_32x32x16_bf16 a[160:175], v[128:131], v[96:99], a[160:175]
    v_perm_b32 v116, v75, v73, s24
    v_perm_b32 v117, v79, v77, s24
    v_perm_b32 v118, v83, v81, s24
    v_mfma_f32_32x32x16_bf16 a[224:239], v[132:135], v[96:99], a[224:239]
    v_perm_b32 v119, v87, v85, s24
    s_waitcnt lgkmcnt(0)
    v_mfma_f32_32x32x16_bf16 a[48:63], v[120:123], v[100:103], a[48:63]
    v_mfma_f32_32x32x16_bf16 a[112:127], v[124:127], v[100:103], a[112:127]
    v_mfma_f32_32x32x16_bf16 a[176:191], v[128:131], v[100:103], a[176:191]
    v_mfma_f32_32x32x16_bf16 a[240:255], v[132:135], v[100:103], a[240:255]
    s_nop 0
    v_mfma_f32_32x32x16_bf16 a[0:15], v[136:139], v[104:107], a[0:15]
    ds_read_b128 v[120:123], v8 offset:4224
    ds_read_b128 v[124:127], v9 offset:4224
    ds_read_b128 v[128:131], v10 offset:4224
    v_mfma_f32_32x32x16_bf16 a[64:79], v[140:143], v[104:107], a[64:79]
    ds_read_b128 v[132:135], v11 offset:4224
    buffer_load_dwordx4 v[72:75], v16, s[16:19], s22 offen
    buffer_load_dwordx4 v[76:79], v17, s[16:19], s22 offen
    v_mfma_f32_32x32x16_bf16 a[128:143], v[144:147], v[104:107], a[128:143]
    buffer_load_dwordx4 v[80:83], v18, s[16:19], s22 offen
    buffer_load_dwordx4 v[84:87], v19, s[16:19], s22 offen
    s_add_u32 s22, s22, 131072
    v_mfma_f32_32x32x16_bf16 a[192:207], v[148:151], v[104:107], a[192:207]
    s_waitcnt vmcnt(12)
    v_permlane16_swap_b32 v24, v26
    v_permlane16_swap_b32 v25, v27
    v_mfma_f32_32x32x16_bf16 a[16:31], v[136:139], v[108:111], a[16:31]
    v_permlane16_swap_b32 v28, v30
    v_permlane16_swap_b32 v29, v31
    v_permlane16_swap_b32 v32, v34
    v_mfma_f32_32x32x16_bf16 a[80:95], v[140:143], v[108:111], a[80:95]
    v_permlane16_swap_b32 v33, v35
    v_permlane16_swap_b32 v36, v38
    v_permlane16_swap_b32 v37, v39
    v_mfma_f32_32x32x16_bf16 a[144:159], v[144:147], v[108:111], a[144:159]
    v_perm_b32 v88, v26, v24, s23
    v_perm_b32 v89, v30, v28, s23
    v_perm_b32 v90, v34, v32, s23
    v_mfma_f32_32x32x16_bf16 a[208:223], v[148:151], v[108:111], a[208:223]
    v_perm_b32 v91, v38, v36, s23
    v_perm_b32 v92, v26, v24, s24
    v_perm_b32 v93, v30, v28, s24
    v_mfma_f32_32x32x16_bf16 a[32:47], v[136:139], v[112:115], a[32:47]
    v_perm_b32 v94, v34, v32, s24
    v_perm_b32 v95, v38, v36, s24
    v_perm_b32 v96, v27, v25, s23
    v_mfma_f32_32x32x16_bf16 a[96:111], v[140:143], v[112:115], a[96:111]
    v_perm_b32 v97, v31, v29, s23
    v_perm_b32 v98, v35, v33, s23
    v_perm_b32 v99, v39, v37, s23
    v_mfma_f32_32x32x16_bf16 a[160:175], v[144:147], v[112:115], a[160:175]
    v_perm_b32 v100, v27, v25, s24
    v_perm_b32 v101, v31, v29, s24
    v_perm_b32 v102, v35, v33, s24
    v_mfma_f32_32x32x16_bf16 a[224:239], v[148:151], v[112:115], a[224:239]
    v_perm_b32 v103, v39, v37, s24
    s_waitcnt lgkmcnt(0)
    v_mfma_f32_32x32x16_bf16 a[48:63], v[136:139], v[116:119], a[48:63]
    v_mfma_f32_32x32x16_bf16 a[112:127], v[140:143], v[116:119], a[112:127]
    v_mfma_f32_32x32x16_bf16 a[176:191], v[144:147], v[116:119], a[176:191]
    v_mfma_f32_32x32x16_bf16 a[240:255], v[148:151], v[116:119], a[240:255]
    s_nop 0
    s_sub_u32 s21, s21, 1
    s_cmp_lg_u32 s21, 0
    s_cbranch_scc1 L_gv_11
    s_nop 7
    s_nop 7
    s_branch L_w_ve
L_w_v2:
    buffer_load_dwordx4 v[24:27], v16, s[16:19], s22 offen
    buffer_load_dwordx4 v[28:31], v17, s[16:19], s22 offen
    buffer_load_dwordx4 v[32:35], v18, s[16:19], s22 offen
    buffer_load_dwordx4 v[36:39], v19, s[16:19], s22 offen
    s_add_u32 s22, s22, 131072
    buffer_load_dwordx4 v[40:43], v16, s[16:19], s22 offen
    buffer_load_dwordx4 v[44:47], v17, s[16:19], s22 offen
    buffer_load_dwordx4 v[48:51], v18, s[16:19], s22 offen
    buffer_load_dwordx4 v[52:55], v19, s[16:19], s22 offen
    s_add_u32 s22, s22, 131072
    buffer_load_dwordx4 v[56:59], v16, s[16:19], s22 offen
    buffer_load_dwordx4 v[60:63], v17, s[16:19], s22 offen
    buffer_load_dwordx4 v[64:67], v18, s[16:19], s22 offen
    buffer_load_dwordx4 v[68:71], v19, s[16:19], s22 offen
    s_add_u32 s22, s22, 131072
    buffer_load_dwordx4 v[72:75], v16, s[16:19], s22 offen
    buffer_load_dwordx4 v[76:79], v17, s[16:19], s22 offen
    buffer_load_dwordx4 v[80:83], v18, s[16:19], s22 offen
    buffer_load_dwordx4 v[84:87], v19, s[16:19], s22 offen
    s_add_u32 s22, s22, 131072
    ds_read_b128 v[120:123], v8 offset:0
    ds_read_b128 v[124:127], v9 offset:0
    s_waitcnt vmcnt(12)
    v_permlane16_swap_b32 v24, v26
    v_permlane16_swap_b32 v25, v27
    v_permlane16_swap_b32 v28, v30
    v_permlane16_swap_b32 v29, v31
    v_permlane16_swap_b32 v32, v34
    v_permlane16_swap_b32 v33, v35
    v_permlane16_swap_b32 v36, v38
    v_permlane16_swap_b32 v37, v39
    v_perm_b32 v88, v26, v24, s23
    v_perm_b32 v89, v30, v28, s23
    v_perm_b32 v90, v34, v32, s23
    v_perm_b32 v91, v38, v36, s23
    v_perm_b32 v92, v26, v24, s24
    v_perm_b32 v93, v30, v28, s24
    v_perm_b32 v94, v34, v32, s24
    v_perm_b32 v95, v38, v36, s24
    v_perm_b32 v96, v27, v25, s23
    v_perm_b32 v97, v31, v29, s23
    v_perm_b32 v98, v35, v33, s23
    v_perm_b32 v99, v39, v37, s23
    v_perm_b32 v100, v27, v25, s24
    v_perm_b32 v101, v31, v29, s24
    v_perm_b32 v102, v35, v33, s24
    v_perm_b32 v103, v39, v37, s24
    s_waitcnt lgkmcnt(0)
    v_mfma_f32_32x32x16_bf16 a[0:15], v[120:123], v[88:91], 0
    ds_read_b128 v[136:139], v8 offset:1056
    ds_read_b128 v[140:143], v9 offset:1056
    buffer_load_dwordx4 v[24:27], v16, s[16:19], s22 offen
    buffer_load_dwordx4 v[28:31], v17, s[16:19], s22 offen
    buffer_load_dwordx4 v[32:35], v18, s[16:19], s22 offen
    v_mfma_f32_32x32x16_bf16 a[64:79], v[124:127], v[88:91], 0
    buffer_load_dwordx4 v[36:39], v19, s[16:19], s22 offen
    s_add_u32 s22, s22, 131072
    s_waitcnt vmcnt(12)
    v_permlane16_swap_b32 v40, v42
    v_permlane16_swap_b32 v41, v43
    v_mfma_f32_32x32x16_bf16 a[16:31], v[120:123], v[92:95], 0
    v_permlane16_swap_b32 v44, v46
    v_permlane16_swap_b32 v45, v47
    v_permlane16_swap_b32 v48, v50
    v_permlane16_swap_b32 v49, v51
    v_permlane16_swap_b32 v52, v54
    v_mfma_f32_32x32x16_bf16 a[80:95], v[124:127], v[92:95], 0
    v_permlane16_swap_b32 v53, v55
    v_perm_b32 v104, v42, v40, s23
    v_perm_b32 v105, v46, v44, s23
    v_perm_b32 v106, v50, v48, s23
    v_perm_b32 v107, v54, v52, s23
    v_mfma_f32_32x32x16_bf16 a[32:47], v[120:123], v[96:99], 0
    v_perm_b32 v108, v42, v40, s24
    v_perm_b32 v109, v46, v44, s24
    v_perm_b32 v110, v50, v48, s24
    v_perm_b32 v111, v54, v52, s24
    v_perm_b32 v112, v43, v41, s23
    v_mfma_f32_32x32x16_bf16 a[96:111], v[124:127], v[96:99], 0
    v_perm_b32 v113, v47, v45, s23
    v_perm_b32 v114, v51, v49, s23
    v_perm_b32 v115, v55, v53, s23
    v_perm_b32 v116, v43, v41, s24
    v_perm_b32 v117, v47, v45, s24
    v_mfma_f32_32x32x16_bf16 a[48:63], v[120:123], v[100:103], 0
    v_perm_b32 v118, v51, v49, s24
    v_perm_b32 v119, v55, v53, s24
    s_waitcnt lgkmcnt(0)
    v_mfma_f32_32x32x16_bf16 a[112:127], v[124:127], v[100:103], 0
    s_nop 0
    v_mfma_f32_32x32x16_bf16 a[0:15], v[136:139], v[104:107], a[0:15]
    ds_read_b128 v[120:123], v8 offset:2112
    ds_read_b128 v[124:127], v9 offset:2112
    buffer_load_dwordx4 v[40:43], v16, s[16:19], s22 offen
    buffer_load_dwordx4 v[44:47], v17, s[16:19], s22 offen
    buffer_load_dwordx4 v[48:51], v18, s[16:19], s22 offen
    v_mfma_f32_32x32x16_bf16 a[64:79], v[140:143], v[104:107], a[64:79]
    buffer_load_dwordx4 v[52:55], v19, s[16:19], s22 offen
    s_add_u32 s22, s22, 131072
    s_waitcnt vmcnt(12)
    v_permlane16_swap_b32 v56, v58
    v_permlane16_swap_b32 v57, v59
    v_mfma_f32_32x32x16_bf16 a[16:31], v[136:139], v[108:111], a[16:31]
    v_permlane16_swap_b32 v60, v62
    v_permlane16_swap_b32 v61, v63
    v_permlane16_swap_b32 v64, v66
    v_permlane16_swap_b32 v65, v67
    v_permlane16_swap_b32 v68, v70
    v_mfma_f32_32x32x16_bf16 a[80:95], v[140:143], v[108:111], a[80:95]
    v_permlane16_swap_b32 v69, v71
    v_perm_b32 v88, v58, v56, s23
    v_perm_b32 v89, v62, v60, s23
    v_perm_b32 v90, v66, v64, s23
    v_perm_b32 v91, v70, v68, s23
    v_mfma_f32_32x32x16_bf16 a[32:47], v[136:139], v[112:115], a[32:47]
    v_perm_b32 v92, v58, v56, s24
    v_perm_b32 v93, v62, v60, s24
    v_perm_b32 v94, v66, v64, s24
    v_perm_b32 v95, v70, v68, s24
    v_perm_b32 v96, v59, v57, s23
    v_mfma_f32_32x32x16_bf16 a[96:111], v[140:143], v[112:115], a[96:111]
    v_perm_b32 v97, v63, v61, s23
    v_perm_b32 v98, v67, v65, s23
    v_perm_b32 v99, v71, v69, s23
    v_perm_b32 v100, v59, v57, s24
    v_perm_b32 v101, v63, v61, s24
    v_mfma_f32_32x32x16_bf16 a[48:63], v[136:139], v[116:119], a[48:63]
    v_perm_b32 v102, v67, v65, s24
    v_perm_b32 v103, v71, v69, s24
    s_waitcnt lgkmcnt(0)
    v_mfma_f32_32x32x16_bf16 a[112:127], v[140:143], v[116:119], a[112:127]
    s_nop 0
    v_mfma_f32_32x32x16_bf16 a[0:15], v[120:123], v[88:91], a[0:15]
    ds_read_b128 v[136:139], v8 offset:3168
    ds_read_b128 v[140:143], v9 offset:3168
    buffer_load_dwordx4 v[56:59], v16, s[16:19], s22 offen
    buffer_load_dwordx4 v[60:63], v17, s[16:19], s22 offen
    buffer_load_dwordx4 v[64:67], v18, s[16:19], s22 offen
    v_mfma_f32_32x32x16_bf16 a[64:79], v[124:127], v[88:91], a[64:79]
    buffer_load_dwordx4 v[68:71], v19, s[16:19], s22 offen
    s_add_u32 s22, s22, 131072
    s_waitcnt vmcnt(12)
    v_permlane16_swap_b32 v72, v74
    v_permlane16_swap_b32 v73, v75
    v_mfma_f32_32x32x16_bf16 a[16:31], v[120:123], v[92:95], a[16:31]
    v_permlane16_swap_b32 v76, v78
    v_permlane16_swap_b32 v77, v79
    v_permlane16_swap_b32 v80, v82
    v_permlane16_swap_b32 v81, v83
    v_permlane16_swap_b32 v84, v86
    v_mfma_f32_32x32x16_bf16 a[80:95], v[124:127], v[92:95], a[80:95]
    v_permlane16_swap_b32 v85, v87
    v_perm_b32 v104, v74, v72, s23
    v_perm_b32 v105, v78, v76, s23
    v_perm_b32 v106, v82, v80, s23
    v_perm_b32 v107, v86, v84, s23
    v_mfma_f32_32x32x16_bf16 a[32:47], v[120:123], v[96:99], a[32:47]
    v_perm_b32 v108, v74, v72, s24
    v_perm_b32 v109, v78, v76, s24
    v_perm_b32 v110, v82, v80, s24
    v_perm_b32 v111, v86, v84, s24
    v_perm_b32 v112, v75, v73, s23
    v_mfma_f32_32x32x16_bf16 a[96:111], v[124:127], v[96:99], a[96:111]
    v_perm_b32 v113, v79, v77, s23
    v_perm_b32 v114, v83, v81, s23
    v_perm_b32 v115, v87, v85, s23
    v_perm_b32 v116, v75, v73, s24
    v_perm_b32 v117, v79, v77, s24
    v_mfma_f32_32x32x16_bf16 a[48:63], v[120:123], v[100:103], a[48:63]
    v_perm_b32 v118, v83, v81, s24
    v_perm_b32 v119, v87, v85, s24
    s_waitcnt lgkmcnt(0)
    v_mfma_f32_32x32x16_bf16 a[112:127], v[124:127], v[100:103], a[112:127]
    s_nop 0
    v_mfma_f32_32x32x16_bf16 a[0:15], v[136:139], v[104:107], a[0:15]
    ds_read_b128 v[120:123], v8 offset:4224
    ds_read_b128 v[124:127], v9 offset:4224
    buffer_load_dwordx4 v[72:75], v16, s[16:19], s22 offen
    buffer_load_dwordx4 v[76:79], v17, s[16:19], s22 offen
    buffer_load_dwordx4 v[80:83], v18, s[16:19], s22 offen
    v_mfma_f32_32x32x16_bf16 a[64:79], v[140:143], v[104:107], a[64:79]
    buffer_load_dwordx4 v[84:87], v19, s[16:19], s22 offen
    s_add_u32 s22, s22, 131072
    s_waitcnt vmcnt(12)
    v_permlane16_swap_b32 v24, v26
    v_permlane16_swap_b32 v25, v27
    v_mfma_f32_32x32x16_bf16 a[16:31], v[136:139], v[108:111], a[16:31]
    v_permlane16_swap_b32 v28, v30
    v_permlane16_swap_b32 v29, v31
    v_permlane16_swap_b32 v32, v34
    v_permlane16_swap_b32 v33, v35
    v_permlane16_swap_b32 v36, v38
    v_mfma_f32_32x32x16_bf16 a[80:95], v[140:143], v[108:111], a[80:95]
    v_permlane16_swap_b32 v37, v39
    v_perm_b32 v88, v26, v24, s23
    v_perm_b32 v89, v30, v28, s23
    v_perm_b32 v90, v34, v32, s23
    v_perm_b32 v91, v38, v36, s23
    v_mfma_f32_32x32x16_bf16 a[32:47], v[136:139], v[112:115], a[32:47]
    v_perm_b32 v92, v26, v24, s24
    v_perm_b32 v93, v30, v28, s24
    v_perm_b32 v94, v34, v32, s24
    v_perm_b32 v95, v38, v36, s24
    v_perm_b32 v96, v27, v25, s23
    v_mfma_f32_32x32x16_bf16 a[96:111], v[140:143], v[112:115], a[96:111]
    v_perm_b32 v97, v31, v29, s23
    v_perm_b32 v98, v35, v33, s23
    v_perm_b32 v99, v39, v37, s23
    v_perm_b32 v100, v27, v25, s24
    v_perm_b32 v101, v31, v29, s24
    v_mfma_f32_32x32x16_bf16 a[48:63], v[136:139], v[116:119], a[48:63]
    v_perm_b32 v102, v35, v33, s24
    v_perm_b32 v103, v39, v37, s24
    s_waitcnt lgkmcnt(0)
    v_mfma_f32_32x32x16_bf16 a[112:127], v[140:143], v[116:119], a[112:127]
    s_nop 0
    s_mov_b32 s21, 7
L_gv2_12:
    v_add_u32 v8, 4224, v8
    v_add_u32 v9, 4224, v9
    v_mfma_f32_32x32x16_bf16 a[0:15], v[120:123], v[88:91], a[0:15]
    ds_read_b128 v[136:139], v8 offset:1056
    ds_read_b128 v[140:143], v9 offset:1056
    buffer_load_dwordx4 v[24:27], v16, s[16:19], s22 offen
    buffer_load_dwordx4 v[28:31], v17, s[16:19], s22 offen
    buffer_load_dwordx4 v[32:35], v18, s[16:19], s22 offen
    v_mfma_f32_32x32x16_bf16 a[64:79], v[124:127], v[88:91], a[64:79]
    buffer_load_dwordx4 v[36:39], v19, s[16:19], s22 offen
    s_add_u32 s22, s22, 131072
    s_waitcnt vmcnt(12)
    v_permlane16_swap_b32 v40, v42
    v_permlane16_swap_b32 v41, v43
    v_mfma_f32_32x32x16_bf16 a[16:31], v[120:123], v[92:95], a[16:31]
    v_permlane16_swap_b32 v44, v46
    v_permlane16_swap_b32 v45, v47
    v_permlane16_swap_b32 v48, v50
    v_permlane16_swap_b32 v49, v51
    v_permlane16_swap_b32 v52, v54
    v_mfma_f32_32x32x16_bf16 a[80:95], v[124:127], v[92:95], a[80:95]
    v_permlane16_swap_b32 v53, v55
    v_perm_b32 v104, v42, v40, s23
    v_perm_b32 v105, v46, v44, s23
    v_perm_b32 v106, v50, v48, s23
    v_perm_b32 v107, v54, v52, s23
    v_mfma_f32_32x32x16_bf16 a[32:47], v[120:123], v[96:99], a[32:47]
    v_perm_b32 v108, v42, v40, s24
    v_perm_b32 v109, v46, v44, s24
    v_perm_b32 v110, v50, v48, s24
    v_perm_b32 v111, v54, v52, s24
    v_perm_b32 v112, v43, v41, s23
    v_mfma_f32_32x32x16_bf16 a[96:111], v[124:127], v[96:99], a[96:111]
    v_perm_b32 v113, v47, v45, s23
    v_perm_b32 v114, v51, v49, s23
    v_perm_b32 v115, v55, v53, s23
    v_perm_b32 v116, v43, v41, s24
    v_perm_b32 v117, v47, v45, s24
    v_mfma_f32_32x32x16_bf16 a[48:63], v[120:123], v[100:103], a[48:63]
    v_perm_b32 v118, v51, v49, s24
    v_perm_b32 v119, v55, v53, s24
    s_waitcnt lgkmcnt(0)
    v_mfma_f32_32x32x16_bf16 a[112:127], v[124:127], v[100:103], a[112:127]
    s_nop 0
    v_mfma_f32_32x32x16_bf16 a[0:15], v[136:139], v[104:107], a[0:15]
    ds_read_b128 v[120:123], v8 offset:2112
    ds_read_b128 v[124:127], v9 offset:2112
    buffer_load_dwordx4 v[40:43], v16, s[16:19], s22 offen
    buffer_load_dwordx4 v[44:47], v17, s[16:19], s22 offen
    buffer_load_dwordx4 v[48:51], v18, s[16:19], s22 offen
    v_mfma_f32_32x32x16_bf16 a[64:79], v[140:143], v[104:107], a[64:79]
    buffer_load_dwordx4 v[52:55], v19, s[16:19], s22 offen
    s_add_u32 s22, s22, 131072
    s_waitcnt vmcnt(12)
    v_permlane16_swap_b32 v56, v58
    v_permlane16_swap_b32 v57, v59
    v_mfma_f32_32x32x16_bf16 a[16:31], v[136:139], v[108:111], a[16:31]
    v_permlane16_swap_b32 v60, v62
    v_permlane16_swap_b32 v61, v63
    v_permlane16_swap_b32 v64, v66
    v_permlane16_swap_b32 v65, v67
    v_permlane16_swap_b32 v68, v70
    v_mfma_f32_32x32x16_bf16 a[80:95], v[140:143], v[108:111], a[80:95]
    v_permlane16_swap_b32 v69, v71
    v_perm_b32 v88, v58, v56, s23
    v_perm_b32 v89, v62, v60, s23
    v_perm_b32 v90, v66, v64, s23
    v_perm_b32 v91, v70, v68, s23
    v_mfma_f32_32x32x16_bf16 a[32:47], v[136:139], v[112:115], a[32:47]
    v_perm_b32 v92, v58, v56, s24
    v_perm_b32 v93, v62, v60, s24
    v_perm_b32 v94, v66, v64, s24
    v_perm_b32 v95, v70, v68, s24
    v_perm_b32 v96, v59, v57, s23
    v_mfma_f32_32x32x16_bf16 a[96:111], v[140:143], v[112:115], a[96:111]
    v_perm_b32 v97, v63, v61, s23
    v_perm_b32 v98, v67, v65, s23
    v_perm_b32 v99, v71, v69, s23
    v_perm_b32 v100, v59, v57, s24
    v_perm_b32 v101, v63, v61, s24
    v_mfma_f32_32x32x16_bf16 a[48:63], v[136:139], v[116:119], a[48:63]
    v_perm_b32 v102, v67, v65, s24
    v_perm_b32 v103, v71, v69, s24
    s_waitcnt lgkmcnt(0)
    v_mfma_f32_32x32x16_bf16 a[112:127], v[140:143], v[116:119], a[112:127]
    s_nop 0
    v_mfma_f32_32x32x16_bf16 a[0:15], v[120:123], v[88:91], a[0:15]
    ds_read_b128 v[136:139], v8 offset:3168
    ds_read_b128 v[140:143], v9 offset:3168
    buffer_load_dwordx4 v[56:59], v16, s[16:19], s22 offen
    buffer_load_dwordx4 v[60:63], v17, s[16:19], s22 offen
    buffer_load_dwordx4 v[64:67], v18, s[16:19], s22 offen
    v_mfma_f32_32x32x16_bf16 a[64:79], v[124:127], v[88:91], a[64:79]
    buffer_load_dwordx4 v[68:71], v19, s[16:19], s22 offen
    s_add_u32 s22, s22, 131072
    s_waitcnt vmcnt(12)
    v_permlane16_swap_b32 v72, v74
    v_permlane16_swap_b32 v73, v75
    v_mfma_f32_32x32x16_bf16 a[16:31], v[120:123], v[92:95], a[16:31]
    v_permlane16_swap_b32 v76, v78
    v_permlane16_swap_b32 v77, v79
    v_permlane16_swap_b32 v80, v82
    v_permlane16_swap_b32 v81, v83
    v_permlane16_swap_b32 v84, v86
    v_mfma_f32_32x32x16_bf16 a[80:95], v[124:127], v[92:95], a[80:95]
    v_permlane16_swap_b32 v85, v87
    v_perm_b32 v104, v74, v72, s23
    v_perm_b32 v105, v78, v76, s23
    v_perm_b32 v106, v82, v80, s23
    v_perm_b32 v107, v86, v84, s23
    v_mfma_f32_32x32x16_bf16 a[32:47], v[120:123], v[96:99], a[32:47]
    v_perm_b32 v108, v74, v72, s24
    v_perm_b32 v109, v78, v76, s24
    v_perm_b32 v110, v82, v80, s24
    v_perm_b32 v111, v86, v84, s24
    v_perm_b32 v112, v75, v73, s23
    v_mfma_f32_32x32x16_bf16 a[96:111], v[124:127], v[96:99], a[96:111]
    v_perm_b32 v113, v79, v77, s23
    v_perm_b32 v114, v83, v81, s23
    v_perm_b32 v115, v87, v85, s23
    v_perm_b32 v116, v75, v73, s24
    v_perm_b32 v117, v79, v77, s24
    v_mfma_f32_32x32x16_bf16 a[48:63], v[120:123], v[100:103], a[48:63]
    v_perm_b32 v118, v83, v81, s24
    v_perm_b32 v119, v87, v85, s24
    s_waitcnt lgkmcnt(0)
    v_mfma_f32_32x32x16_bf16 a[112:127], v[124:127], v[100:103], a[112:127]
    s_nop 0
    v_mfma_f32_32x32x16_bf16 a[0:15], v[136:139], v[104:107], a[0:15]
    ds_read_b128 v[120:123], v8 offset:4224
    ds_read_b128 v[124:127], v9 offset:4224
    buffer_load_dwordx4 v[72:75], v16, s[16:19], s22 offen
    buffer_load_dwordx4 v[76:79], v17, s[16:19], s22 offen
    buffer_load_dwordx4 v[80:83], v18, s[16:19], s22 offen
    v_mfma_f32_32x32x16_bf16 a[64:79], v[140:143], v[104:107], a[64:79]
    buffer_load_dwordx4 v[84:87], v19, s[16:19], s22 offen
    s_add_u32 s22, s22, 131072
    s_waitcnt vmcnt(12)
    v_permlane16_swap_b32 v24, v26
    v_permlane16_swap_b32 v25, v27
    v_mfma_f32_32x32x16_bf16 a[16:31], v[136:139], v[108:111], a[16:31]
    v_permlane16_swap_b32 v28, v30
    v_permlane16_swap_b32 v29, v31
    v_permlane16_swap_b32 v32, v34
    v_permlane16_swap_b32 v33, v35
    v_permlane16_swap_b32 v36, v38
    v_mfma_f32_32x32x16_bf16 a[80:95], v[140:143], v[108:111], a[80:95]
    v_permlane16_swap_b32 v37, v39
    v_perm_b32 v88, v26, v24, s23
    v_perm_b32 v89, v30, v28, s23
    v_perm_b32 v90, v34, v32, s23
    v_perm_b32 v91, v38, v36, s23
    v_mfma_f32_32x32x16_bf16 a[32:47], v[136:139], v[112:115], a[32:47]
    v_perm_b32 v92, v26, v24, s24
    v_perm_b32 v93, v30, v28, s24
    v_perm_b32 v94, v34, v32, s24
    v_perm_b32 v95, v38, v36, s24
    v_perm_b32 v96, v27, v25, s23
    v_mfma_f32_32x32x16_bf16 a[96:111], v[140:143], v[112:115], a[96:111]
    v_perm_b32 v97, v31, v29, s23
    v_perm_b32 v98, v35, v33, s23
    v_perm_b32 v99, v39, v37, s23
    v_perm_b32 v100, v27, v25, s24
    v_perm_b32 v101, v31, v29, s24
    v_mfma_f32_32x32x16_bf16 a[48:63], v[136:139], v[116:119], a[48:63]
    v_perm_b32 v102, v35, v33, s24
    v_perm_b32 v103, v39, v37, s24
    s_waitcnt lgkmcnt(0)
    v_mfma_f32_32x32x16_bf16 a[112:127], v[140:143], v[116:119], a[112:127]
    s_nop 0
    s_sub_u32 s21, s21, 1
    s_cmp_lg_u32 s21, 0
    s_cbranch_scc1 L_gv2_12
    s_nop 7
    s_nop 7
L_w_ve:
    v_accvgpr_read_b32 v224, a0
    v_accvgpr_read_b32 v225, a1
    v_accvgpr_read_b32 v226, a2
    v_accvgpr_read_b32 v227, a3
    v_accvgpr_read_b32 v228, a4
    v_accvgpr_read_b32 v229, a5
    v_accvgpr_read_b32 v230, a6
    v_accvgpr_read_b32 v231, a7
    v_cvt_pk_bf16_f32 v232, v224, v225
    v_cvt_pk_bf16_f32 v233, v226, v227
    v_cvt_pk_bf16_f32 v234, v228, v229
    v_cvt_pk_bf16_f32 v235, v230, v231
    ds_write_b128 v6, v[232:235] offset:0
    v_accvgpr_read_b32 v236, a8
    v_accvgpr_read_b32 v237, a9
    v_accvgpr_read_b32 v238, a10
    v_accvgpr_read_b32 v239, a11
    v_accvgpr_read_b32 v240, a12
    v_accvgpr_read_b32 v241, a13
    v_accvgpr_read_b32 v242, a14
    v_accvgpr_read_b32 v243, a15
    v_cvt_pk_bf16_f32 v244, v236, v237
    v_cvt_pk_bf16_f32 v245, v238, v239
    v_cvt_pk_bf16_f32 v246, v240, v241
    v_cvt_pk_bf16_f32 v247, v242, v243
    ds_write_b128 v6, v[244:247] offset:512
    v_accvgpr_read_b32 v224, a32
    v_accvgpr_read_b32 v225, a33
    v_accvgpr_read_b32 v226, a34
    v_accvgpr_read_b32 v227, a35
    v_accvgpr_read_b32 v228, a36
    v_accvgpr_read_b32 v229, a37
    v_accvgpr_read_b32 v230, a38
    v_accvgpr_read_b32 v231, a39
    v_cvt_pk_bf16_f32 v232, v224, v225
    v_cvt_pk_bf16_f32 v233, v226, v227
    v_cvt_pk_bf16_f32 v234, v228, v229
    v_cvt_pk_bf16_f32 v235, v230, v231
    ds_write_b128 v6, v[232:235] offset:16
    v_accvgpr_read_b32 v236, a40
    v_accvgpr_read_b32 v237, a41
    v_accvgpr_read_b32 v238, a42
    v_accvgpr_read_b32 v239, a43
    v_accvgpr_read_b32 v240, a44
    v_accvgpr_read_b32 v241, a45
    v_accvgpr_read_b32 v242, a46
    v_accvgpr_read_b32 v243, a47
    v_cvt_pk_bf16_f32 v244, v236, v237
    v_cvt_pk_bf16_f32 v245, v238, v239
    v_cvt_pk_bf16_f32 v246, v240, v241
    v_cvt_pk_bf16_f32 v247, v242, v243
    ds_write_b128 v6, v[244:247] offset:528
    ds_read_b128 v[192:195], v20 offset:0
    ds_read_b128 v[196:199], v20 offset:1024
    ds_read_b128 v[200:203], v20 offset:2048
    ds_read_b128 v[204:207], v20 offset:3072
    s_add_u32 s7, s26, 4096
    s_waitcnt lgkmcnt(0)
    buffer_store_dwordx4 v[192:195], v15, s[8:11], s26 offen offset:0 sc1
    buffer_store_dwordx4 v[196:199], v15, s[8:11], s26 offen offset:2048 sc1
    buffer_store_dwordx4 v[200:203], v15, s[8:11], s7 offen offset:0 sc1
    buffer_store_dwordx4 v[204:207], v15, s[8:11], s7 offen offset:2048 sc1
    v_accvgpr_read_b32 v224, a16
    v_accvgpr_read_b32 v225, a17
    v_accvgpr_read_b32 v226, a18
    v_accvgpr_read_b32 v227, a19
    v_accvgpr_read_b32 v228, a20
    v_accvgpr_read_b32 v229, a21
    v_accvgpr_read_b32 v230, a22
    v_accvgpr_read_b32 v231, a23
    v_cvt_pk_bf16_f32 v232, v224, v225
    v_cvt_pk_bf16_f32 v233, v226, v227
    v_cvt_pk_bf16_f32 v234, v228, v229
    v_cvt_pk_bf16_f32 v235, v230, v231
    ds_write_b128 v6, v[232:235] offset:0
    v_accvgpr_read_b32 v236, a24
    v_accvgpr_read_b32 v237, a25
    v_accvgpr_read_b32 v238, a26
    v_accvgpr_read_b32 v239, a27
    v_accvgpr_read_b32 v240, a28
    v_accvgpr_read_b32 v241, a29
    v_accvgpr_read_b32 v242, a30
    v_accvgpr_read_b32 v243, a31
    v_cvt_pk_bf16_f32 v244, v236, v237
    v_cvt_pk_bf16_f32 v245, v238, v239
    v_cvt_pk_bf16_f32 v246, v240, v241
    v_cvt_pk_bf16_f32 v247, v242, v243
    ds_write_b128 v6, v[244:247] offset:512
    v_accvgpr_read_b32 v224, a48
    v_accvgpr_read_b32 v225, a49
    v_accvgpr_read_b32 v226, a50
    v_accvgpr_read_b32 v227, a51
    v_accvgpr_read_b32 v228, a52
    v_accvgpr_read_b32 v229, a53
    v_accvgpr_read_b32 v230, a54
    v_accvgpr_read_b32 v231, a55
    v_cvt_pk_bf16_f32 v232, v224, v225
    v_cvt_pk_bf16_f32 v233, v226, v227
    v_cvt_pk_bf16_f32 v234, v228, v229
    v_cvt_pk_bf16_f32 v235, v230, v231
    ds_write_b128 v6, v[232:235] offset:16
    v_accvgpr_read_b32 v236, a56
    v_accvgpr_read_b32 v237, a57
    v_accvgpr_read_b32 v238, a58
    v_accvgpr_read_b32 v239, a59
    v_accvgpr_read_b32 v240, a60
    v_accvgpr_read_b32 v241, a61
    v_accvgpr_read_b32 v242, a62
    v_accvgpr_read_b32 v243, a63
    v_cvt_pk_bf16_f32 v244, v236, v237
    v_cvt_pk_bf16_f32 v245, v238, v239
    v_cvt_pk_bf16_f32 v246, v240, v241
    v_cvt_pk_bf16_f32 v247, v242, v243
    ds_write_b128 v6, v[244:247] offset:528
    ds_read_b128 v[208:211], v20 offset:0
    ds_read_b128 v[212:215], v20 offset:1024
    ds_read_b128 v[216:219], v20 offset:2048
    ds_read_b128 v[220:223], v20 offset:3072
    s_add_u32 s7, s26, 4096
    s_waitcnt lgkmcnt(0)
    buffer_store_dwordx4 v[208:211], v15, s[8:11], s26 offen offset:1024 sc1
    buffer_store_dwordx4 v[212:215], v15, s[8:11], s26 offen offset:3072 sc1
    buffer_store_dwordx4 v[216:219], v15, s[8:11], s7 offen offset:1024 sc1
    buffer_store_dwordx4 v[220:223], v15, s[8:11], s7 offen offset:3072 sc1
    s_add_u32 s26, s26, 262144
    v_accvgpr_read_b32 v224, a64
    v_accvgpr_read_b32 v225, a65
    v_accvgpr_read_b32 v226, a66
    v_accvgpr_read_b32 v227, a67
    v_accvgpr_read_b32 v228, a68
    v_accvgpr_read_b32 v229, a69
    v_accvgpr_read_b32 v230, a70
    v_accvgpr_read_b32 v231, a71
    v_cvt_pk_bf16_f32 v232, v224, v225
    v_cvt_pk_bf16_f32 v233, v226, v227
    v_cvt_pk_bf16_f32 v234, v228, v229
    v_cvt_pk_bf16_f32 v235, v230, v231
    ds_write_b128 v6, v[232:235] offset:0
    v_accvgpr_read_b32 v236, a72
    v_accvgpr_read_b32 v237, a73
    v_accvgpr_read_b32 v238, a74
    v_accvgpr_read_b32 v239, a75
    v_accvgpr_read_b32 v240, a76
    v_accvgpr_read_b32 v241, a77
    v_accvgpr_read_b32 v242, a78
    v_accvgpr_read_b32 v243, a79
    v_cvt_pk_bf16_f32 v244, v236, v237
    v_cvt_pk_bf16_f32 v245, v238, v239
    v_cvt_pk_bf16_f32 v246, v240, v241
    v_cvt_pk_bf16_f32 v247, v242, v243
    ds_write_b128 v6, v[244:247] offset:512
    v_accvgpr_read_b32 v224, a96
    v_accvgpr_read_b32 v225, a97
    v_accvgpr_read_b32 v226, a98
    v_accvgpr_read_b32 v227, a99
    v_accvgpr_read_b32 v228, a100
    v_accvgpr_read_b32 v229, a101
    v_accvgpr_read_b32 v230, a102
    v_accvgpr_read_b32 v231, a103
    v_cvt_pk_bf16_f32 v232, v224, v225
    v_cvt_pk_bf16_f32 v233, v226, v227
    v_cvt_pk_bf16_f32 v234, v228, v229
    v_cvt_pk_bf16_f32 v235, v230, v231
    ds_write_b128 v6, v[232:235] offset:16
    v_accvgpr_read_b32 v236, a104
    v_accvgpr_read_b32 v237, a105
    v_accvgpr_read_b32 v238, a106
    v_accvgpr_read_b32 v239, a107
    v_accvgpr_read_b32 v240, a108
    v_accvgpr_read_b32 v241, a109
    v_accvgpr_read_b32 v242, a110
    v_accvgpr_read_b32 v243, a111
    v_cvt_pk_bf16_f32 v244, v236, v237
    v_cvt_pk_bf16_f32 v245, v238, v239
    v_cvt_pk_bf16_f32 v246, v240, v241
    v_cvt_pk_bf16_f32 v247, v242, v243
    ds_write_b128 v6, v[244:247] offset:528
    ds_read_b128 v[192:195], v20 offset:0
    ds_read_b128 v[196:199], v20 offset:1024
    ds_read_b128 v[200:203], v20 offset:2048
    ds_read_b128 v[204:207], v20 offset:3072
    s_add_u32 s7, s26, 4096
    s_waitcnt lgkmcnt(0)
    buffer_store_dwordx4 v[192:195], v15, s[8:11], s26 offen offset:0 sc1
    buffer_store_dwordx4 v[196:199], v15, s[8:11], s26 offen offset:2048 sc1
    buffer_store_dwordx4 v[200:203], v15, s[8:11], s7 offen offset:0 sc1
    buffer_store_dwordx4 v[204:207], v15, s[8:11], s7 offen offset:2048 sc1
    v_accvgpr_read_b32 v224, a80
    v_accvgpr_read_b32 v225, a81
    v_accvgpr_read_b32 v226, a82
    v_accvgpr_read_b32 v227, a83
    v_accvgpr_read_b32 v228, a84
    v_accvgpr_read_b32 v229, a85
    v_accvgpr_read_b32 v230, a86
    v_accvgpr_read_b32 v231, a87
    v_cvt_pk_bf16_f32 v232, v224, v225
    v_cvt_pk_bf16_f32 v233, v226, v227
    v_cvt_pk_bf16_f32 v234, v228, v229
    v_cvt_pk_bf16_f32 v235, v230, v231
    ds_write_b128 v6, v[232:235] offset:0
    v_accvgpr_read_b32 v236, a88
    v_accvgpr_read_b32 v237, a89
    v_accvgpr_read_b32 v238, a90
    v_accvgpr_read_b32 v239, a91
    v_accvgpr_read_b32 v240, a92
    v_accvgpr_read_b32 v241, a93
    v_accvgpr_read_b32 v242, a94
    v_accvgpr_read_b32 v243, a95
    v_cvt_pk_bf16_f32 v244, v236, v237
    v_cvt_pk_bf16_f32 v245, v238, v239
    v_cvt_pk_bf16_f32 v246, v240, v241
    v_cvt_pk_bf16_f32 v247, v242, v243
    ds_write_b128 v6, v[244:247] offset:512
    v_accvgpr_read_b32 v224, a112
    v_accvgpr_read_b32 v225, a113
    v_accvgpr_read_b32 v226, a114
    v_accvgpr_read_b32 v227, a115
    v_accvgpr_read_b32 v228, a116
    v_accvgpr_read_b32 v229, a117
    v_accvgpr_read_b32 v230, a118
    v_accvgpr_read_b32 v231, a119
    v_cvt_pk_bf16_f32 v232, v224, v225
    v_cvt_pk_bf16_f32 v233, v226, v227
    v_cvt_pk_bf16_f32 v234, v228, v229
    v_cvt_pk_bf16_f32 v235, v230, v231
    ds_write_b128 v6, v[232:235] offset:16
    v_accvgpr_read_b32 v236, a120
    v_accvgpr_read_b32 v237, a121
    v_accvgpr_read_b32 v238, a122
    v_accvgpr_read_b32 v239, a123
    v_accvgpr_read_b32 v240, a124
    v_accvgpr_read_b32 v241, a125
    v_accvgpr_read_b32 v242, a126
    v_accvgpr_read_b32 v243, a127
    v_cvt_pk_bf16_f32 v244, v236, v237
    v_cvt_pk_bf16_f32 v245, v238, v239
    v_cvt_pk_bf16_f32 v246, v240, v241
    v_cvt_pk_bf16_f32 v247, v242, v243
    ds_write_b128 v6, v[244:247] offset:528
    ds_read_b128 v[208:211], v20 offset:0
    ds_read_b128 v[212:215], v20 offset:1024
    ds_read_b128 v[216:219], v20 offset:2048
    ds_read_b128 v[220:223], v20 offset:3072
    s_add_u32 s7, s26, 4096
    s_waitcnt lgkmcnt(0)
    buffer_store_dwordx4 v[208:211], v15, s[8:11], s26 offen offset:1024 sc1
    buffer_store_dwordx4 v[212:215], v15, s[8:11], s26 offen offset:3072 sc1
    buffer_store_dwordx4 v[216:219], v15, s[8:11], s7 offen offset:1024 sc1
    buffer_store_dwordx4 v[220:223], v15, s[8:11], s7 offen offset:3072 sc1
    s_add_u32 s26, s26, 262144
    s_cmp_eq_u32 s52, 2
    s_cbranch_scc1 L_w_fin
    v_accvgpr_read_b32 v224, a128
    v_accvgpr_read_b32 v225, a129
    v_accvgpr_read_b32 v226, a130
    v_accvgpr_read_b32 v227, a131
    v_accvgpr_read_b32 v228, a132
    v_accvgpr_read_b32 v229, a133
    v_accvgpr_read_b32 v230, a134
    v_accvgpr_read_b32 v231, a135
    v_cvt_pk_bf16_f32 v232, v224, v225
    v_cvt_pk_bf16_f32 v233, v226, v227
    v_cvt_pk_bf16_f32 v234, v228, v229
    v_cvt_pk_bf16_f32 v235, v230, v231
    ds_write_b128 v6, v[232:235] offset:0
    v_accvgpr_read_b32 v236, a136
    v_accvgpr_read_b32 v237, a137
    v_accvgpr_read_b32 v238, a138
    v_accvgpr_read_b32 v239, a139
    v_accvgpr_read_b32 v240, a140
    v_accvgpr_read_b32 v241, a141
    v_accvgpr_read_b32 v242, a142
    v_accvgpr_read_b32 v243, a143
    v_cvt_pk_bf16_f32 v244, v236, v237
    v_cvt_pk_bf16_f32 v245, v238, v239
    v_cvt_pk_bf16_f32 v246, v240, v241
    v_cvt_pk_bf16_f32 v247, v242, v243
    ds_write_b128 v6, v[244:247] offset:512
    v_accvgpr_read_b32 v224, a160
    v_accvgpr_read_b32 v225, a161
    v_accvgpr_read_b32 v226, a162
    v_accvgpr_read_b32 v227, a163
    v_accvgpr_read_b32 v228, a164
    v_accvgpr_read_b32 v229, a165
    v_accvgpr_read_b32 v230, a166
    v_accvgpr_read_b32 v231, a167
    v_cvt_pk_bf16_f32 v232, v224, v225
    v_cvt_pk_bf16_f32 v233, v226, v227
    v_cvt_pk_bf16_f32 v234, v228, v229
    v_cvt_pk_bf16_f32 v235, v230, v231
    ds_write_b128 v6, v[232:235] offset:16
    v_accvgpr_read_b32 v236, a168
    v_accvgpr_read_b32 v237, a169
    v_accvgpr_read_b32 v238, a170
    v_accvgpr_read_b32 v239, a171
    v_accvgpr_read_b32 v240, a172
    v_accvgpr_read_b32 v241, a173
    v_accvgpr_read_b32 v242, a174
    v_accvgpr_read_b32 v243, a175
    v_cvt_pk_bf16_f32 v244, v236, v237
    v_cvt_pk_bf16_f32 v245, v238, v239
    v_cvt_pk_bf16_f32 v246, v240, v241
    v_cvt_pk_bf16_f32 v247, v242, v243
    ds_write_b128 v6, v[244:247] offset:528
    ds_read_b128 v[192:195], v20 offset:0
    ds_read_b128 v[196:199], v20 offset:1024
    ds_read_b128 v[200:203], v20 offset:2048
    ds_read_b128 v[204:207], v20 offset:3072
    s_add_u32 s7, s26, 4096
    s_waitcnt lgkmcnt(0)
    buffer_store_dwordx4 v[192:195], v15, s[8:11], s26 offen offset:0 sc1
    buffer_store_dwordx4 v[196:199], v15, s[8:11], s26 offen offset:2048 sc1
    buffer_store_dwordx4 v[200:203], v15, s[8:11], s7 offen offset:0 sc1
    buffer_store_dwordx4 v[204:207], v15, s[8:11], s7 offen offset:2048 sc1
    v_accvgpr_read_b32 v224, a144
    v_accvgpr_read_b32 v225, a145
    v_accvgpr_read_b32 v226, a146
    v_accvgpr_read_b32 v227, a147
    v_accvgpr_read_b32 v228, a148
    v_accvgpr_read_b32 v229, a149
    v_accvgpr_read_b32 v230, a150
    v_accvgpr_read_b32 v231, a151
    v_cvt_pk_bf16_f32 v232, v224, v225
    v_cvt_pk_bf16_f32 v233, v226, v227
    v_cvt_pk_bf16_f32 v234, v228, v229
    v_cvt_pk_bf16_f32 v235, v230, v231
    ds_write_b128 v6, v[232:235] offset:0
    v_accvgpr_read_b32 v236, a152
    v_accvgpr_read_b32 v237, a153
    v_accvgpr_read_b32 v238, a154
    v_accvgpr_read_b32 v239, a155
    v_accvgpr_read_b32 v240, a156
    v_accvgpr_read_b32 v241, a157
    v_accvgpr_read_b32 v242, a158
    v_accvgpr_read_b32 v243, a159
    v_cvt_pk_bf16_f32 v244, v236, v237
    v_cvt_pk_bf16_f32 v245, v238, v239
    v_cvt_pk_bf16_f32 v246, v240, v241
    v_cvt_pk_bf16_f32 v247, v242, v243
    ds_write_b128 v6, v[244:247] offset:512
    v_accvgpr_read_b32 v224, a176
    v_accvgpr_read_b32 v225, a177
    v_accvgpr_read_b32 v226, a178
    v_accvgpr_read_b32 v227, a179
    v_accvgpr_read_b32 v228, a180
    v_accvgpr_read_b32 v229, a181
    v_accvgpr_read_b32 v230, a182
    v_accvgpr_read_b32 v231, a183
    v_cvt_pk_bf16_f32 v232, v224, v225
    v_cvt_pk_bf16_f32 v233, v226, v227
    v_cvt_pk_bf16_f32 v234, v228, v229
    v_cvt_pk_bf16_f32 v235, v230, v231
    ds_write_b128 v6, v[232:235] offset:16
    v_accvgpr_read_b32 v236, a184
    v_accvgpr_read_b32 v237, a185
    v_accvgpr_read_b32 v238, a186
    v_accvgpr_read_b32 v239, a187
    v_accvgpr_read_b32 v240, a188
    v_accvgpr_read_b32 v241, a189
    v_accvgpr_read_b32 v242, a190
    v_accvgpr_read_b32 v243, a191
    v_cvt_pk_bf16_f32 v244, v236, v237
    v_cvt_pk_bf16_f32 v245, v238, v239
    v_cvt_pk_bf16_f32 v246, v240, v241
    v_cvt_pk_bf16_f32 v247, v242, v243
    ds_write_b128 v6, v[244:247] offset:528
    ds_read_b128 v[208:211], v20 offset:0
    ds_read_b128 v[212:215], v20 offset:1024
    ds_read_b128 v[216:219], v20 offset:2048
    ds_read_b128 v[220:223], v20 offset:3072
    s_add_u32 s7, s26, 4096
    s_waitcnt lgkmcnt(0)
    buffer_store_dwordx4 v[208:211], v15, s[8:11], s26 offen offset:1024 sc1
    buffer_store_dwordx4 v[212:215], v15, s[8:11], s26 offen offset:3072 sc1
    buffer_store_dwordx4 v[216:219], v15, s[8:11], s7 offen offset:1024 sc1
    buffer_store_dwordx4 v[220:223], v15, s[8:11], s7 offen offset:3072 sc1
    s_add_u32 s26, s26, 262144
    v_accvgpr_read_b32 v224, a192
    v_accvgpr_read_b32 v225, a193
    v_accvgpr_read_b32 v226, a194
    v_accvgpr_read_b32 v227, a195
    v_accvgpr_read_b32 v228, a196
    v_accvgpr_read_b32 v229, a197
    v_accvgpr_read_b32 v230, a198
    v_accvgpr_read_b32 v231, a199
    v_cvt_pk_bf16_f32 v232, v224, v225
    v_cvt_pk_bf16_f32 v233, v226, v227
    v_cvt_pk_bf16_f32 v234, v228, v229
    v_cvt_pk_bf16_f32 v235, v230, v231
    ds_write_b128 v6, v[232:235] offset:0
    v_accvgpr_read_b32 v236, a200
    v_accvgpr_read_b32 v237, a201
    v_accvgpr_read_b32 v238, a202
    v_accvgpr_read_b32 v239, a203
    v_accvgpr_read_b32 v240, a204
    v_accvgpr_read_b32 v241, a205
    v_accvgpr_read_b32 v242, a206
    v_accvgpr_read_b32 v243, a207
    v_cvt_pk_bf16_f32 v244, v236, v237
    v_cvt_pk_bf16_f32 v245, v238, v239
    v_cvt_pk_bf16_f32 v246, v240, v241
    v_cvt_pk_bf16_f32 v247, v242, v243
    ds_write_b128 v6, v[244:247] offset:512
    v_accvgpr_read_b32 v224, a224
    v_accvgpr_read_b32 v225, a225
    v_accvgpr_read_b32 v226, a226
    v_accvgpr_read_b32 v227, a227
    v_accvgpr_read_b32 v228, a228
    v_accvgpr_read_b32 v229, a229
    v_accvgpr_read_b32 v230, a230
    v_accvgpr_read_b32 v231, a231
    v_cvt_pk_bf16_f32 v232, v224, v225
    v_cvt_pk_bf16_f32 v233, v226, v227
    v_cvt_pk_bf16_f32 v234, v228, v229
    v_cvt_pk_bf16_f32 v235, v230, v231
    ds_write_b128 v6, v[232:235] offset:16
    v_accvgpr_read_b32 v236, a232
    v_accvgpr_read_b32 v237, a233
    v_accvgpr_read_b32 v238, a234
    v_accvgpr_read_b32 v239, a235
    v_accvgpr_read_b32 v240, a236
    v_accvgpr_read_b32 v241, a237
    v_accvgpr_read_b32 v242, a238
    v_accvgpr_read_b32 v243, a239
    v_cvt_pk_bf16_f32 v244, v236, v237
    v_cvt_pk_bf16_f32 v245, v238, v239
    v_cvt_pk_bf16_f32 v246, v240, v241
    v_cvt_pk_bf16_f32 v247, v242, v243
    ds_write_b128 v6, v[244:247] offset:528
    ds_read_b128 v[192:195], v20 offset:0
    ds_read_b128 v[196:199], v20 offset:1024
    ds_read_b128 v[200:203], v20 offset:2048
    ds_read_b128 v[204:207], v20 offset:3072
    s_add_u32 s7, s26, 4096
    s_waitcnt lgkmcnt(0)
    buffer_store_dwordx4 v[192:195], v15, s[8:11], s26 offen offset:0 sc1
    buffer_store_dwordx4 v[196:199], v15, s[8:11], s26 offen offset:2048 sc1
    buffer_store_dwordx4 v[200:203], v15, s[8:11], s7 offen offset:0 sc1
    buffer_store_dwordx4 v[204:207], v15, s[8:11], s7 offen offset:2048 sc1
    v_accvgpr_read_b32 v224, a208
    v_accvgpr_read_b32 v225, a209
    v_accvgpr_read_b32 v226, a210
    v_accvgpr_read_b32 v227, a211
    v_accvgpr_read_b32 v228, a212
    v_accvgpr_read_b32 v229, a213
    v_accvgpr_read_b32 v230, a214
    v_accvgpr_read_b32 v231, a215
    v_cvt_pk_bf16_f32 v232, v224, v225
    v_cvt_pk_bf16_f32 v233, v226, v227
    v_cvt_pk_bf16_f32 v234, v228, v229
    v_cvt_pk_bf16_f32 v235, v230, v231
    ds_write_b128 v6, v[232:235] offset:0
    v_accvgpr_read_b32 v236, a216
    v_accvgpr_read_b32 v237, a217
    v_accvgpr_read_b32 v238, a218
    v_accvgpr_read_b32 v239, a219
    v_accvgpr_read_b32 v240, a220
    v_accvgpr_read_b32 v241, a221
    v_accvgpr_read_b32 v242, a222
    v_accvgpr_read_b32 v243, a223
    v_cvt_pk_bf16_f32 v244, v236, v237
    v_cvt_pk_bf16_f32 v245, v238, v239
    v_cvt_pk_bf16_f32 v246, v240, v241
    v_cvt_pk_bf16_f32 v247, v242, v243
    ds_write_b128 v6, v[244:247] offset:512
    v_accvgpr_read_b32 v224, a240
    v_accvgpr_read_b32 v225, a241
    v_accvgpr_read_b32 v226, a242
    v_accvgpr_read_b32 v227, a243
    v_accvgpr_read_b32 v228, a244
    v_accvgpr_read_b32 v229, a245
    v_accvgpr_read_b32 v230, a246
    v_accvgpr_read_b32 v231, a247
    v_cvt_pk_bf16_f32 v232, v224, v225
    v_cvt_pk_bf16_f32 v233, v226, v227
    v_cvt_pk_bf16_f32 v234, v228, v229
    v_cvt_pk_bf16_f32 v235, v230, v231
    ds_write_b128 v6, v[232:235] offset:16
    v_accvgpr_read_b32 v236, a248
    v_accvgpr_read_b32 v237, a249
    v_accvgpr_read_b32 v238, a250
    v_accvgpr_read_b32 v239, a251
    v_accvgpr_read_b32 v240, a252
    v_accvgpr_read_b32 v241, a253
    v_accvgpr_read_b32 v242, a254
    v_accvgpr_read_b32 v243, a255
    v_cvt_pk_bf16_f32 v244, v236, v237
    v_cvt_pk_bf16_f32 v245, v238, v239
    v_cvt_pk_bf16_f32 v246, v240, v241
    v_cvt_pk_bf16_f32 v247, v242, v243
    ds_write_b128 v6, v[244:247] offset:528
    ds_read_b128 v[208:211], v20 offset:0
    ds_read_b128 v[212:215], v20 offset:1024
    ds_read_b128 v[216:219], v20 offset:2048
    ds_read_b128 v[220:223], v20 offset:3072
    s_add_u32 s7, s26, 4096
    s_waitcnt lgkmcnt(0)
    buffer_store_dwordx4 v[208:211], v15, s[8:11], s26 offen offset:1024 sc1
    buffer_store_dwordx4 v[212:215], v15, s[8:11], s26 offen offset:3072 sc1
    buffer_store_dwordx4 v[216:219], v15, s[8:11], s7 offen offset:1024 sc1
    buffer_store_dwordx4 v[220:223], v15, s[8:11], s7 offen offset:3072 sc1
    s_add_u32 s26, s26, 262144
L_w_fin:
    v_mov_b32 v3, 0
    s_mov_b32 s31, 400000
L_gate_13:
    buffer_load_dword v2, v3, s[48:51], 0 offen offset:40 sc1
    s_waitcnt vmcnt(0)
    v_readfirstlane_b32 s7, v2
    s_sub_u32 s31, s31, 1
    s_cbranch_scc1 L_m_fail
    s_cmp_lt_u32 s7, 32
    s_cbranch_scc1 L_gate_13
    s_lshr_b32 s7, s52, 1
    s_or_b32 s7, s7, 1
    v_lshlrev_b32 v3, 11, v1
    v_mov_b32 v2, 1
    s_mov_b32 exec_lo, s7
    s_mov_b32 exec_hi, 0
    buffer_store_dword v2, v3, s[8:11], s30 offen sc1
    s_mov_b64 exec, -1
    s_add_u32 s29, s29, 1
    s_cmp_lt_u32 s101, 64
    s_cbranch_scc0 L_w_slow
    s_cmp_eq_u32 s52, 4
    s_cbranch_scc1 L_w_idle
    s_cmp_lg_u32 s29, 1
    s_cbranch_scc1 L_w_f3
    s_cmp_ge_u32 s6, 8
    s_cbranch_scc1 L_w_f3
    s_add_u32 s27, s27, 64
    s_branch L_w_tile
L_w_f3:
    s_lshl_b32 s5, s5, 1
    s_add_u32 s5, s5, 24
    s_lshl_b32 s27, s6, 2
    s_mov_b32 s52, 4
    s_barrier
    s_branch L_w_stage
L_w_slow:
    s_sub_u32 s7, s101, 64
    s_cmp_lg_u32 s29, 1
    s_cbranch_scc1 L_w_s3
    s_cmp_ge_u32 s7, 80
    s_cbranch_scc1 L_w_hi
    s_add_u32 s27, s27, 64
    s_branch L_w_tile
L_w_hi:
    s_sub_u32 s7, s7, 80
    s_cmp_lt_u32 s7, 32
    s_cbranch_scc1 L_w_hq
    s_add_u32 s101, s7, 128
    s_branch L_w_toaw
L_w_hq:
    s_and_b32 s5, s7, 3
    s_lshl_b32 s5, s5, 1
    s_add_u32 s5, s5, 24
    s_and_b32 s27, s7, 28
    s_add_u32 s27, s27, 64
    s_barrier
    s_branch L_w_stage
L_w_s3:
    s_cmp_ge_u32 s7, 16
    s_cbranch_scc1 L_w_s4
    s_add_u32 s101, s7, 208
    s_branch L_w_toaw
L_w_s4:
    s_sub_u32 s101, s7, 16
    s_branch L_w_after2
L_w_idle:
    s_mov_b32 s101, 100
    s_branch L_w_after2
L_w_toaw:
    v_mbcnt_lo_u32_b32 v0, -1, 0
    v_mbcnt_hi_u32_b32 v0, -1, v0
    s_lshl_b32 s3, s100, 6
    v_add_u32 v0, s3, v0
    s_barrier
    s_load_dwordx2 s[16:17], s[0:1], 40
    s_load_dwordx2 s[18:19], s[0:1], 112
    v_and_b32 v1, 63, v0
    s_mov_b32 s4, s100
    s_sub_u32 s31, s101, 160
    s_and_b32 s5, s31, 7
    s_bfe_u32 s6, s31, 0x10003
    s_lshr_b32 s7, s31, 4
    s_mov_b32 s23, 0x05040100
    s_mov_b32 s24, 0x07060302
    s_mov_b32 s22, 0x3e0293ee
    s_waitcnt lgkmcnt(0)
    s_mov_b32 s8, s18
    s_and_b32 s9, s19, 0xffff
    s_mov_b32 s10, 268435456
    s_mov_b32 s11, 0x00020000
    s_mov_b32 s12, s16
    s_and_b32 s13, s17, 0xffff
    s_mov_b32 s14, 4194304
    s_mov_b32 s15, 0x00020000
    v_lshlrev_b32 v2, 4, v1
    s_lshl_b32 s20, s5, 2
    s_add_u32 s20, s20, s4
    s_lshl_b32 s56, s20, 6
    s_add_u32 s56, s56, 60817408
    s_lshr_b32 s21, s7, 1
    s_lshl_b32 s21, s21, 11
    s_add_u32 s56, s56, s21
    s_lshl_b32 s57, s20, 7
    s_add_u32 s57, s57, 60882944
    s_lshl_b32 s58, s31, 7
    s_add_u32 s58, s58, 60887040
    s_lshl_b32 s21, s7, 5
    s_add_u32 s20, s20, s21
    s_lshl_b32 s28, s20, 12
    s_lshl_b32 s20, s20, 13
    s_add_u32 s25, s20, 0
    s_add_u32 s26, s20, 16777216
    s_add_u32 s27, s20, 33554432
    s_add_u32 s28, s28, 100794368
    v_bfe_u32 v8, v1, 2, 2
    v_lshlrev_b32 v3, 8, v8
    v_lshrrev_b32 v9, 4, v1
    v_lshl_add_u32 v3, v9, 6, v3
    v_and_b32 v10, 1, v1
    v_lshl_add_u32 v3, v10, 2, v3
    v_lshrrev_b32 v8, 5, v1
    v_lshlrev_b32 v8, 13, v8
    v_and_b32 v9, 31, v1
    v_lshl_add_u32 v10, v9, 2, v8
    v_add_u32 v9, 4096, v10
    s_lshl_b32 s20, s5, 19
    s_lshl_b32 s21, s6, 9
    s_add_u32 s20, s20, s21
    s_lshl_b32 s21, s4, 7
    s_add_u32 s29, s20, s21
    buffer_load_dword v136, v10, s[12:15], s29 offen offset:0
    buffer_load_dword v137, v10, s[12:15], s29 offen offset:1024
    buffer_load_dword v138, v10, s[12:15], s29 offen offset:2048
    buffer_load_dword v139, v10, s[12:15], s29 offen offset:3072
    buffer_load_dword v140, v9, s[12:15], s29 offen offset:0
    buffer_load_dword v141, v9, s[12:15], s29 offen offset:1024
    buffer_load_dword v142, v9, s[12:15], s29 offen offset:2048
    buffer_load_dword v143, v9, s[12:15], s29 offen offset:3072
    s_add_u32 s29, s29, 16384
    buffer_load_dword v144, v10, s[12:15], s29 offen offset:0
    buffer_load_dword v145, v10, s[12:15], s29 offen offset:1024
    buffer_load_dword v146, v10, s[12:15], s29 offen offset:2048
    buffer_load_dword v147, v10, s[12:15], s29 offen offset:3072
    buffer_load_dword v148, v9, s[12:15], s29 offen offset:0
    buffer_load_dword v149, v9, s[12:15], s29 offen offset:1024
    buffer_load_dword v150, v9, s[12:15], s29 offen offset:2048
    buffer_load_dword v151, v9, s[12:15], s29 offen offset:3072
    s_add_u32 s29, s29, 16384
    buffer_load_dword v152, v10, s[12:15], s29 offen offset:0
    buffer_load_dword v153, v10, s[12:15], s29 offen offset:1024
    buffer_load_dword v154, v10, s[12:15], s29 offen offset:2048
    buffer_load_dword v155, v10, s[12:15], s29 offen offset:3072
    buffer_load_dword v156, v9, s[12:15], s29 offen offset:0
    buffer_load_dword v157, v9, s[12:15], s29 offen offset:1024
    buffer_load_dword v158, v9, s[12:15], s29 offen offset:2048
    buffer_load_dword v159, v9, s[12:15], s29 offen offset:3072
    s_add_u32 s29, s29, 16384
    buffer_load_dword v160, v10, s[12:15], s29 offen offset:0
    buffer_load_dword v161, v10, s[12:15], s29 offen offset:1024
    buffer_load_dword v162, v10, s[12:15], s29 offen offset:2048
    buffer_load_dword v163, v10, s[12:15], s29 offen offset:3072
    buffer_load_dword v164, v9, s[12:15], s29 offen offset:0
    buffer_load_dword v165, v9, s[12:15], s29 offen offset:1024
    buffer_load_dword v166, v9, s[12:15], s29 offen offset:2048
    buffer_load_dword v167, v9, s[12:15], s29 offen offset:3072
    s_add_u32 s29, s29, 16384
    buffer_load_dword v168, v10, s[12:15], s29 offen offset:0
    buffer_load_dword v169, v10, s[12:15], s29 offen offset:1024
    buffer_load_dword v170, v10, s[12:15], s29 offen offset:2048
    buffer_load_dword v171, v10, s[12:15], s29 offen offset:3072
    buffer_load_dword v172, v9, s[12:15], s29 offen offset:0
    buffer_load_dword v173, v9, s[12:15], s29 offen offset:1024
    buffer_load_dword v174, v9, s[12:15], s29 offen offset:2048
    buffer_load_dword v175, v9, s[12:15], s29 offen offset:3072
    s_add_u32 s29, s29, 16384
    buffer_load_dword v176, v10, s[12:15], s29 offen offset:0
    buffer_load_dword v177, v10, s[12:15], s29 offen offset:1024
    buffer_load_dword v178, v10, s[12:15], s29 offen offset:2048
    buffer_load_dword v179, v10, s[12:15], s29 offen offset:3072
    buffer_load_dword v180, v9, s[12:15], s29 offen offset:0
    buffer_load_dword v181, v9, s[12:15], s29 offen offset:1024
    buffer_load_dword v182, v9, s[12:15], s29 offen offset:2048
    buffer_load_dword v183, v9, s[12:15], s29 offen offset:3072
    s_add_u32 s29, s29, 16384
    s_waitcnt vmcnt(40)
    v_perm_b32 v184, v137, v136, s23
    v_perm_b32 v185, v139, v138, s23
    v_perm_b32 v186, v141, v140, s23
    v_perm_b32 v187, v143, v142, s23
    v_perm_b32 v188, v137, v136, s24
    v_perm_b32 v189, v139, v138, s24
    v_perm_b32 v190, v141, v140, s24
    v_perm_b32 v191, v143, v142, s24
    buffer_load_dword v136, v10, s[12:15], s29 offen offset:0
    buffer_load_dword v137, v10, s[12:15], s29 offen offset:1024
    buffer_load_dword v138, v10, s[12:15], s29 offen offset:2048
    buffer_load_dword v139, v10, s[12:15], s29 offen offset:3072
    buffer_load_dword v140, v9, s[12:15], s29 offen offset:0
    buffer_load_dword v141, v9, s[12:15], s29 offen offset:1024
    buffer_load_dword v142, v9, s[12:15], s29 offen offset:2048
    buffer_load_dword v143, v9, s[12:15], s29 offen offset:3072
    s_add_u32 s29, s29, 16384
    v_accvgpr_write_b32 a0, v184
    v_accvgpr_write_b32 a1, v185
    v_accvgpr_write_b32 a2, v186
    v_accvgpr_write_b32 a3, v187
    v_accvgpr_write_b32 a4, v188
    v_accvgpr_write_b32 a5, v189
    v_accvgpr_write_b32 a6, v190
    v_accvgpr_write_b32 a7, v191
    s_waitcnt vmcnt(40)
    v_perm_b32 v184, v145, v144, s23
    v_perm_b32 v185, v147, v146, s23
    v_perm_b32 v186, v149, v148, s23
    v_perm_b32 v187, v151, v150, s23
    v_perm_b32 v188, v145, v144, s24
    v_perm_b32 v189, v147, v146, s24
    v_perm_b32 v190, v149, v148, s24
    v_perm_b32 v191, v151, v150, s24
    buffer_load_dword v144, v10, s[12:15], s29 offen offset:0
    buffer_load_dword v145, v10, s[12:15], s29 offen offset:1024
    buffer_load_dword v146, v10, s[12:15], s29 offen offset:2048
    buffer_load_dword v147, v10, s[12:15], s29 offen offset:3072
    buffer_load_dword v148, v9, s[12:15], s29 offen offset:0
    buffer_load_dword v149, v9, s[12:15], s29 offen offset:1024
    buffer_load_dword v150, v9, s[12:15], s29 offen offset:2048
    buffer_load_dword v151, v9, s[12:15], s29 offen offset:3072
    s_add_u32 s29, s29, 16384
    v_accvgpr_write_b32 a8, v184
    v_accvgpr_write_b32 a9, v185
    v_accvgpr_write_b32 a10, v186
    v_accvgpr_write_b32 a11, v187
    v_accvgpr_write_b32 a12, v188
    v_accvgpr_write_b32 a13, v189
    v_accvgpr_write_b32 a14, v190
    v_accvgpr_write_b32 a15, v191
    s_waitcnt vmcnt(40)
    v_perm_b32 v184, v153, v152, s23
    v_perm_b32 v185, v155, v154, s23
    v_perm_b32 v186, v157, v156, s23
    v_perm_b32 v187, v159, v158, s23
    v_perm_b32 v188, v153, v152, s24
    v_perm_b32 v189, v155, v154, s24
    v_perm_b32 v190, v157, v156, s24
    v_perm_b32 v191, v159, v158, s24
    buffer_load_dword v152, v10, s[12:15], s29 offen offset:0
    buffer_load_dword v153, v10, s[12:15], s29 offen offset:1024
    buffer_load_dword v154, v10, s[12:15], s29 offen offset:2048
    buffer_load_dword v155, v10, s[12:15], s29 offen offset:3072
    buffer_load_dword v156, v9, s[12:15], s29 offen offset:0
    buffer_load_dword v157, v9, s[12:15], s29 offen offset:1024
    buffer_load_dword v158, v9, s[12:15], s29 offen offset:2048
    buffer_load_dword v159, v9, s[12:15], s29 offen offset:3072
    s_add_u32 s29, s29, 16384
    v_accvgpr_write_b32 a16, v184
    v_accvgpr_write_b32 a17, v185
    v_accvgpr_write_b32 a18, v186
    v_accvgpr_write_b32 a19, v187
    v_accvgpr_write_b32 a20, v188
    v_accvgpr_write_b32 a21, v189
    v_accvgpr_write_b32 a22, v190
    v_accvgpr_write_b32 a23, v191
    s_waitcnt vmcnt(40)
    v_perm_b32 v184, v161, v160, s23
    v_perm_b32 v185, v163, v162, s23
    v_perm_b32 v186, v165, v164, s23
    v_perm_b32 v187, v167, v166, s23
    v_perm_b32 v188, v161, v160, s24
    v_perm_b32 v189, v163, v162, s24
    v_perm_b32 v190, v165, v164, s24
    v_perm_b32 v191, v167, v166, s24
    buffer_load_dword v160, v10, s[12:15], s29 offen offset:0
    buffer_load_dword v161, v10, s[12:15], s29 offen offset:1024
    buffer_load_dword v162, v10, s[12:15], s29 offen offset:2048
    buffer_load_dword v163, v10, s[12:15], s29 offen offset:3072
    buffer_load_dword v164, v9, s[12:15], s29 offen offset:0
    buffer_load_dword v165, v9, s[12:15], s29 offen offset:1024
    buffer_load_dword v166, v9, s[12:15], s29 offen offset:2048
    buffer_load_dword v167, v9, s[12:15], s29 offen offset:3072
    s_add_u32 s29, s29, 16384
    v_accvgpr_write_b32 a24, v184
    v_accvgpr_write_b32 a25, v185
    v_accvgpr_write_b32 a26, v186
    v_accvgpr_write_b32 a27, v187
    v_accvgpr_write_b32 a28, v188
    v_accvgpr_write_b32 a29, v189
    v_accvgpr_write_b32 a30, v190
    v_accvgpr_write_b32 a31, v191
    s_waitcnt vmcnt(40)
    v_perm_b32 v184, v169, v168, s23
    v_perm_b32 v185, v171, v170, s23
    v_perm_b32 v186, v173, v172, s23
    v_perm_b32 v187, v175, v174, s23
    v_perm_b32 v188, v169, v168, s24
    v_perm_b32 v189, v171, v170, s24
    v_perm_b32 v190, v173, v172, s24
    v_perm_b32 v191, v175, v174, s24
    buffer_load_dword v168, v10, s[12:15], s29 offen offset:0
    buffer_load_dword v169, v10, s[12:15], s29 offen offset:1024
    buffer_load_dword v170, v10, s[12:15], s29 offen offset:2048
    buffer_load_dword v171, v10, s[12:15], s29 offen offset:3072
    buffer_load_dword v172, v9, s[12:15], s29 offen offset:0
    buffer_load_dword v173, v9, s[12:15], s29 offen offset:1024
    buffer_load_dword v174, v9, s[12:15], s29 offen offset:2048
    buffer_load_dword v175, v9, s[12:15], s29 offen offset:3072
    s_add_u32 s29, s29, 16384
    v_accvgpr_write_b32 a32, v184
    v_accvgpr_write_b32 a33, v185
    v_accvgpr_write_b32 a34, v186
    v_accvgpr_write_b32 a35, v187
    v_accvgpr_write_b32 a36, v188
    v_accvgpr_write_b32 a37, v189
    v_accvgpr_write_b32 a38, v190
    v_accvgpr_write_b32 a39, v191
    s_waitcnt vmcnt(40)
    v_perm_b32 v184, v177, v176, s23
    v_perm_b32 v185, v179, v178, s23
    v_perm_b32 v186, v181, v180, s23
    v_perm_b32 v187, v183, v182, s23
    v_perm_b32 v188, v177, v176, s24
    v_perm_b32 v189, v179, v178, s24
    v_perm_b32 v190, v181, v180, s24
    v_perm_b32 v191, v183, v182, s24
    buffer_load_dword v176, v10, s[12:15], s29 offen offset:0
    buffer_load_dword v177, v10, s[12:15], s29 offen offset:1024
    buffer_load_dword v178, v10, s[12:15], s29 offen offset:2048
    buffer_load_dword v179, v10, s[12:15], s29 offen offset:3072
    buffer_load_dword v180, v9, s[12:15], s29 offen offset:0
    buffer_load_dword v181, v9, s[12:15], s29 offen offset:1024
    buffer_load_dword v182, v9, s[12:15], s29 offen offset:2048
    buffer_load_dword v183, v9, s[12:15], s29 offen offset:3072
    s_add_u32 s29, s29, 16384
    v_accvgpr_write_b32 a40, v184
    v_accvgpr_write_b32 a41, v185
    v_accvgpr_write_b32 a42, v186
    v_accvgpr_write_b32 a43, v187
    v_accvgpr_write_b32 a44, v188
    v_accvgpr_write_b32 a45, v189
    v_accvgpr_write_b32 a46, v190
    v_accvgpr_write_b32 a47, v191
    s_waitcnt vmcnt(40)
    v_perm_b32 v184, v137, v136, s23
    v_perm_b32 v185, v139, v138, s23
    v_perm_b32 v186, v141, v140, s23
    v_perm_b32 v187, v143, v142, s23
    v_perm_b32 v188, v137, v136, s24
    v_perm_b32 v189, v139, v138, s24
    v_perm_b32 v190, v141, v140, s24
    v_perm_b32 v191, v143, v142, s24
    buffer_load_dword v136, v10, s[12:15], s29 offen offset:0
    buffer_load_dword v137, v10, s[12:15], s29 offen offset:1024
    buffer_load_dword v138, v10, s[12:15], s29 offen offset:2048
    buffer_load_dword v139, v10, s[12:15], s29 offen offset:3072
    buffer_load_dword v140, v9, s[12:15], s29 offen offset:0
    buffer_load_dword v141, v9, s[12:15], s29 offen offset:1024
    buffer_load_dword v142, v9, s[12:15], s29 offen offset:2048
    buffer_load_dword v143, v9, s[12:15], s29 offen offset:3072
    s_add_u32 s29, s29, 16384
    v_accvgpr_write_b32 a48, v184
    v_accvgpr_write_b32 a49, v185
    v_accvgpr_write_b32 a50, v186
    v_accvgpr_write_b32 a51, v187
    v_accvgpr_write_b32 a52, v188
    v_accvgpr_write_b32 a53, v189
    v_accvgpr_write_b32 a54, v190
    v_accvgpr_write_b32 a55, v191
    s_waitcnt vmcnt(40)
    v_perm_b32 v184, v145, v144, s23
    v_perm_b32 v185, v147, v146, s23
    v_perm_b32 v186, v149, v148, s23
    v_perm_b32 v187, v151, v150, s23
    v_perm_b32 v188, v145, v144, s24
    v_perm_b32 v189, v147, v146, s24
    v_perm_b32 v190, v149, v148, s24
    v_perm_b32 v191, v151, v150, s24
    buffer_load_dword v144, v10, s[12:15], s29 offen offset:0
    buffer_load_dword v145, v10, s[12:15], s29 offen offset:1024
    buffer_load_dword v146, v10, s[12:15], s29 offen offset:2048
    buffer_load_dword v147, v10, s[12:15], s29 offen offset:3072
    buffer_load_dword v148, v9, s[12:15], s29 offen offset:0
    buffer_load_dword v149, v9, s[12:15], s29 offen offset:1024
    buffer_load_dword v150, v9, s[12:15], s29 offen offset:2048
    buffer_load_dword v151, v9, s[12:15], s29 offen offset:3072
    s_add_u32 s29, s29, 16384
    v_accvgpr_write_b32 a56, v184
    v_accvgpr_write_b32 a57, v185
    v_accvgpr_write_b32 a58, v186
    v_accvgpr_write_b32 a59, v187
    v_accvgpr_write_b32 a60, v188
    v_accvgpr_write_b32 a61, v189
    v_accvgpr_write_b32 a62, v190
    v_accvgpr_write_b32 a63, v191
    s_waitcnt vmcnt(40)
    v_perm_b32 v184, v153, v152, s23
    v_perm_b32 v185, v155, v154, s23
    v_perm_b32 v186, v157, v156, s23
    v_perm_b32 v187, v159, v158, s23
    v_perm_b32 v188, v153, v152, s24
    v_perm_b32 v189, v155, v154, s24
    v_perm_b32 v190, v157, v156, s24
    v_perm_b32 v191, v159, v158, s24
    buffer_load_dword v152, v10, s[12:15], s29 offen offset:0
    buffer_load_dword v153, v10, s[12:15], s29 offen offset:1024
    buffer_load_dword v154, v10, s[12:15], s29 offen offset:2048
    buffer_load_dword v155, v10, s[12:15], s29 offen offset:3072
    buffer_load_dword v156, v9, s[12:15], s29 offen offset:0
    buffer_load_dword v157, v9, s[12:15], s29 offen offset:1024
    buffer_load_dword v158, v9, s[12:15], s29 offen offset:2048
    buffer_load_dword v159, v9, s[12:15], s29 offen offset:3072
    s_add_u32 s29, s29, 16384
    v_accvgpr_write_b32 a64, v184
    v_accvgpr_write_b32 a65, v185
    v_accvgpr_write_b32 a66, v186
    v_accvgpr_write_b32 a67, v187
    v_accvgpr_write_b32 a68, v188
    v_accvgpr_write_b32 a69, v189
    v_accvgpr_write_b32 a70, v190
    v_accvgpr_write_b32 a71, v191
    s_waitcnt vmcnt(40)
    v_perm_b32 v184, v161, v160, s23
    v_perm_b32 v185, v163, v162, s23
    v_perm_b32 v186, v165, v164, s23
    v_perm_b32 v187, v167, v166, s23
    v_perm_b32 v188, v161, v160, s24
    v_perm_b32 v189, v163, v162, s24
    v_perm_b32 v190, v165, v164, s24
    v_perm_b32 v191, v167, v166, s24
    buffer_load_dword v160, v10, s[12:15], s29 offen offset:0
    buffer_load_dword v161, v10, s[12:15], s29 offen offset:1024
    buffer_load_dword v162, v10, s[12:15], s29 offen offset:2048
    buffer_load_dword v163, v10, s[12:15], s29 offen offset:3072
    buffer_load_dword v164, v9, s[12:15], s29 offen offset:0
    buffer_load_dword v165, v9, s[12:15], s29 offen offset:1024
    buffer_load_dword v166, v9, s[12:15], s29 offen offset:2048
    buffer_load_dword v167, v9, s[12:15], s29 offen offset:3072
    s_add_u32 s29, s29, 16384
    v_accvgpr_write_b32 a72, v184
    v_accvgpr_write_b32 a73, v185
    v_accvgpr_write_b32 a74, v186
    v_accvgpr_write_b32 a75, v187
    v_accvgpr_write_b32 a76, v188
    v_accvgpr_write_b32 a77, v189
    v_accvgpr_write_b32 a78, v190
    v_accvgpr_write_b32 a79, v191
    s_waitcnt vmcnt(40)
    v_perm_b32 v184, v169, v168, s23
    v_perm_b32 v185, v171, v170, s23
    v_perm_b32 v186, v173, v172, s23
    v_perm_b32 v187, v175, v174, s23
    v_perm_b32 v188, v169, v168, s24
    v_perm_b32 v189, v171, v170, s24
    v_perm_b32 v190, v173, v172, s24
    v_perm_b32 v191, v175, v174, s24
    buffer_load_dword v168, v10, s[12:15], s29 offen offset:0
    buffer_load_dword v169, v10, s[12:15], s29 offen offset:1024
    buffer_load_dword v170, v10, s[12:15], s29 offen offset:2048
    buffer_load_dword v171, v10, s[12:15], s29 offen offset:3072
    buffer_load_dword v172, v9, s[12:15], s29 offen offset:0
    buffer_load_dword v173, v9, s[12:15], s29 offen offset:1024
    buffer_load_dword v174, v9, s[12:15], s29 offen offset:2048
    buffer_load_dword v175, v9, s[12:15], s29 offen offset:3072
    s_add_u32 s29, s29, 16384
    v_accvgpr_write_b32 a80, v184
    v_accvgpr_write_b32 a81, v185
    v_accvgpr_write_b32 a82, v186
    v_accvgpr_write_b32 a83, v187
    v_accvgpr_write_b32 a84, v188
    v_accvgpr_write_b32 a85, v189
    v_accvgpr_write_b32 a86, v190
    v_accvgpr_write_b32 a87, v191
    s_waitcnt vmcnt(40)
    v_perm_b32 v184, v177, v176, s23
    v_perm_b32 v185, v179, v178, s23
    v_perm_b32 v186, v181, v180, s23
    v_perm_b32 v187, v183, v182, s23
    v_perm_b32 v188, v177, v176, s24
    v_perm_b32 v189, v179, v178, s24
    v_perm_b32 v190, v181, v180, s24
    v_perm_b32 v191, v183, v182, s24
    buffer_load_dword v176, v10, s[12:15], s29 offen offset:0
    buffer_load_dword v177, v10, s[12:15], s29 offen offset:1024
    buffer_load_dword v178, v10, s[12:15], s29 offen offset:2048
    buffer_load_dword v179, v10, s[12:15], s29 offen offset:3072
    buffer_load_dword v180, v9, s[12:15], s29 offen offset:0
    buffer_load_dword v181, v9, s[12:15], s29 offen offset:1024
    buffer_load_dword v182, v9, s[12:15], s29 offen offset:2048
    buffer_load_dword v183, v9, s[12:15], s29 offen offset:3072
    s_add_u32 s29, s29, 16384
    v_accvgpr_write_b32 a88, v184
    v_accvgpr_write_b32 a89, v185
    v_accvgpr_write_b32 a90, v186
    v_accvgpr_write_b32 a91, v187
    v_accvgpr_write_b32 a92, v188
    v_accvgpr_write_b32 a93, v189
    v_accvgpr_write_b32 a94, v190
    v_accvgpr_write_b32 a95, v191
    s_waitcnt vmcnt(40)
    v_perm_b32 v184, v137, v136, s23
    v_perm_b32 v185, v139, v138, s23
    v_perm_b32 v186, v141, v140, s23
    v_perm_b32 v187, v143, v142, s23
    v_perm_b32 v188, v137, v136, s24
    v_perm_b32 v189, v139, v138, s24
    v_perm_b32 v190, v141, v140, s24
    v_perm_b32 v191, v143, v142, s24
    buffer_load_dword v136, v10, s[12:15], s29 offen offset:0
    buffer_load_dword v137, v10, s[12:15], s29 offen offset:1024
    buffer_load_dword v138, v10, s[12:15], s29 offen offset:2048
    buffer_load_dword v139, v10, s[12:15], s29 offen offset:3072
    buffer_load_dword v140, v9, s[12:15], s29 offen offset:0
    buffer_load_dword v141, v9, s[12:15], s29 offen offset:1024
    buffer_load_dword v142, v9, s[12:15], s29 offen offset:2048
    buffer_load_dword v143, v9, s[12:15], s29 offen offset:3072
    s_add_u32 s29, s29, 16384
    v_accvgpr_write_b32 a96, v184
    v_accvgpr_write_b32 a97, v185
    v_accvgpr_write_b32 a98, v186
    v_accvgpr_write_b32 a99, v187
    v_accvgpr_write_b32 a100, v188
    v_accvgpr_write_b32 a101, v189
    v_accvgpr_write_b32 a102, v190
    v_accvgpr_write_b32 a103, v191
    s_waitcnt vmcnt(40)
    v_perm_b32 v184, v145, v144, s23
    v_perm_b32 v185, v147, v146, s23
    v_perm_b32 v186, v149, v148, s23
    v_perm_b32 v187, v151, v150, s23
    v_perm_b32 v188, v145, v144, s24
    v_perm_b32 v189, v147, v146, s24
    v_perm_b32 v190, v149, v148, s24
    v_perm_b32 v191, v151, v150, s24
    buffer_load_dword v144, v10, s[12:15], s29 offen offset:0
    buffer_load_dword v145, v10, s[12:15], s29 offen offset:1024
    buffer_load_dword v146, v10, s[12:15], s29 offen offset:2048
    buffer_load_dword v147, v10, s[12:15], s29 offen offset:3072
    buffer_load_dword v148, v9, s[12:15], s29 offen offset:0
    buffer_load_dword v149, v9, s[12:15], s29 offen offset:1024
    buffer_load_dword v150, v9, s[12:15], s29 offen offset:2048
    buffer_load_dword v151, v9, s[12:15], s29 offen offset:3072
    s_add_u32 s29, s29, 16384
    v_accvgpr_write_b32 a104, v184
    v_accvgpr_write_b32 a105, v185
    v_accvgpr_write_b32 a106, v186
    v_accvgpr_write_b32 a107, v187
    v_accvgpr_write_b32 a108, v188
    v_accvgpr_write_b32 a109, v189
    v_accvgpr_write_b32 a110, v190
    v_accvgpr_write_b32 a111, v191
    s_waitcnt vmcnt(40)
    v_perm_b32 v184, v153, v152, s23
    v_perm_b32 v185, v155, v154, s23
    v_perm_b32 v186, v157, v156, s23
    v_perm_b32 v187, v159, v158, s23
    v_perm_b32 v188, v153, v152, s24
    v_perm_b32 v189, v155, v154, s24
    v_perm_b32 v190, v157, v156, s24
    v_perm_b32 v191, v159, v158, s24
    buffer_load_dword v152, v10, s[12:15], s29 offen offset:0
    buffer_load_dword v153, v10, s[12:15], s29 offen offset:1024
    buffer_load_dword v154, v10, s[12:15], s29 offen offset:2048
    buffer_load_dword v155, v10, s[12:15], s29 offen offset:3072
    buffer_load_dword v156, v9, s[12:15], s29 offen offset:0
    buffer_load_dword v157, v9, s[12:15], s29 offen offset:1024
    buffer_load_dword v158, v9, s[12:15], s29 offen offset:2048
    buffer_load_dword v159, v9, s[12:15], s29 offen offset:3072
    s_add_u32 s29, s29, 16384
    v_accvgpr_write_b32 a112, v184
    v_accvgpr_write_b32 a113, v185
    v_accvgpr_write_b32 a114, v186
    v_accvgpr_write_b32 a115, v187
    v_accvgpr_write_b32 a116, v188
    v_accvgpr_write_b32 a117, v189
    v_accvgpr_write_b32 a118, v190
    v_accvgpr_write_b32 a119, v191
    s_waitcnt vmcnt(40)
    v_perm_b32 v184, v161, v160, s23
    v_perm_b32 v185, v163, v162, s23
    v_perm_b32 v186, v165, v164, s23
    v_perm_b32 v187, v167, v166, s23
    v_perm_b32 v188, v161, v160, s24
    v_perm_b32 v189, v163, v162, s24
    v_perm_b32 v190, v165, v164, s24
    v_perm_b32 v191, v167, v166, s24
    buffer_load_dword v160, v10, s[12:15], s29 offen offset:0
    buffer_load_dword v161, v10, s[12:15], s29 offen offset:1024
    buffer_load_dword v162, v10, s[12:15], s29 offen offset:2048
    buffer_load_dword v163, v10, s[12:15], s29 offen offset:3072
    buffer_load_dword v164, v9, s[12:15], s29 offen offset:0
    buffer_load_dword v165, v9, s[12:15], s29 offen offset:1024
    buffer_load_dword v166, v9, s[12:15], s29 offen offset:2048
    buffer_load_dword v167, v9, s[12:15], s29 offen offset:3072
    s_add_u32 s29, s29, 16384
    v_accvgpr_write_b32 a120, v184
    v_accvgpr_write_b32 a121, v185
    v_accvgpr_write_b32 a122, v186
    v_accvgpr_write_b32 a123, v187
    v_accvgpr_write_b32 a124, v188
    v_accvgpr_write_b32 a125, v189
    v_accvgpr_write_b32 a126, v190
    v_accvgpr_write_b32 a127, v191
    s_waitcnt vmcnt(40)
    v_perm_b32 v184, v169, v168, s23
    v_perm_b32 v185, v171, v170, s23
    v_perm_b32 v186, v173, v172, s23
    v_perm_b32 v187, v175, v174, s23
    v_perm_b32 v188, v169, v168, s24
    v_perm_b32 v189, v171, v170, s24
    v_perm_b32 v190, v173, v172, s24
    v_perm_b32 v191, v175, v174, s24
    buffer_load_dword v168, v10, s[12:15], s29 offen offset:0
    buffer_load_dword v169, v10, s[12:15], s29 offen offset:1024
    buffer_load_dword v170, v10, s[12:15], s29 offen offset:2048
    buffer_load_dword v171, v10, s[12:15], s29 offen offset:3072
    buffer_load_dword v172, v9, s[12:15], s29 offen offset:0
    buffer_load_dword v173, v9, s[12:15], s29 offen offset:1024
    buffer_load_dword v174, v9, s[12:15], s29 offen offset:2048
    buffer_load_dword v175, v9, s[12:15], s29 offen offset:3072
    s_add_u32 s29, s29, 16384
    v_accvgpr_write_b32 a128, v184
    v_accvgpr_write_b32 a129, v185
    v_accvgpr_write_b32 a130, v186
    v_accvgpr_write_b32 a131, v187
    v_accvgpr_write_b32 a132, v188
    v_accvgpr_write_b32 a133, v189
    v_accvgpr_write_b32 a134, v190
    v_accvgpr_write_b32 a135, v191
    s_waitcnt vmcnt(40)
    v_perm_b32 v184, v177, v176, s23
    v_perm_b32 v185, v179, v178, s23
    v_perm_b32 v186, v181, v180, s23
    v_perm_b32 v187, v183, v182, s23
    v_perm_b32 v188, v177, v176, s24
    v_perm_b32 v189, v179, v178, s24
    v_perm_b32 v190, v181, v180, s24
    v_perm_b32 v191, v183, v182, s24
    buffer_load_dword v176, v10, s[12:15], s29 offen offset:0
    buffer_load_dword v177, v10, s[12:15], s29 offen offset:1024
    buffer_load_dword v178, v10, s[12:15], s29 offen offset:2048
    buffer_load_dword v179, v10, s[12:15], s29 offen offset:3072
    buffer_load_dword v180, v9, s[12:15], s29 offen offset:0
    buffer_load_dword v181, v9, s[12:15], s29 offen offset:1024
    buffer_load_dword v182, v9, s[12:15], s29 offen offset:2048
    buffer_load_dword v183, v9, s[12:15], s29 offen offset:3072
    s_add_u32 s29, s29, 16384
    v_accvgpr_write_b32 a136, v184
    v_accvgpr_write_b32 a137, v185
    v_accvgpr_write_b32 a138, v186
    v_accvgpr_write_b32 a139, v187
    v_accvgpr_write_b32 a140, v188
    v_accvgpr_write_b32 a141, v189
    v_accvgpr_write_b32 a142, v190
    v_accvgpr_write_b32 a143, v191
    s_waitcnt vmcnt(40)
    v_perm_b32 v184, v137, v136, s23
    v_perm_b32 v185, v139, v138, s23
    v_perm_b32 v186, v141, v140, s23
    v_perm_b32 v187, v143, v142, s23
    v_perm_b32 v188, v137, v136, s24
    v_perm_b32 v189, v139, v138, s24
    v_perm_b32 v190, v141, v140, s24
    v_perm_b32 v191, v143, v142, s24
    buffer_load_dword v136, v10, s[12:15], s29 offen offset:0
    buffer_load_dword v137, v10, s[12:15], s29 offen offset:1024
    buffer_load_dword v138, v10, s[12:15], s29 offen offset:2048
    buffer_load_dword v139, v10, s[12:15], s29 offen offset:3072
    buffer_load_dword v140, v9, s[12:15], s29 offen offset:0
    buffer_load_dword v141, v9, s[12:15], s29 offen offset:1024
    buffer_load_dword v142, v9, s[12:15], s29 offen offset:2048
    buffer_load_dword v143, v9, s[12:15], s29 offen offset:3072
    s_add_u32 s29, s29, 16384
    v_accvgpr_write_b32 a144, v184
    v_accvgpr_write_b32 a145, v185
    v_accvgpr_write_b32 a146, v186
    v_accvgpr_write_b32 a147, v187
    v_accvgpr_write_b32 a148, v188
    v_accvgpr_write_b32 a149, v189
    v_accvgpr_write_b32 a150, v190
    v_accvgpr_write_b32 a151, v191
    s_waitcnt vmcnt(40)
    v_perm_b32 v184, v145, v144, s23
    v_perm_b32 v185, v147, v146, s23
    v_perm_b32 v186, v149, v148, s23
    v_perm_b32 v187, v151, v150, s23
    v_perm_b32 v188, v145, v144, s24
    v_perm_b32 v189, v147, v146, s24
    v_perm_b32 v190, v149, v148, s24
    v_perm_b32 v191, v151, v150, s24
    buffer_load_dword v144, v10, s[12:15], s29 offen offset:0
    buffer_load_dword v145, v10, s[12:15], s29 offen offset:1024
    buffer_load_dword v146, v10, s[12:15], s29 offen offset:2048
    buffer_load_dword v147, v10, s[12:15], s29 offen offset:3072
    buffer_load_dword v148, v9, s[12:15], s29 offen offset:0
    buffer_load_dword v149, v9, s[12:15], s29 offen offset:1024
    buffer_load_dword v150, v9, s[12:15], s29 offen offset:2048
    buffer_load_dword v151, v9, s[12:15], s29 offen offset:3072
    s_add_u32 s29, s29, 16384
    v_accvgpr_write_b32 a152, v184
    v_accvgpr_write_b32 a153, v185
    v_accvgpr_write_b32 a154, v186
    v_accvgpr_write_b32 a155, v187
    v_accvgpr_write_b32 a156, v188
    v_accvgpr_write_b32 a157, v189
    v_accvgpr_write_b32 a158, v190
    v_accvgpr_write_b32 a159, v191
    s_waitcnt vmcnt(40)
    v_perm_b32 v184, v153, v152, s23
    v_perm_b32 v185, v155, v154, s23
    v_perm_b32 v186, v157, v156, s23
    v_perm_b32 v187, v159, v158, s23
    v_perm_b32 v188, v153, v152, s24
    v_perm_b32 v189, v155, v154, s24
    v_perm_b32 v190, v157, v156, s24
    v_perm_b32 v191, v159, v158, s24
    buffer_load_dword v152, v10, s[12:15], s29 offen offset:0
    buffer_load_dword v153, v10, s[12:15], s29 offen offset:1024
    buffer_load_dword v154, v10, s[12:15], s29 offen offset:2048
    buffer_load_dword v155, v10, s[12:15], s29 offen offset:3072
    buffer_load_dword v156, v9, s[12:15], s29 offen offset:0
    buffer_load_dword v157, v9, s[12:15], s29 offen offset:1024
    buffer_load_dword v158, v9, s[12:15], s29 offen offset:2048
    buffer_load_dword v159, v9, s[12:15], s29 offen offset:3072
    s_add_u32 s29, s29, 16384
    v_accvgpr_write_b32 a160, v184
    v_accvgpr_write_b32 a161, v185
    v_accvgpr_write_b32 a162, v186
    v_accvgpr_write_b32 a163, v187
    v_accvgpr_write_b32 a164, v188
    v_accvgpr_write_b32 a165, v189
    v_accvgpr_write_b32 a166, v190
    v_accvgpr_write_b32 a167, v191
    s_waitcnt vmcnt(40)
    v_perm_b32 v184, v161, v160, s23
    v_perm_b32 v185, v163, v162, s23
    v_perm_b32 v186, v165, v164, s23
    v_perm_b32 v187, v167, v166, s23
    v_perm_b32 v188, v161, v160, s24
    v_perm_b32 v189, v163, v162, s24
    v_perm_b32 v190, v165, v164, s24
    v_perm_b32 v191, v167, v166, s24
    buffer_load_dword v160, v10, s[12:15], s29 offen offset:0
    buffer_load_dword v161, v10, s[12:15], s29 offen offset:1024
    buffer_load_dword v162, v10, s[12:15], s29 offen offset:2048
    buffer_load_dword v163, v10, s[12:15], s29 offen offset:3072
    buffer_load_dword v164, v9, s[12:15], s29 offen offset:0
    buffer_load_dword v165, v9, s[12:15], s29 offen offset:1024
    buffer_load_dword v166, v9, s[12:15], s29 offen offset:2048
    buffer_load_dword v167, v9, s[12:15], s29 offen offset:3072
    s_add_u32 s29, s29, 16384
    v_accvgpr_write_b32 a168, v184
    v_accvgpr_write_b32 a169, v185
    v_accvgpr_write_b32 a170, v186
    v_accvgpr_write_b32 a171, v187
    v_accvgpr_write_b32 a172, v188
    v_accvgpr_write_b32 a173, v189
    v_accvgpr_write_b32 a174, v190
    v_accvgpr_write_b32 a175, v191
    s_waitcnt vmcnt(40)
    v_perm_b32 v184, v169, v168, s23
    v_perm_b32 v185, v171, v170, s23
    v_perm_b32 v186, v173, v172, s23
    v_perm_b32 v187, v175, v174, s23
    v_perm_b32 v188, v169, v168, s24
    v_perm_b32 v189, v171, v170, s24
    v_perm_b32 v190, v173, v172, s24
    v_perm_b32 v191, v175, v174, s24
    buffer_load_dword v168, v10, s[12:15], s29 offen offset:0
    buffer_load_dword v169, v10, s[12:15], s29 offen offset:1024
    buffer_load_dword v170, v10, s[12:15], s29 offen offset:2048
    buffer_load_dword v171, v10, s[12:15], s29 offen offset:3072
    buffer_load_dword v172, v9, s[12:15], s29 offen offset:0
    buffer_load_dword v173, v9, s[12:15], s29 offen offset:1024
    buffer_load_dword v174, v9, s[12:15], s29 offen offset:2048
    buffer_load_dword v175, v9, s[12:15], s29 offen offset:3072
    s_add_u32 s29, s29, 16384
    v_accvgpr_write_b32 a176, v184
    v_accvgpr_write_b32 a177, v185
    v_accvgpr_write_b32 a178, v186
    v_accvgpr_write_b32 a179, v187
    v_accvgpr_write_b32 a180, v188
    v_accvgpr_write_b32 a181, v189
    v_accvgpr_write_b32 a182, v190
    v_accvgpr_write_b32 a183, v191
    s_waitcnt vmcnt(40)
    v_perm_b32 v184, v177, v176, s23
    v_perm_b32 v185, v179, v178, s23
    v_perm_b32 v186, v181, v180, s23
    v_perm_b32 v187, v183, v182, s23
    v_perm_b32 v188, v177, v176, s24
    v_perm_b32 v189, v179, v178, s24
    v_perm_b32 v190, v181, v180, s24
    v_perm_b32 v191, v183, v182, s24
    buffer_load_dword v176, v10, s[12:15], s29 offen offset:0
    buffer_load_dword v177, v10, s[12:15], s29 offen offset:1024
    buffer_load_dword v178, v10, s[12:15], s29 offen offset:2048
    buffer_load_dword v179, v10, s[12:15], s29 offen offset:3072
    buffer_load_dword v180, v9, s[12:15], s29 offen offset:0
    buffer_load_dword v181, v9, s[12:15], s29 offen offset:1024
    buffer_load_dword v182, v9, s[12:15], s29 offen offset:2048
    buffer_load_dword v183, v9, s[12:15], s29 offen offset:3072
    s_add_u32 s29, s29, 16384
    v_accvgpr_write_b32 a184, v184
    v_accvgpr_write_b32 a185, v185
    v_accvgpr_write_b32 a186, v186
    v_accvgpr_write_b32 a187, v187
    v_accvgpr_write_b32 a188, v188
    v_accvgpr_write_b32 a189, v189
    v_accvgpr_write_b32 a190, v190
    v_accvgpr_write_b32 a191, v191
    s_waitcnt vmcnt(40)
    v_perm_b32 v184, v137, v136, s23
    v_perm_b32 v185, v139, v138, s23
    v_perm_b32 v186, v141, v140, s23
    v_perm_b32 v187, v143, v142, s23
    v_perm_b32 v188, v137, v136, s24
    v_perm_b32 v189, v139, v138, s24
    v_perm_b32 v190, v141, v140, s24
    v_perm_b32 v191, v143, v142, s24
    buffer_load_dword v136, v10, s[12:15], s29 offen offset:0
    buffer_load_dword v137, v10, s[12:15], s29 offen offset:1024
    buffer_load_dword v138, v10, s[12:15], s29 offen offset:2048
    buffer_load_dword v139, v10, s[12:15], s29 offen offset:3072
    buffer_load_dword v140, v9, s[12:15], s29 offen offset:0
    buffer_load_dword v141, v9, s[12:15], s29 offen offset:1024
    buffer_load_dword v142, v9, s[12:15], s29 offen offset:2048
    buffer_load_dword v143, v9, s[12:15], s29 offen offset:3072
    s_add_u32 s29, s29, 16384
    v_accvgpr_write_b32 a192, v184
    v_accvgpr_write_b32 a193, v185
    v_accvgpr_write_b32 a194, v186
    v_accvgpr_write_b32 a195, v187
    v_accvgpr_write_b32 a196, v188
    v_accvgpr_write_b32 a197, v189
    v_accvgpr_write_b32 a198, v190
    v_accvgpr_write_b32 a199, v191
    s_waitcnt vmcnt(40)
    v_perm_b32 v184, v145, v144, s23
    v_perm_b32 v185, v147, v146, s23
    v_perm_b32 v186, v149, v148, s23
    v_perm_b32 v187, v151, v150, s23
    v_perm_b32 v188, v145, v144, s24
    v_perm_b32 v189, v147, v146, s24
    v_perm_b32 v190, v149, v148, s24
    v_perm_b32 v191, v151, v150, s24
    buffer_load_dword v144, v10, s[12:15], s29 offen offset:0
    buffer_load_dword v145, v10, s[12:15], s29 offen offset:1024
    buffer_load_dword v146, v10, s[12:15], s29 offen offset:2048
    buffer_load_dword v147, v10, s[12:15], s29 offen offset:3072
    buffer_load_dword v148, v9, s[12:15], s29 offen offset:0
    buffer_load_dword v149, v9, s[12:15], s29 offen offset:1024
    buffer_load_dword v150, v9, s[12:15], s29 offen offset:2048
    buffer_load_dword v151, v9, s[12:15], s29 offen offset:3072
    s_add_u32 s29, s29, 16384
    v_accvgpr_write_b32 a200, v184
    v_accvgpr_write_b32 a201, v185
    v_accvgpr_write_b32 a202, v186
    v_accvgpr_write_b32 a203, v187
    v_accvgpr_write_b32 a204, v188
    v_accvgpr_write_b32 a205, v189
    v_accvgpr_write_b32 a206, v190
    v_accvgpr_write_b32 a207, v191
    s_waitcnt vmcnt(40)
    v_perm_b32 v184, v153, v152, s23
    v_perm_b32 v185, v155, v154, s23
    v_perm_b32 v186, v157, v156, s23
    v_perm_b32 v187, v159, v158, s23
    v_perm_b32 v188, v153, v152, s24
    v_perm_b32 v189, v155, v154, s24
    v_perm_b32 v190, v157, v156, s24
    v_perm_b32 v191, v159, v158, s24
    v_accvgpr_write_b32 a208, v184
    v_accvgpr_write_b32 a209, v185
    v_accvgpr_write_b32 a210, v186
    v_accvgpr_write_b32 a211, v187
    v_accvgpr_write_b32 a212, v188
    v_accvgpr_write_b32 a213, v189
    v_accvgpr_write_b32 a214, v190
    v_accvgpr_write_b32 a215, v191
    s_waitcnt vmcnt(32)
    v_perm_b32 v184, v161, v160, s23
    v_perm_b32 v185, v163, v162, s23
    v_perm_b32 v186, v165, v164, s23
    v_perm_b32 v187, v167, v166, s23
    v_perm_b32 v188, v161, v160, s24
    v_perm_b32 v189, v163, v162, s24
    v_perm_b32 v190, v165, v164, s24
    v_perm_b32 v191, v167, v166, s24
    v_accvgpr_write_b32 a216, v184
    v_accvgpr_write_b32 a217, v185
    v_accvgpr_write_b32 a218, v186
    v_accvgpr_write_b32 a219, v187
    v_accvgpr_write_b32 a220, v188
    v_accvgpr_write_b32 a221, v189
    v_accvgpr_write_b32 a222, v190
    v_accvgpr_write_b32 a223, v191
    s_waitcnt vmcnt(24)
    v_perm_b32 v184, v169, v168, s23
    v_perm_b32 v185, v171, v170, s23
    v_perm_b32 v186, v173, v172, s23
    v_perm_b32 v187, v175, v174, s23
    v_perm_b32 v188, v169, v168, s24
    v_perm_b32 v189, v171, v170, s24
    v_perm_b32 v190, v173, v172, s24
    v_perm_b32 v191, v175, v174, s24
    v_accvgpr_write_b32 a224, v184
    v_accvgpr_write_b32 a225, v185
    v_accvgpr_write_b32 a226, v186
    v_accvgpr_write_b32 a227, v187
    v_accvgpr_write_b32 a228, v188
    v_accvgpr_write_b32 a229, v189
    v_accvgpr_write_b32 a230, v190
    v_accvgpr_write_b32 a231, v191
    s_waitcnt vmcnt(16)
    v_perm_b32 v184, v177, v176, s23
    v_perm_b32 v185, v179, v178, s23
    v_perm_b32 v186, v181, v180, s23
    v_perm_b32 v187, v183, v182, s23
    v_perm_b32 v188, v177, v176, s24
    v_perm_b32 v189, v179, v178, s24
    v_perm_b32 v190, v181, v180, s24
    v_perm_b32 v191, v183, v182, s24
    v_accvgpr_write_b32 a232, v184
    v_accvgpr_write_b32 a233, v185
    v_accvgpr_write_b32 a234, v186
    v_accvgpr_write_b32 a235, v187
    v_accvgpr_write_b32 a236, v188
    v_accvgpr_write_b32 a237, v189
    v_accvgpr_write_b32 a238, v190
    v_accvgpr_write_b32 a239, v191
    s_waitcnt vmcnt(8)
    v_perm_b32 v184, v137, v136, s23
    v_perm_b32 v185, v139, v138, s23
    v_perm_b32 v186, v141, v140, s23
    v_perm_b32 v187, v143, v142, s23
    v_perm_b32 v188, v137, v136, s24
    v_perm_b32 v189, v139, v138, s24
    v_perm_b32 v190, v141, v140, s24
    v_perm_b32 v191, v143, v142, s24
    v_accvgpr_write_b32 a240, v184
    v_accvgpr_write_b32 a241, v185
    v_accvgpr_write_b32 a242, v186
    v_accvgpr_write_b32 a243, v187
    v_accvgpr_write_b32 a244, v188
    v_accvgpr_write_b32 a245, v189
    v_accvgpr_write_b32 a246, v190
    v_accvgpr_write_b32 a247, v191
    s_waitcnt vmcnt(0)
    v_perm_b32 v184, v145, v144, s23
    v_perm_b32 v185, v147, v146, s23
    v_perm_b32 v186, v149, v148, s23
    v_perm_b32 v187, v151, v150, s23
    v_perm_b32 v188, v145, v144, s24
    v_perm_b32 v189, v147, v146, s24
    v_perm_b32 v190, v149, v148, s24
    v_perm_b32 v191, v151, v150, s24
    v_accvgpr_write_b32 a248, v184
    v_accvgpr_write_b32 a249, v185
    v_accvgpr_write_b32 a250, v186
    v_accvgpr_write_b32 a251, v187
    v_accvgpr_write_b32 a252, v188
    v_accvgpr_write_b32 a253, v189
    v_accvgpr_write_b32 a254, v190
    v_accvgpr_write_b32 a255, v191
    v_and_b32 v8, 12, v1
    v_and_b32 v9, 15, v1
    v_add_u32 v8, v8, v9
    v_lshrrev_b32 v9, 4, v1
    v_lshlrev_b32 v10, 3, v9
    v_sub_u32 v8, v8, v10
    v_cmp_le_i32 s[32:33], -4, v8
    v_cmp_le_i32 s[34:35], -3, v8
    v_cmp_le_i32 s[36:37], -2, v8
    v_cmp_le_i32 s[38:39], -1, v8
    v_cmp_le_i32 s[40:41], 0, v8
    v_cmp_le_i32 s[42:43], 1, v8
    v_cmp_le_i32 s[44:45], 2, v8
    v_cmp_le_i32 s[46:47], 3, v8
    v_cmp_le_i32 s[48:49], 4, v8
    v_cmp_le_i32 s[50:51], 5, v8
    v_cmp_le_i32 s[52:53], 6, v8
    v_cmp_le_i32 s[54:55], 7, v8
    v_mov_b32 v7, 0xff7fffff
    v_mov_b32 v12, 0x3f803f80
    v_mov_b32 v13, 0x3f803f80
    v_mov_b32 v14, 0x3f803f80
    v_mov_b32 v15, 0x3f803f80
    v_lshlrev_b32 v4, 9, v9
    v_and_b32 v8, 15, v1
    v_lshl_add_u32 v4, v8, 4, v4
    s_lshl_b32 s20, s4, 13
    v_add_u32 v4, s20, v4
    v_mov_b32 v5, v2
    v_and_b32 v8, 3, v1
    v_bfe_u32 v9, v1, 2, 2
    v_lshl_add_u32 v8, v9, 3, v8
    v_bfe_u32 v9, v1, 4, 1
    v_lshl_add_u32 v8, v9, 2, v8
    v_lshrrev_b32 v9, 5, v1
    v_lshlrev_b32 v9, 9, v9
    v_lshl_add_u32 v6, v8, 4, v9
    s_lshl_b32 s20, s5, 6
    s_add_u32 s20, s20, s7
    s_lshl_b32 s20, s20, 3
    s_lshl_b32 s21, s6, 2
    s_add_u32 s20, s20, s21
    s_add_u32 s20, s20, s4
    s_lshl_b32 s29, s20, 12
    s_add_u32 s29, s29, 83886080
    s_mov_b32 s30, 0
    s_add_u32 s60, s7, 1
L_aw_loop:
    s_mov_b64 exec, 7
    s_mov_b32 s59, 400000
L_awq_14:
    buffer_load_dword v8, v2, s[8:11], s56 offen sc1
    s_waitcnt vmcnt(0)
    v_cmp_eq_u32 vcc, 0, v8
    s_cbranch_vccz L_awqd_15
    s_sub_u32 s59, s59, 1
    s_cbranch_scc1 L_m_fail
    s_sleep 8
    s_branch L_awq_14
L_awqd_15:
    s_mov_b64 exec, -1
    s_add_u32 s56, s56, 4096
    buffer_load_dwordx4 v[16:19], v2, s[8:11], s25 offen offset:0 sc1
    buffer_load_dwordx4 v[20:23], v2, s[8:11], s25 offen offset:1024 sc1
    buffer_load_dwordx4 v[24:27], v2, s[8:11], s25 offen offset:2048 sc1
    buffer_load_dwordx4 v[28:31], v2, s[8:11], s25 offen offset:3072 sc1
    s_add_u32 s20, s25, 4096
    buffer_load_dwordx4 v[32:35], v2, s[8:11], s20 offen offset:0 sc1
    buffer_load_dwordx4 v[36:39], v2, s[8:11], s20 offen offset:1024 sc1
    buffer_load_dwordx4 v[40:43], v2, s[8:11], s20 offen offset:2048 sc1
    buffer_load_dwordx4 v[44:47], v2, s[8:11], s20 offen offset:3072 sc1
    buffer_load_dwordx4 v[48:51], v2, s[8:11], s26 offen offset:0 sc1
    buffer_load_dwordx4 v[52:55], v2, s[8:11], s26 offen offset:1024 sc1
    buffer_load_dwordx4 v[56:59], v2, s[8:11], s26 offen offset:2048 sc1
    buffer_load_dwordx4 v[60:63], v2, s[8:11], s26 offen offset:3072 sc1
    s_add_u32 s20, s26, 4096
    buffer_load_dwordx4 v[64:67], v2, s[8:11], s20 offen offset:0 sc1
    buffer_load_dwordx4 v[68:71], v2, s[8:11], s20 offen offset:1024 sc1
    buffer_load_dwordx4 v[72:75], v2, s[8:11], s20 offen offset:2048 sc1
    buffer_load_dwordx4 v[76:79], v2, s[8:11], s20 offen offset:3072 sc1
    buffer_load_dwordx4 v[80:83], v2, s[8:11], s27 offen offset:0 sc1
    buffer_load_dwordx4 v[84:87], v2, s[8:11], s27 offen offset:1024 sc1
    buffer_load_dwordx4 v[88:91], v2, s[8:11], s27 offen offset:2048 sc1
    buffer_load_dwordx4 v[92:95], v2, s[8:11], s27 offen offset:3072 sc1
    s_add_u32 s20, s27, 4096
    buffer_load_dwordx4 v[96:99], v2, s[8:11], s20 offen offset:0 sc1
    buffer_load_dwordx4 v[100:103], v2, s[8:11], s20 offen offset:1024 sc1
    buffer_load_dwordx4 v[104:107], v2, s[8:11], s20 offen offset:2048 sc1
    buffer_load_dwordx4 v[108:111], v2, s[8:11], s20 offen offset:3072 sc1
    s_add_u32 s25, s25, 1048576
    s_add_u32 s26, s26, 1048576
    s_add_u32 s27, s27, 1048576
    s_waitcnt vmcnt(8)
    v_mfma_f32_16x16x32_bf16 v[136:139], v[48:51], v[16:19], 0
    v_mfma_f32_16x16x32_bf16 v[140:143], v[64:67], v[16:19], 0
    v_mfma_f32_16x16x32_bf16 v[148:151], v[48:51], v[32:35], 0
    v_mfma_f32_16x16x32_bf16 v[152:155], v[64:67], v[32:35], 0
    v_mfma_f32_16x16x32_bf16 v[136:139], v[52:55], v[20:23], v[136:139]
    v_mfma_f32_16x16x32_bf16 v[140:143], v[68:71], v[20:23], v[140:143]
    v_mfma_f32_16x16x32_bf16 v[148:151], v[52:55], v[36:39], v[148:151]
    v_mfma_f32_16x16x32_bf16 v[152:155], v[68:71], v[36:39], v[152:155]
    v_mfma_f32_16x16x32_bf16 v[136:139], v[56:59], v[24:27], v[136:139]
    v_mfma_f32_16x16x32_bf16 v[140:143], v[72:75], v[24:27], v[140:143]
    v_mfma_f32_16x16x32_bf16 v[148:151], v[56:59], v[40:43], v[148:151]
    v_mfma_f32_16x16x32_bf16 v[152:155], v[72:75], v[40:43], v[152:155]
    v_mfma_f32_16x16x32_bf16 v[136:139], v[60:63], v[28:31], v[136:139]
    v_mfma_f32_16x16x32_bf16 v[140:143], v[76:79], v[28:31], v[140:143]
    v_mfma_f32_16x16x32_bf16 v[148:151], v[60:63], v[44:47], v[148:151]
    v_mfma_f32_16x16x32_bf16 v[152:155], v[76:79], v[44:47], v[152:155]
    s_mov_b64 exec, 1
    s_mov_b32 s59, 400000
L_awm_16:
    buffer_load_dword v8, v2, s[8:11], s57 offen sc1
    s_waitcnt vmcnt(0)
    v_cmp_gt_u32 vcc, s60, v8
    s_cbranch_vccz L_awmd_17
    s_sub_u32 s59, s59, 1
    s_cbranch_scc1 L_m_fail
    s_sleep 2
    s_cmp_ge_u32 s30, 14
    s_cbranch_scc1 L_awm_16
    s_sleep 64
    s_branch L_awm_16
L_awmd_17:
    s_mov_b64 exec, -1
    buffer_load_dword v112, v3, s[8:11], s28 offen offset:0 sc1
    buffer_load_dword v113, v3, s[8:11], s28 offen offset:16 sc1
    buffer_load_dword v114, v3, s[8:11], s28 offen offset:32 sc1
    buffer_load_dword v115, v3, s[8:11], s28 offen offset:48 sc1
    buffer_load_dword v116, v3, s[8:11], s28 offen offset:1024 sc1
    buffer_load_dword v117, v3, s[8:11], s28 offen offset:1040 sc1
    buffer_load_dword v118, v3, s[8:11], s28 offen offset:1056 sc1
    buffer_load_dword v119, v3, s[8:11], s28 offen offset:1072 sc1
    buffer_load_dword v120, v3, s[8:11], s28 offen offset:2048 sc1
    buffer_load_dword v121, v3, s[8:11], s28 offen offset:2064 sc1
    buffer_load_dword v122, v3, s[8:11], s28 offen offset:2080 sc1
    buffer_load_dword v123, v3, s[8:11], s28 offen offset:2096 sc1
    buffer_load_dword v124, v3, s[8:11], s28 offen offset:3072 sc1
    buffer_load_dword v125, v3, s[8:11], s28 offen offset:3088 sc1
    buffer_load_dword v126, v3, s[8:11], s28 offen offset:3104 sc1
    buffer_load_dword v127, v3, s[8:11], s28 offen offset:3120 sc1
    buffer_load_dwordx2 v[128:129], v2, s[8:11], s28 offen offset:8 sc1
    buffer_load_dwordx2 v[130:131], v2, s[8:11], s28 offen offset:1032 sc1
    buffer_load_dwordx2 v[132:133], v2, s[8:11], s28 offen offset:2056 sc1
    buffer_load_dwordx2 v[134:135], v2, s[8:11], s28 offen offset:3080 sc1
    s_add_u32 s28, s28, 524288
    v_cndmask_b32 v136, v7, v136, s[40:41]
    v_cndmask_b32 v137, v7, v137, s[42:43]
    v_cndmask_b32 v138, v7, v138, s[44:45]
    v_cndmask_b32 v139, v7, v139, s[46:47]
    v_cndmask_b32 v140, v7, v140, s[48:49]
    v_cndmask_b32 v141, v7, v141, s[50:51]
    v_cndmask_b32 v142, v7, v142, s[52:53]
    v_cndmask_b32 v143, v7, v143, s[54:55]
    v_cndmask_b32 v148, v7, v148, s[32:33]
    v_cndmask_b32 v149, v7, v149, s[34:35]
    v_cndmask_b32 v150, v7, v150, s[36:37]
    v_cndmask_b32 v151, v7, v151, s[38:39]
    v_cndmask_b32 v152, v7, v152, s[40:41]
    v_cndmask_b32 v153, v7, v153, s[42:43]
    v_cndmask_b32 v154, v7, v154, s[44:45]
    v_cndmask_b32 v155, v7, v155, s[46:47]
    v_max3_f32 v8, v136, v137, v138
    v_max3_f32 v10, v139, v140, v141
    v_max3_f32 v8, v8, v142, v143
    v_max_f32 v8, v8, v10
    v_max3_f32 v9, v148, v149, v150
    v_max3_f32 v11, v151, v152, v153
    v_max3_f32 v9, v9, v154, v155
    v_max_f32 v9, v9, v11
    s_waitcnt vmcnt(4)
    v_mfma_f32_16x16x32_bf16 v[144:147], v[112:115], v[16:19], 0
    v_mfma_f32_16x16x32_bf16 v[156:159], v[112:115], v[32:35], 0
    v_mfma_f32_16x16x32_bf16 v[144:147], v[116:119], v[20:23], v[144:147]
    v_mfma_f32_16x16x32_bf16 v[156:159], v[116:119], v[36:39], v[156:159]
    v_mfma_f32_16x16x32_bf16 v[144:147], v[120:123], v[24:27], v[144:147]
    v_mfma_f32_16x16x32_bf16 v[156:159], v[120:123], v[40:43], v[156:159]
    v_mfma_f32_16x16x32_bf16 v[144:147], v[124:127], v[28:31], v[144:147]
    v_mfma_f32_16x16x32_bf16 v[156:159], v[124:127], v[44:47], v[156:159]
    s_nop 7
    v_max3_f32 v8, v8, v144, v145
    v_max3_f32 v9, v9, v156, v157
    v_mov_b32 v10, v8
    v_mov_b32 v11, v9
    s_nop 1
    v_permlane16_swap_b32 v8, v10
    v_permlane16_swap_b32 v9, v11
    v_max_f32 v8, v8, v10
    v_max_f32 v9, v9, v11
    v_mov_b32 v10, v8
    v_mov_b32 v11, v9
    s_nop 1
    v_permlane32_swap_b32 v8, v10
    v_permlane32_swap_b32 v9, v11
    v_max_f32 v8, v8, v10
    v_max_f32 v9, v9, v11
    v_mul_f32 v8, s22, v8
    v_mul_f32 v9, s22, v9
    v_fma_f32 v136, v136, s22, -v8
    v_fma_f32 v137, v137, s22, -v8
    v_fma_f32 v138, v138, s22, -v8
    v_fma_f32 v139, v139, s22, -v8
    v_fma_f32 v140, v140, s22, -v8
    v_fma_f32 v141, v141, s22, -v8
    v_fma_f32 v142, v142, s22, -v8
    v_fma_f32 v143, v143, s22, -v8
    v_fma_f32 v144, v144, s22, -v8
    v_fma_f32 v145, v145, s22, -v8
    v_exp_f32 v136, v136
    v_exp_f32 v137, v137
    v_exp_f32 v138, v138
    v_exp_f32 v139, v139
    v_exp_f32 v140, v140
    v_exp_f32 v141, v141
    v_exp_f32 v142, v142
    v_exp_f32 v143, v143
    v_exp_f32 v144, v144
    v_exp_f32 v145, v145
    v_fma_f32 v148, v148, s22, -v9
    v_fma_f32 v149, v149, s22, -v9
    v_fma_f32 v150, v150, s22, -v9
    v_fma_f32 v151, v151, s22, -v9
    v_fma_f32 v152, v152, s22, -v9
    v_fma_f32 v153, v153, s22, -v9
    v_fma_f32 v154, v154, s22, -v9
    v_fma_f32 v155, v155, s22, -v9
    v_fma_f32 v156, v156, s22, -v9
    v_fma_f32 v157, v157, s22, -v9
    v_exp_f32 v148, v148
    v_exp_f32 v149, v149
    v_exp_f32 v150, v150
    v_exp_f32 v151, v151
    v_exp_f32 v152, v152
    v_exp_f32 v153, v153
    v_exp_f32 v154, v154
    v_exp_f32 v155, v155
    v_exp_f32 v156, v156
    v_exp_f32 v157, v157
    s_nop 0
    v_cvt_pk_bf16_f32 v136, v136, v137
    v_cvt_pk_bf16_f32 v137, v138, v139
    v_cvt_pk_bf16_f32 v138, v140, v141
    v_cvt_pk_bf16_f32 v139, v142, v143
    v_cvt_pk_bf16_f32 v160, v144, v145
    v_mov_b32 v161, 0
    v_mov_b32 v162, 0
    v_mov_b32 v163, v160
    v_cvt_pk_bf16_f32 v148, v148, v149
    v_cvt_pk_bf16_f32 v149, v150, v151
    v_cvt_pk_bf16_f32 v150, v152, v153
    v_cvt_pk_bf16_f32 v151, v154, v155
    v_cvt_pk_bf16_f32 v164, v156, v157
    v_mov_b32 v165, 0
    v_mov_b32 v166, 0
    v_mov_b32 v167, v164
    s_waitcnt vmcnt(0)
    s_nop 0
    v_mfma_f32_16x16x32_bf16 v[184:187], v[12:15], v[136:139], 0
    v_mfma_f32_16x16x32_bf16 v[188:191], v[12:15], v[148:151], 0
    v_mfma_f32_16x16x16_bf16 v[184:187], v[12:13], v[160:161], v[184:187]
    v_mfma_f32_16x16x16_bf16 v[188:191], v[12:13], v[164:165], v[188:191]
    v_mfma_f32_16x16x32_bf16 v[168:171], v[80:83], v[136:139], 0
    v_mfma_f32_16x16x32_bf16 v[172:175], v[84:87], v[136:139], 0
    v_mfma_f32_16x16x16_bf16 v[168:171], v[128:129], v[160:161], v[168:171]
    v_mfma_f32_16x16x16_bf16 v[172:175], v[128:129], v[162:163], v[172:175]
    s_nop 3
    v_rcp_f32 v184, v184
    v_rcp_f32 v188, v188
    v_mfma_f32_16x16x32_bf16 v[176:179], v[88:91], v[136:139], 0
    v_mfma_f32_16x16x32_bf16 v[180:183], v[92:95], v[136:139], 0
    v_mfma_f32_16x16x16_bf16 v[176:179], v[130:131], v[160:161], v[176:179]
    v_mfma_f32_16x16x16_bf16 v[180:183], v[130:131], v[162:163], v[180:183]
    s_nop 3
    v_mul_f32 v168, v168, v184
    v_mul_f32 v169, v169, v184
    v_mul_f32 v170, v170, v184
    v_mul_f32 v171, v171, v184
    v_mul_f32 v172, v172, v184
    v_mul_f32 v173, v173, v184
    v_mul_f32 v174, v174, v184
    v_mul_f32 v175, v175, v184
    v_cvt_pk_bf16_f32 v192, v168, v172
    v_cvt_pk_bf16_f32 v193, v169, v173
    v_cvt_pk_bf16_f32 v194, v170, v174
    v_cvt_pk_bf16_f32 v195, v171, v175
    ds_write_b128 v4, v[192:195] offset:0
    v_mfma_f32_16x16x32_bf16 v[168:171], v[96:99], v[136:139], 0
    v_mfma_f32_16x16x32_bf16 v[172:175], v[100:103], v[136:139], 0
    v_mfma_f32_16x16x16_bf16 v[168:171], v[132:133], v[160:161], v[168:171]
    v_mfma_f32_16x16x16_bf16 v[172:175], v[132:133], v[162:163], v[172:175]
    s_nop 3
    v_mul_f32 v176, v176, v184
    v_mul_f32 v177, v177, v184
    v_mul_f32 v178, v178, v184
    v_mul_f32 v179, v179, v184
    v_mul_f32 v180, v180, v184
    v_mul_f32 v181, v181, v184
    v_mul_f32 v182, v182, v184
    v_mul_f32 v183, v183, v184
    v_cvt_pk_bf16_f32 v196, v176, v180
    v_cvt_pk_bf16_f32 v197, v177, v181
    v_cvt_pk_bf16_f32 v198, v178, v182
    v_cvt_pk_bf16_f32 v199, v179, v183
    ds_write_b128 v4, v[196:199] offset:2048
    v_mfma_f32_16x16x32_bf16 v[176:179], v[104:107], v[136:139], 0
    v_mfma_f32_16x16x32_bf16 v[180:183], v[108:111], v[136:139], 0
    v_mfma_f32_16x16x16_bf16 v[176:179], v[134:135], v[160:161], v[176:179]
    v_mfma_f32_16x16x16_bf16 v[180:183], v[134:135], v[162:163], v[180:183]
    s_nop 3
    v_mul_f32 v168, v168, v184
    v_mul_f32 v169, v169, v184
    v_mul_f32 v170, v170, v184
    v_mul_f32 v171, v171, v184
    v_mul_f32 v172, v172, v184
    v_mul_f32 v173, v173, v184
    v_mul_f32 v174, v174, v184
    v_mul_f32 v175, v175, v184
    v_cvt_pk_bf16_f32 v192, v168, v172
    v_cvt_pk_bf16_f32 v193, v169, v173
    v_cvt_pk_bf16_f32 v194, v170, v174
    v_cvt_pk_bf16_f32 v195, v171, v175
    ds_write_b128 v4, v[192:195] offset:4096
    v_mfma_f32_16x16x32_bf16 v[168:171], v[80:83], v[148:151], 0
    v_mfma_f32_16x16x32_bf16 v[172:175], v[84:87], v[148:151], 0
    v_mfma_f32_16x16x16_bf16 v[168:171], v[128:129], v[164:165], v[168:171]
    v_mfma_f32_16x16x16_bf16 v[172:175], v[128:129], v[166:167], v[172:175]
    s_nop 3
    v_mul_f32 v176, v176, v184
    v_mul_f32 v177, v177, v184
    v_mul_f32 v178, v178, v184
    v_mul_f32 v179, v179, v184
    v_mul_f32 v180, v180, v184
    v_mul_f32 v181, v181, v184
    v_mul_f32 v182, v182, v184
    v_mul_f32 v183, v183, v184
    v_cvt_pk_bf16_f32 v196, v176, v180
    v_cvt_pk_bf16_f32 v197, v177, v181
    v_cvt_pk_bf16_f32 v198, v178, v182
    v_cvt_pk_bf16_f32 v199, v179, v183
    ds_write_b128 v4, v[196:199] offset:6144
    v_mfma_f32_16x16x32_bf16 v[176:179], v[88:91], v[148:151], 0
    v_mfma_f32_16x16x32_bf16 v[180:183], v[92:95], v[148:151], 0
    v_mfma_f32_16x16x16_bf16 v[176:179], v[130:131], v[164:165], v[176:179]
    v_mfma_f32_16x16x16_bf16 v[180:183], v[130:131], v[166:167], v[180:183]
    s_nop 3
    v_mul_f32 v168, v168, v188
    v_mul_f32 v169, v169, v188
    v_mul_f32 v170, v170, v188
    v_mul_f32 v171, v171, v188
    v_mul_f32 v172, v172, v188
    v_mul_f32 v173, v173, v188
    v_mul_f32 v174, v174, v188
    v_mul_f32 v175, v175, v188
    v_cvt_pk_bf16_f32 v192, v168, v172
    v_cvt_pk_bf16_f32 v193, v169, v173
    v_cvt_pk_bf16_f32 v194, v170, v174
    v_cvt_pk_bf16_f32 v195, v171, v175
    ds_write_b128 v4, v[192:195] offset:256
    v_mfma_f32_16x16x32_bf16 v[168:171], v[96:99], v[148:151], 0
    v_mfma_f32_16x16x32_bf16 v[172:175], v[100:103], v[148:151], 0
    v_mfma_f32_16x16x16_bf16 v[168:171], v[132:133], v[164:165], v[168:171]
    v_mfma_f32_16x16x16_bf16 v[172:175], v[132:133], v[166:167], v[172:175]
    s_nop 3
    v_mul_f32 v176, v176, v188
    v_mul_f32 v177, v177, v188
    v_mul_f32 v178, v178, v188
    v_mul_f32 v179, v179, v188
    v_mul_f32 v180, v180, v188
    v_mul_f32 v181, v181, v188
    v_mul_f32 v182, v182, v188
    v_mul_f32 v183, v183, v188
    v_cvt_pk_bf16_f32 v196, v176, v180
    v_cvt_pk_bf16_f32 v197, v177, v181
    v_cvt_pk_bf16_f32 v198, v178, v182
    v_cvt_pk_bf16_f32 v199, v179, v183
    ds_write_b128 v4, v[196:199] offset:2304
    v_mfma_f32_16x16x32_bf16 v[176:179], v[104:107], v[148:151], 0
    v_mfma_f32_16x16x32_bf16 v[180:183], v[108:111], v[148:151], 0
    v_mfma_f32_16x16x16_bf16 v[176:179], v[134:135], v[164:165], v[176:179]
    v_mfma_f32_16x16x16_bf16 v[180:183], v[134:135], v[166:167], v[180:183]
    s_nop 3
    v_mul_f32 v168, v168, v188
    v_mul_f32 v169, v169, v188
    v_mul_f32 v170, v170, v188
    v_mul_f32 v171, v171, v188
    v_mul_f32 v172, v172, v188
    v_mul_f32 v173, v173, v188
    v_mul_f32 v174, v174, v188
    v_mul_f32 v175, v175, v188
    v_cvt_pk_bf16_f32 v192, v168, v172
    v_cvt_pk_bf16_f32 v193, v169, v173
    v_cvt_pk_bf16_f32 v194, v170, v174
    v_cvt_pk_bf16_f32 v195, v171, v175
    ds_write_b128 v4, v[192:195] offset:4352
    s_nop 7
    s_nop 3
    v_mul_f32 v176, v176, v188
    v_mul_f32 v177, v177, v188
    v_mul_f32 v178, v178, v188
    v_mul_f32 v179, v179, v188
    v_mul_f32 v180, v180, v188
    v_mul_f32 v181, v181, v188
    v_mul_f32 v182, v182, v188
    v_mul_f32 v183, v183, v188
    v_cvt_pk_bf16_f32 v196, v176, v180
    v_cvt_pk_bf16_f32 v197, v177, v181
    v_cvt_pk_bf16_f32 v198, v178, v182
    v_cvt_pk_bf16_f32 v199, v179, v183
    ds_write_b128 v4, v[196:199] offset:6400
    s_waitcnt lgkmcnt(0)
    s_barrier
    ds_read_b128 v[232:235], v5 offset:0
    ds_read_b128 v[236:239], v5 offset:1024
    ds_read_b128 v[240:243], v5 offset:2048
    ds_read_b128 v[244:247], v5 offset:3072
    s_waitcnt lgkmcnt(3)
    v_mfma_f32_32x32x16_bf16 v[200:215], a[0:3], v[232:235], 0
    v_mfma_f32_32x32x16_bf16 v[216:231], a[4:7], v[232:235], 0
    ds_read_b128 v[232:235], v5 offset:4096
    s_waitcnt lgkmcnt(3)
    v_mfma_f32_32x32x16_bf16 v[200:215], a[8:11], v[236:239], v[200:215]
    v_mfma_f32_32x32x16_bf16 v[216:231], a[12:15], v[236:239], v[216:231]
    ds_read_b128 v[236:239], v5 offset:5120
    s_waitcnt lgkmcnt(3)
    v_mfma_f32_32x32x16_bf16 v[200:215], a[16:19], v[240:243], v[200:215]
    v_mfma_f32_32x32x16_bf16 v[216:231], a[20:23], v[240:243], v[216:231]
    ds_read_b128 v[240:243], v5 offset:6144
    s_waitcnt lgkmcnt(3)
    v_mfma_f32_32x32x16_bf16 v[200:215], a[24:27], v[244:247], v[200:215]
    v_mfma_f32_32x32x16_bf16 v[216:231], a[28:31], v[244:247], v[216:231]
    ds_read_b128 v[244:247], v5 offset:7168
    s_waitcnt lgkmcnt(3)
    v_mfma_f32_32x32x16_bf16 v[200:215], a[32:35], v[232:235], v[200:215]
    v_mfma_f32_32x32x16_bf16 v[216:231], a[36:39], v[232:235], v[216:231]
    ds_read_b128 v[232:235], v5 offset:8192
    s_waitcnt lgkmcnt(3)
    v_mfma_f32_32x32x16_bf16 v[200:215], a[40:43], v[236:239], v[200:215]
    v_mfma_f32_32x32x16_bf16 v[216:231], a[44:47], v[236:239], v[216:231]
    ds_read_b128 v[236:239], v5 offset:9216
    s_waitcnt lgkmcnt(3)
    v_mfma_f32_32x32x16_bf16 v[200:215], a[48:51], v[240:243], v[200:215]
    v_mfma_f32_32x32x16_bf16 v[216:231], a[52:55], v[240:243], v[216:231]
    ds_read_b128 v[240:243], v5 offset:10240
    s_waitcnt lgkmcnt(3)
    v_mfma_f32_32x32x16_bf16 v[200:215], a[56:59], v[244:247], v[200:215]
    v_mfma_f32_32x32x16_bf16 v[216:231], a[60:63], v[244:247], v[216:231]
    ds_read_b128 v[244:247], v5 offset:11264
    s_waitcnt lgkmcnt(3)
    v_mfma_f32_32x32x16_bf16 v[200:215], a[64:67], v[232:235], v[200:215]
    v_mfma_f32_32x32x16_bf16 v[216:231], a[68:71], v[232:235], v[216:231]
    ds_read_b128 v[232:235], v5 offset:12288
    s_waitcnt lgkmcnt(3)
    v_mfma_f32_32x32x16_bf16 v[200:215], a[72:75], v[236:239], v[200:215]
    v_mfma_f32_32x32x16_bf16 v[216:231], a[76:79], v[236:239], v[216:231]
    ds_read_b128 v[236:239], v5 offset:13312
    s_waitcnt lgkmcnt(3)
    v_mfma_f32_32x32x16_bf16 v[200:215], a[80:83], v[240:243], v[200:215]
    v_mfma_f32_32x32x16_bf16 v[216:231], a[84:87], v[240:243], v[216:231]
    ds_read_b128 v[240:243], v5 offset:14336
    s_waitcnt lgkmcnt(3)
    v_mfma_f32_32x32x16_bf16 v[200:215], a[88:91], v[244:247], v[200:215]
    v_mfma_f32_32x32x16_bf16 v[216:231], a[92:95], v[244:247], v[216:231]
    ds_read_b128 v[244:247], v5 offset:15360
    s_waitcnt lgkmcnt(3)
    v_mfma_f32_32x32x16_bf16 v[200:215], a[96:99], v[232:235], v[200:215]
    v_mfma_f32_32x32x16_bf16 v[216:231], a[100:103], v[232:235], v[216:231]
    ds_read_b128 v[232:235], v5 offset:16384
    s_waitcnt lgkmcnt(3)
    v_mfma_f32_32x32x16_bf16 v[200:215], a[104:107], v[236:239], v[200:215]
    v_mfma_f32_32x32x16_bf16 v[216:231], a[108:111], v[236:239], v[216:231]
    ds_read_b128 v[236:239], v5 offset:17408
    s_waitcnt lgkmcnt(3)
    v_mfma_f32_32x32x16_bf16 v[200:215], a[112:115], v[240:243], v[200:215]
    v_mfma_f32_32x32x16_bf16 v[216:231], a[116:119], v[240:243], v[216:231]
    ds_read_b128 v[240:243], v5 offset:18432
    s_waitcnt lgkmcnt(3)
    v_mfma_f32_32x32x16_bf16 v[200:215], a[120:123], v[244:247], v[200:215]
    v_mfma_f32_32x32x16_bf16 v[216:231], a[124:127], v[244:247], v[216:231]
    ds_read_b128 v[244:247], v5 offset:19456
    s_waitcnt lgkmcnt(3)
    v_mfma_f32_32x32x16_bf16 v[200:215], a[128:131], v[232:235], v[200:215]
    v_mfma_f32_32x32x16_bf16 v[216:231], a[132:135], v[232:235], v[216:231]
    ds_read_b128 v[232:235], v5 offset:20480
    s_waitcnt lgkmcnt(3)
    v_mfma_f32_32x32x16_bf16 v[200:215], a[136:139], v[236:239], v[200:215]
    v_mfma_f32_32x32x16_bf16 v[216:231], a[140:143], v[236:239], v[216:231]
    ds_read_b128 v[236:239], v5 offset:21504
    s_waitcnt lgkmcnt(3)
    v_mfma_f32_32x32x16_bf16 v[200:215], a[144:147], v[240:243], v[200:215]
    v_mfma_f32_32x32x16_bf16 v[216:231], a[148:151], v[240:243], v[216:231]
    ds_read_b128 v[240:243], v5 offset:22528
    s_waitcnt lgkmcnt(3)
    v_mfma_f32_32x32x16_bf16 v[200:215], a[152:155], v[244:247], v[200:215]
    v_mfma_f32_32x32x16_bf16 v[216:231], a[156:159], v[244:247], v[216:231]
    ds_read_b128 v[244:247], v5 offset:23552
    s_waitcnt lgkmcnt(3)
    v_mfma_f32_32x32x16_bf16 v[200:215], a[160:163], v[232:235], v[200:215]
    v_mfma_f32_32x32x16_bf16 v[216:231], a[164:167], v[232:235], v[216:231]
    ds_read_b128 v[232:235], v5 offset:24576
    s_waitcnt lgkmcnt(3)
    v_mfma_f32_32x32x16_bf16 v[200:215], a[168:171], v[236:239], v[200:215]
    v_mfma_f32_32x32x16_bf16 v[216:231], a[172:175], v[236:239], v[216:231]
    ds_read_b128 v[236:239], v5 offset:25600
    s_waitcnt lgkmcnt(3)
    v_mfma_f32_32x32x16_bf16 v[200:215], a[176:179], v[240:243], v[200:215]
    v_mfma_f32_32x32x16_bf16 v[216:231], a[180:183], v[240:243], v[216:231]
    ds_read_b128 v[240:243], v5 offset:26624
    s_waitcnt lgkmcnt(3)
    v_mfma_f32_32x32x16_bf16 v[200:215], a[184:187], v[244:247], v[200:215]
    v_mfma_f32_32x32x16_bf16 v[216:231], a[188:191], v[244:247], v[216:231]
    ds_read_b128 v[244:247], v5 offset:27648
    s_waitcnt lgkmcnt(3)
    v_mfma_f32_32x32x16_bf16 v[200:215], a[192:195], v[232:235], v[200:215]
    v_mfma_f32_32x32x16_bf16 v[216:231], a[196:199], v[232:235], v[216:231]
    ds_read_b128 v[232:235], v5 offset:28672
    s_waitcnt lgkmcnt(3)
    v_mfma_f32_32x32x16_bf16 v[200:215], a[200:203], v[236:239], v[200:215]
    v_mfma_f32_32x32x16_bf16 v[216:231], a[204:207], v[236:239], v[216:231]
    ds_read_b128 v[236:239], v5 offset:29696
    s_waitcnt lgkmcnt(3)
    v_mfma_f32_32x32x16_bf16 v[200:215], a[208:211], v[240:243], v[200:215]
    v_mfma_f32_32x32x16_bf16 v[216:231], a[212:215], v[240:243], v[216:231]
    ds_read_b128 v[240:243], v5 offset:30720
    s_waitcnt lgkmcnt(3)
    v_mfma_f32_32x32x16_bf16 v[200:215], a[216:219], v[244:247], v[200:215]
    v_mfma_f32_32x32x16_bf16 v[216:231], a[220:223], v[244:247], v[216:231]
    ds_read_b128 v[244:247], v5 offset:31744
    s_waitcnt lgkmcnt(3)
    v_mfma_f32_32x32x16_bf16 v[200:215], a[224:227], v[232:235], v[200:215]
    v_mfma_f32_32x32x16_bf16 v[216:231], a[228:231], v[232:235], v[216:231]
    s_waitcnt lgkmcnt(2)
    v_mfma_f32_32x32x16_bf16 v[200:215], a[232:235], v[236:239], v[200:215]
    v_mfma_f32_32x32x16_bf16 v[216:231], a[236:239], v[236:239], v[216:231]
    s_waitcnt lgkmcnt(1)
    v_mfma_f32_32x32x16_bf16 v[200:215], a[240:243], v[240:243], v[200:215]
    v_mfma_f32_32x32x16_bf16 v[216:231], a[244:247], v[240:243], v[216:231]
    s_waitcnt lgkmcnt(0)
    v_mfma_f32_32x32x16_bf16 v[200:215], a[248:251], v[244:247], v[200:215]
    v_mfma_f32_32x32x16_bf16 v[216:231], a[252:255], v[244:247], v[216:231]
    s_nop 7
    s_nop 3
    v_cvt_pk_bf16_f32 v192, v200, v216
    v_cvt_pk_bf16_f32 v193, v201, v217
    v_cvt_pk_bf16_f32 v194, v202, v218
    v_cvt_pk_bf16_f32 v195, v203, v219
    buffer_store_dwordx4 v[192:195], v6, s[8:11], s29 offen offset:0 sc1
    v_cvt_pk_bf16_f32 v196, v204, v220
    v_cvt_pk_bf16_f32 v197, v205, v221
    v_cvt_pk_bf16_f32 v198, v206, v222
    v_cvt_pk_bf16_f32 v199, v207, v223
    buffer_store_dwordx4 v[196:199], v6, s[8:11], s29 offen offset:1024 sc1
    v_cvt_pk_bf16_f32 v192, v208, v224
    v_cvt_pk_bf16_f32 v193, v209, v225
    v_cvt_pk_bf16_f32 v194, v210, v226
    v_cvt_pk_bf16_f32 v195, v211, v227
    buffer_store_dwordx4 v[192:195], v6, s[8:11], s29 offen offset:2048 sc1
    v_cvt_pk_bf16_f32 v196, v212, v228
    v_cvt_pk_bf16_f32 v197, v213, v229
    v_cvt_pk_bf16_f32 v198, v214, v230
    v_cvt_pk_bf16_f32 v199, v215, v231
    buffer_store_dwordx4 v[196:199], v6, s[8:11], s29 offen offset:3072 sc1
    s_add_u32 s29, s29, 131072
    s_add_u32 s30, s30, 1
    s_add_u32 s60, s60, 4
    v_mov_b32 v8, s30
    s_waitcnt vmcnt(0)
    s_barrier
    s_cmp_lg_u32 s4, 0
    s_cbranch_scc1 L_aw_nf
    s_mov_b64 exec, 1
    buffer_store_dword v8, v2, s[8:11], s58 offen sc1
    s_mov_b64 exec, -1
L_aw_nf:
    s_cmp_lt_u32 s30, 16
    s_cbranch_scc1 L_aw_loop
    s_waitcnt vmcnt(0)
    s_branch L_m_g2pre
L_w_after2:
    s_cmp_lt_u32 s101, 88
    s_cselect_b32 s99, 2, 0
    s_cmp_lt_u32 s101, 32
    s_cselect_b32 s99, 1, s99
L_m_g2pre:
    v_mbcnt_lo_u32_b32 v0, -1, 0
    v_mbcnt_hi_u32_b32 v0, -1, v0
    s_lshl_b32 s3, s100, 6
    v_add_u32 v0, s3, v0
    s_load_dwordx2 s[16:17], s[0:1], 80
    v_and_b32 v1, 63, v0
    s_mov_b32 s6, 0x05040100
    s_mov_b32 s7, 0x07060302
    v_lshrrev_b32 v2, 5, v1
    v_lshlrev_b32 v2, 15, v2
    v_and_b32 v3, 31, v1
    v_lshl_add_u32 v3, v3, 2, v2
    v_add_u32 v4, 4096, v3
    v_add_u32 v5, 8192, v3
    v_add_u32 v6, 12288, v3
    v_add_u32 v7, 16384, v3
    v_add_u32 v8, 20480, v3
    v_add_u32 v9, 24576, v3
    v_add_u32 v10, 28672, v3
    s_lshr_b32 s4, s98, 3
    s_lshl_b32 s20, s4, 7
    s_mul_i32 s4, s100, 1835008
    s_add_u32 s20, s20, s4
    s_waitcnt lgkmcnt(0)
    s_mov_b32 s12, s16
    s_and_b32 s13, s17, 0xffff
    s_mov_b32 s14, 7340032
    s_mov_b32 s15, 0x00020000
    buffer_load_dword v16, v3, s[12:15], s20 offen
    buffer_load_dword v17, v4, s[12:15], s20 offen
    buffer_load_dword v18, v5, s[12:15], s20 offen
    buffer_load_dword v19, v6, s[12:15], s20 offen
    buffer_load_dword v20, v7, s[12:15], s20 offen
    buffer_load_dword v21, v8, s[12:15], s20 offen
    buffer_load_dword v22, v9, s[12:15], s20 offen
    buffer_load_dword v23, v10, s[12:15], s20 offen
    s_add_u32 s20, s20, 65536
    buffer_load_dword v24, v3, s[12:15], s20 offen
    buffer_load_dword v25, v4, s[12:15], s20 offen
    buffer_load_dword v26, v5, s[12:15], s20 offen
    buffer_load_dword v27, v6, s[12:15], s20 offen
    buffer_load_dword v28, v7, s[12:15], s20 offen
    buffer_load_dword v29, v8, s[12:15], s20 offen
    buffer_load_dword v30, v9, s[12:15], s20 offen
    buffer_load_dword v31, v10, s[12:15], s20 offen
    s_add_u32 s20, s20, 65536
    buffer_load_dword v32, v3, s[12:15], s20 offen
    buffer_load_dword v33, v4, s[12:15], s20 offen
    buffer_load_dword v34, v5, s[12:15], s20 offen
    buffer_load_dword v35, v6, s[12:15], s20 offen
    buffer_load_dword v36, v7, s[12:15], s20 offen
    buffer_load_dword v37, v8, s[12:15], s20 offen
    buffer_load_dword v38, v9, s[12:15], s20 offen
    buffer_load_dword v39, v10, s[12:15], s20 offen
    s_add_u32 s20, s20, 65536
    buffer_load_dword v40, v3, s[12:15], s20 offen
    buffer_load_dword v41, v4, s[12:15], s20 offen
    buffer_load_dword v42, v5, s[12:15], s20 offen
    buffer_load_dword v43, v6, s[12:15], s20 offen
    buffer_load_dword v44, v7, s[12:15], s20 offen
    buffer_load_dword v45, v8, s[12:15], s20 offen
    buffer_load_dword v46, v9, s[12:15], s20 offen
    buffer_load_dword v47, v10, s[12:15], s20 offen
    s_add_u32 s20, s20, 65536
    buffer_load_dword v48, v3, s[12:15], s20 offen
    buffer_load_dword v49, v4, s[12:15], s20 offen
    buffer_load_dword v50, v5, s[12:15], s20 offen
    buffer_load_dword v51, v6, s[12:15], s20 offen
    buffer_load_dword v52, v7, s[12:15], s20 offen
    buffer_load_dword v53, v8, s[12:15], s20 offen
    buffer_load_dword v54, v9, s[12:15], s20 offen
    buffer_load_dword v55, v10, s[12:15], s20 offen
    s_add_u32 s20, s20, 65536
    buffer_load_dword v56, v3, s[12:15], s20 offen
    buffer_load_dword v57, v4, s[12:15], s20 offen
    buffer_load_dword v58, v5, s[12:15], s20 offen
    buffer_load_dword v59, v6, s[12:15], s20 offen
    buffer_load_dword v60, v7, s[12:15], s20 offen
    buffer_load_dword v61, v8, s[12:15], s20 offen
    buffer_load_dword v62, v9, s[12:15], s20 offen
    buffer_load_dword v63, v10, s[12:15], s20 offen
    s_add_u32 s20, s20, 65536
    buffer_load_dword v64, v3, s[12:15], s20 offen
    buffer_load_dword v65, v4, s[12:15], s20 offen
    buffer_load_dword v66, v5, s[12:15], s20 offen
    buffer_load_dword v67, v6, s[12:15], s20 offen
    buffer_load_dword v68, v7, s[12:15], s20 offen
    buffer_load_dword v69, v8, s[12:15], s20 offen
    buffer_load_dword v70, v9, s[12:15], s20 offen
    buffer_load_dword v71, v10, s[12:15], s20 offen
    s_add_u32 s20, s20, 65536
    s_waitcnt vmcnt(48)
    v_perm_b32 v80, v17, v16, s6
    v_perm_b32 v81, v19, v18, s6
    v_perm_b32 v82, v21, v20, s6
    v_perm_b32 v83, v23, v22, s6
    v_perm_b32 v84, v17, v16, s7
    v_perm_b32 v85, v19, v18, s7
    v_perm_b32 v86, v21, v20, s7
    v_perm_b32 v87, v23, v22, s7
    buffer_load_dword v16, v3, s[12:15], s20 offen
    buffer_load_dword v17, v4, s[12:15], s20 offen
    buffer_load_dword v18, v5, s[12:15], s20 offen
    buffer_load_dword v19, v6, s[12:15], s20 offen
    buffer_load_dword v20, v7, s[12:15], s20 offen
    buffer_load_dword v21, v8, s[12:15], s20 offen
    buffer_load_dword v22, v9, s[12:15], s20 offen
    buffer_load_dword v23, v10, s[12:15], s20 offen
    s_add_u32 s20, s20, 65536
    v_accvgpr_write_b32 a0, v80
    v_accvgpr_write_b32 a1, v81
    v_accvgpr_write_b32 a2, v82
    v_accvgpr_write_b32 a3, v83
    v_accvgpr_write_b32 a4, v84
    v_accvgpr_write_b32 a5, v85
    v_accvgpr_write_b32 a6, v86
    v_accvgpr_write_b32 a7, v87
    s_waitcnt vmcnt(48)
    v_perm_b32 v80, v25, v24, s6
    v_perm_b32 v81, v27, v26, s6
    v_perm_b32 v82, v29, v28, s6
    v_perm_b32 v83, v31, v30, s6
    v_perm_b32 v84, v25, v24, s7
    v_perm_b32 v85, v27, v26, s7
    v_perm_b32 v86, v29, v28, s7
    v_perm_b32 v87, v31, v30, s7
    buffer_load_dword v24, v3, s[12:15], s20 offen
    buffer_load_dword v25, v4, s[12:15], s20 offen
    buffer_load_dword v26, v5, s[12:15], s20 offen
    buffer_load_dword v27, v6, s[12:15], s20 offen
    buffer_load_dword v28, v7, s[12:15], s20 offen
    buffer_load_dword v29, v8, s[12:15], s20 offen
    buffer_load_dword v30, v9, s[12:15], s20 offen
    buffer_load_dword v31, v10, s[12:15], s20 offen
    s_add_u32 s20, s20, 65536
    v_accvgpr_write_b32 a8, v80
    v_accvgpr_write_b32 a9, v81
    v_accvgpr_write_b32 a10, v82
    v_accvgpr_write_b32 a11, v83
    v_accvgpr_write_b32 a12, v84
    v_accvgpr_write_b32 a13, v85
    v_accvgpr_write_b32 a14, v86
    v_accvgpr_write_b32 a15, v87
    s_waitcnt vmcnt(48)
    v_perm_b32 v80, v33, v32, s6
    v_perm_b32 v81, v35, v34, s6
    v_perm_b32 v82, v37, v36, s6
    v_perm_b32 v83, v39, v38, s6
    v_perm_b32 v84, v33, v32, s7
    v_perm_b32 v85, v35, v34, s7
    v_perm_b32 v86, v37, v36, s7
    v_perm_b32 v87, v39, v38, s7
    buffer_load_dword v32, v3, s[12:15], s20 offen
    buffer_load_dword v33, v4, s[12:15], s20 offen
    buffer_load_dword v34, v5, s[12:15], s20 offen
    buffer_load_dword v35, v6, s[12:15], s20 offen
    buffer_load_dword v36, v7, s[12:15], s20 offen
    buffer_load_dword v37, v8, s[12:15], s20 offen
    buffer_load_dword v38, v9, s[12:15], s20 offen
    buffer_load_dword v39, v10, s[12:15], s20 offen
    s_add_u32 s20, s20, 65536
    v_accvgpr_write_b32 a16, v80
    v_accvgpr_write_b32 a17, v81
    v_accvgpr_write_b32 a18, v82
    v_accvgpr_write_b32 a19, v83
    v_accvgpr_write_b32 a20, v84
    v_accvgpr_write_b32 a21, v85
    v_accvgpr_write_b32 a22, v86
    v_accvgpr_write_b32 a23, v87
    s_waitcnt vmcnt(48)
    v_perm_b32 v80, v41, v40, s6
    v_perm_b32 v81, v43, v42, s6
    v_perm_b32 v82, v45, v44, s6
    v_perm_b32 v83, v47, v46, s6
    v_perm_b32 v84, v41, v40, s7
    v_perm_b32 v85, v43, v42, s7
    v_perm_b32 v86, v45, v44, s7
    v_perm_b32 v87, v47, v46, s7
    buffer_load_dword v40, v3, s[12:15], s20 offen
    buffer_load_dword v41, v4, s[12:15], s20 offen
    buffer_load_dword v42, v5, s[12:15], s20 offen
    buffer_load_dword v43, v6, s[12:15], s20 offen
    buffer_load_dword v44, v7, s[12:15], s20 offen
    buffer_load_dword v45, v8, s[12:15], s20 offen
    buffer_load_dword v46, v9, s[12:15], s20 offen
    buffer_load_dword v47, v10, s[12:15], s20 offen
    s_add_u32 s20, s20, 65536
    v_accvgpr_write_b32 a24, v80
    v_accvgpr_write_b32 a25, v81
    v_accvgpr_write_b32 a26, v82
    v_accvgpr_write_b32 a27, v83
    v_accvgpr_write_b32 a28, v84
    v_accvgpr_write_b32 a29, v85
    v_accvgpr_write_b32 a30, v86
    v_accvgpr_write_b32 a31, v87
    s_waitcnt vmcnt(48)
    v_perm_b32 v80, v49, v48, s6
    v_perm_b32 v81, v51, v50, s6
    v_perm_b32 v82, v53, v52, s6
    v_perm_b32 v83, v55, v54, s6
    v_perm_b32 v84, v49, v48, s7
    v_perm_b32 v85, v51, v50, s7
    v_perm_b32 v86, v53, v52, s7
    v_perm_b32 v87, v55, v54, s7
    buffer_load_dword v48, v3, s[12:15], s20 offen
    buffer_load_dword v49, v4, s[12:15], s20 offen
    buffer_load_dword v50, v5, s[12:15], s20 offen
    buffer_load_dword v51, v6, s[12:15], s20 offen
    buffer_load_dword v52, v7, s[12:15], s20 offen
    buffer_load_dword v53, v8, s[12:15], s20 offen
    buffer_load_dword v54, v9, s[12:15], s20 offen
    buffer_load_dword v55, v10, s[12:15], s20 offen
    s_add_u32 s20, s20, 65536
    v_accvgpr_write_b32 a32, v80
    v_accvgpr_write_b32 a33, v81
    v_accvgpr_write_b32 a34, v82
    v_accvgpr_write_b32 a35, v83
    v_accvgpr_write_b32 a36, v84
    v_accvgpr_write_b32 a37, v85
    v_accvgpr_write_b32 a38, v86
    v_accvgpr_write_b32 a39, v87
    s_waitcnt vmcnt(48)
    v_perm_b32 v80, v57, v56, s6
    v_perm_b32 v81, v59, v58, s6
    v_perm_b32 v82, v61, v60, s6
    v_perm_b32 v83, v63, v62, s6
    v_perm_b32 v84, v57, v56, s7
    v_perm_b32 v85, v59, v58, s7
    v_perm_b32 v86, v61, v60, s7
    v_perm_b32 v87, v63, v62, s7
    buffer_load_dword v56, v3, s[12:15], s20 offen
    buffer_load_dword v57, v4, s[12:15], s20 offen
    buffer_load_dword v58, v5, s[12:15], s20 offen
    buffer_load_dword v59, v6, s[12:15], s20 offen
    buffer_load_dword v60, v7, s[12:15], s20 offen
    buffer_load_dword v61, v8, s[12:15], s20 offen
    buffer_load_dword v62, v9, s[12:15], s20 offen
    buffer_load_dword v63, v10, s[12:15], s20 offen
    s_add_u32 s20, s20, 65536
    v_accvgpr_write_b32 a40, v80
    v_accvgpr_write_b32 a41, v81
    v_accvgpr_write_b32 a42, v82
    v_accvgpr_write_b32 a43, v83
    v_accvgpr_write_b32 a44, v84
    v_accvgpr_write_b32 a45, v85
    v_accvgpr_write_b32 a46, v86
    v_accvgpr_write_b32 a47, v87
    s_waitcnt vmcnt(48)
    v_perm_b32 v80, v65, v64, s6
    v_perm_b32 v81, v67, v66, s6
    v_perm_b32 v82, v69, v68, s6
    v_perm_b32 v83, v71, v70, s6
    v_perm_b32 v84, v65, v64, s7
    v_perm_b32 v85, v67, v66, s7
    v_perm_b32 v86, v69, v68, s7
    v_perm_b32 v87, v71, v70, s7
    buffer_load_dword v64, v3, s[12:15], s20 offen
    buffer_load_dword v65, v4, s[12:15], s20 offen
    buffer_load_dword v66, v5, s[12:15], s20 offen
    buffer_load_dword v67, v6, s[12:15], s20 offen
    buffer_load_dword v68, v7, s[12:15], s20 offen
    buffer_load_dword v69, v8, s[12:15], s20 offen
    buffer_load_dword v70, v9, s[12:15], s20 offen
    buffer_load_dword v71, v10, s[12:15], s20 offen
    s_add_u32 s20, s20, 65536
    v_accvgpr_write_b32 a48, v80
    v_accvgpr_write_b32 a49, v81
    v_accvgpr_write_b32 a50, v82
    v_accvgpr_write_b32 a51, v83
    v_accvgpr_write_b32 a52, v84
    v_accvgpr_write_b32 a53, v85
    v_accvgpr_write_b32 a54, v86
    v_accvgpr_write_b32 a55, v87
    s_waitcnt vmcnt(48)
    v_perm_b32 v80, v17, v16, s6
    v_perm_b32 v81, v19, v18, s6
    v_perm_b32 v82, v21, v20, s6
    v_perm_b32 v83, v23, v22, s6
    v_perm_b32 v84, v17, v16, s7
    v_perm_b32 v85, v19, v18, s7
    v_perm_b32 v86, v21, v20, s7
    v_perm_b32 v87, v23, v22, s7
    buffer_load_dword v16, v3, s[12:15], s20 offen
    buffer_load_dword v17, v4, s[12:15], s20 offen
    buffer_load_dword v18, v5, s[12:15], s20 offen
    buffer_load_dword v19, v6, s[12:15], s20 offen
    buffer_load_dword v20, v7, s[12:15], s20 offen
    buffer_load_dword v21, v8, s[12:15], s20 offen
    buffer_load_dword v22, v9, s[12:15], s20 offen
    buffer_load_dword v23, v10, s[12:15], s20 offen
    s_add_u32 s20, s20, 65536
    v_accvgpr_write_b32 a56, v80
    v_accvgpr_write_b32 a57, v81
    v_accvgpr_write_b32 a58, v82
    v_accvgpr_write_b32 a59, v83
    v_accvgpr_write_b32 a60, v84
    v_accvgpr_write_b32 a61, v85
    v_accvgpr_write_b32 a62, v86
    v_accvgpr_write_b32 a63, v87
    s_waitcnt vmcnt(48)
    v_perm_b32 v80, v25, v24, s6
    v_perm_b32 v81, v27, v26, s6
    v_perm_b32 v82, v29, v28, s6
    v_perm_b32 v83, v31, v30, s6
    v_perm_b32 v84, v25, v24, s7
    v_perm_b32 v85, v27, v26, s7
    v_perm_b32 v86, v29, v28, s7
    v_perm_b32 v87, v31, v30, s7
    buffer_load_dword v24, v3, s[12:15], s20 offen
    buffer_load_dword v25, v4, s[12:15], s20 offen
    buffer_load_dword v26, v5, s[12:15], s20 offen
    buffer_load_dword v27, v6, s[12:15], s20 offen
    buffer_load_dword v28, v7, s[12:15], s20 offen
    buffer_load_dword v29, v8, s[12:15], s20 offen
    buffer_load_dword v30, v9, s[12:15], s20 offen
    buffer_load_dword v31, v10, s[12:15], s20 offen
    s_add_u32 s20, s20, 65536
    v_accvgpr_write_b32 a64, v80
    v_accvgpr_write_b32 a65, v81
    v_accvgpr_write_b32 a66, v82
    v_accvgpr_write_b32 a67, v83
    v_accvgpr_write_b32 a68, v84
    v_accvgpr_write_b32 a69, v85
    v_accvgpr_write_b32 a70, v86
    v_accvgpr_write_b32 a71, v87
    s_waitcnt vmcnt(48)
    v_perm_b32 v80, v33, v32, s6
    v_perm_b32 v81, v35, v34, s6
    v_perm_b32 v82, v37, v36, s6
    v_perm_b32 v83, v39, v38, s6
    v_perm_b32 v84, v33, v32, s7
    v_perm_b32 v85, v35, v34, s7
    v_perm_b32 v86, v37, v36, s7
    v_perm_b32 v87, v39, v38, s7
    buffer_load_dword v32, v3, s[12:15], s20 offen
    buffer_load_dword v33, v4, s[12:15], s20 offen
    buffer_load_dword v34, v5, s[12:15], s20 offen
    buffer_load_dword v35, v6, s[12:15], s20 offen
    buffer_load_dword v36, v7, s[12:15], s20 offen
    buffer_load_dword v37, v8, s[12:15], s20 offen
    buffer_load_dword v38, v9, s[12:15], s20 offen
    buffer_load_dword v39, v10, s[12:15], s20 offen
    s_add_u32 s20, s20, 65536
    v_accvgpr_write_b32 a72, v80
    v_accvgpr_write_b32 a73, v81
    v_accvgpr_write_b32 a74, v82
    v_accvgpr_write_b32 a75, v83
    v_accvgpr_write_b32 a76, v84
    v_accvgpr_write_b32 a77, v85
    v_accvgpr_write_b32 a78, v86
    v_accvgpr_write_b32 a79, v87
    s_waitcnt vmcnt(48)
    v_perm_b32 v80, v41, v40, s6
    v_perm_b32 v81, v43, v42, s6
    v_perm_b32 v82, v45, v44, s6
    v_perm_b32 v83, v47, v46, s6
    v_perm_b32 v84, v41, v40, s7
    v_perm_b32 v85, v43, v42, s7
    v_perm_b32 v86, v45, v44, s7
    v_perm_b32 v87, v47, v46, s7
    buffer_load_dword v40, v3, s[12:15], s20 offen
    buffer_load_dword v41, v4, s[12:15], s20 offen
    buffer_load_dword v42, v5, s[12:15], s20 offen
    buffer_load_dword v43, v6, s[12:15], s20 offen
    buffer_load_dword v44, v7, s[12:15], s20 offen
    buffer_load_dword v45, v8, s[12:15], s20 offen
    buffer_load_dword v46, v9, s[12:15], s20 offen
    buffer_load_dword v47, v10, s[12:15], s20 offen
    s_add_u32 s20, s20, 65536
    v_accvgpr_write_b32 a80, v80
    v_accvgpr_write_b32 a81, v81
    v_accvgpr_write_b32 a82, v82
    v_accvgpr_write_b32 a83, v83
    v_accvgpr_write_b32 a84, v84
    v_accvgpr_write_b32 a85, v85
    v_accvgpr_write_b32 a86, v86
    v_accvgpr_write_b32 a87, v87
    s_waitcnt vmcnt(48)
    v_perm_b32 v80, v49, v48, s6
    v_perm_b32 v81, v51, v50, s6
    v_perm_b32 v82, v53, v52, s6
    v_perm_b32 v83, v55, v54, s6
    v_perm_b32 v84, v49, v48, s7
    v_perm_b32 v85, v51, v50, s7
    v_perm_b32 v86, v53, v52, s7
    v_perm_b32 v87, v55, v54, s7
    buffer_load_dword v48, v3, s[12:15], s20 offen
    buffer_load_dword v49, v4, s[12:15], s20 offen
    buffer_load_dword v50, v5, s[12:15], s20 offen
    buffer_load_dword v51, v6, s[12:15], s20 offen
    buffer_load_dword v52, v7, s[12:15], s20 offen
    buffer_load_dword v53, v8, s[12:15], s20 offen
    buffer_load_dword v54, v9, s[12:15], s20 offen
    buffer_load_dword v55, v10, s[12:15], s20 offen
    s_add_u32 s20, s20, 65536
    v_accvgpr_write_b32 a88, v80
    v_accvgpr_write_b32 a89, v81
    v_accvgpr_write_b32 a90, v82
    v_accvgpr_write_b32 a91, v83
    v_accvgpr_write_b32 a92, v84
    v_accvgpr_write_b32 a93, v85
    v_accvgpr_write_b32 a94, v86
    v_accvgpr_write_b32 a95, v87
    s_waitcnt vmcnt(48)
    v_perm_b32 v80, v57, v56, s6
    v_perm_b32 v81, v59, v58, s6
    v_perm_b32 v82, v61, v60, s6
    v_perm_b32 v83, v63, v62, s6
    v_perm_b32 v84, v57, v56, s7
    v_perm_b32 v85, v59, v58, s7
    v_perm_b32 v86, v61, v60, s7
    v_perm_b32 v87, v63, v62, s7
    buffer_load_dword v56, v3, s[12:15], s20 offen
    buffer_load_dword v57, v4, s[12:15], s20 offen
    buffer_load_dword v58, v5, s[12:15], s20 offen
    buffer_load_dword v59, v6, s[12:15], s20 offen
    buffer_load_dword v60, v7, s[12:15], s20 offen
    buffer_load_dword v61, v8, s[12:15], s20 offen
    buffer_load_dword v62, v9, s[12:15], s20 offen
    buffer_load_dword v63, v10, s[12:15], s20 offen
    s_add_u32 s20, s20, 65536
    v_accvgpr_write_b32 a96, v80
    v_accvgpr_write_b32 a97, v81
    v_accvgpr_write_b32 a98, v82
    v_accvgpr_write_b32 a99, v83
    v_accvgpr_write_b32 a100, v84
    v_accvgpr_write_b32 a101, v85
    v_accvgpr_write_b32 a102, v86
    v_accvgpr_write_b32 a103, v87
    s_waitcnt vmcnt(48)
    v_perm_b32 v80, v65, v64, s6
    v_perm_b32 v81, v67, v66, s6
    v_perm_b32 v82, v69, v68, s6
    v_perm_b32 v83, v71, v70, s6
    v_perm_b32 v84, v65, v64, s7
    v_perm_b32 v85, v67, v66, s7
    v_perm_b32 v86, v69, v68, s7
    v_perm_b32 v87, v71, v70, s7
    buffer_load_dword v64, v3, s[12:15], s20 offen
    buffer_load_dword v65, v4, s[12:15], s20 offen
    buffer_load_dword v66, v5, s[12:15], s20 offen
    buffer_load_dword v67, v6, s[12:15], s20 offen
    buffer_load_dword v68, v7, s[12:15], s20 offen
    buffer_load_dword v69, v8, s[12:15], s20 offen
    buffer_load_dword v70, v9, s[12:15], s20 offen
    buffer_load_dword v71, v10, s[12:15], s20 offen
    s_add_u32 s20, s20, 65536
    v_accvgpr_write_b32 a104, v80
    v_accvgpr_write_b32 a105, v81
    v_accvgpr_write_b32 a106, v82
    v_accvgpr_write_b32 a107, v83
    v_accvgpr_write_b32 a108, v84
    v_accvgpr_write_b32 a109, v85
    v_accvgpr_write_b32 a110, v86
    v_accvgpr_write_b32 a111, v87
    s_waitcnt vmcnt(48)
    v_perm_b32 v80, v17, v16, s6
    v_perm_b32 v81, v19, v18, s6
    v_perm_b32 v82, v21, v20, s6
    v_perm_b32 v83, v23, v22, s6
    v_perm_b32 v84, v17, v16, s7
    v_perm_b32 v85, v19, v18, s7
    v_perm_b32 v86, v21, v20, s7
    v_perm_b32 v87, v23, v22, s7
    buffer_load_dword v16, v3, s[12:15], s20 offen
    buffer_load_dword v17, v4, s[12:15], s20 offen
    buffer_load_dword v18, v5, s[12:15], s20 offen
    buffer_load_dword v19, v6, s[12:15], s20 offen
    buffer_load_dword v20, v7, s[12:15], s20 offen
    buffer_load_dword v21, v8, s[12:15], s20 offen
    buffer_load_dword v22, v9, s[12:15], s20 offen
    buffer_load_dword v23, v10, s[12:15], s20 offen
    s_add_u32 s20, s20, 65536
    v_accvgpr_write_b32 a112, v80
    v_accvgpr_write_b32 a113, v81
    v_accvgpr_write_b32 a114, v82
    v_accvgpr_write_b32 a115, v83
    v_accvgpr_write_b32 a116, v84
    v_accvgpr_write_b32 a117, v85
    v_accvgpr_write_b32 a118, v86
    v_accvgpr_write_b32 a119, v87
    s_waitcnt vmcnt(48)
    v_perm_b32 v80, v25, v24, s6
    v_perm_b32 v81, v27, v26, s6
    v_perm_b32 v82, v29, v28, s6
    v_perm_b32 v83, v31, v30, s6
    v_perm_b32 v84, v25, v24, s7
    v_perm_b32 v85, v27, v26, s7
    v_perm_b32 v86, v29, v28, s7
    v_perm_b32 v87, v31, v30, s7
    buffer_load_dword v24, v3, s[12:15], s20 offen
    buffer_load_dword v25, v4, s[12:15], s20 offen
    buffer_load_dword v26, v5, s[12:15], s20 offen
    buffer_load_dword v27, v6, s[12:15], s20 offen
    buffer_load_dword v28, v7, s[12:15], s20 offen
    buffer_load_dword v29, v8, s[12:15], s20 offen
    buffer_load_dword v30, v9, s[12:15], s20 offen
    buffer_load_dword v31, v10, s[12:15], s20 offen
    s_add_u32 s20, s20, 65536
    v_accvgpr_write_b32 a120, v80
    v_accvgpr_write_b32 a121, v81
    v_accvgpr_write_b32 a122, v82
    v_accvgpr_write_b32 a123, v83
    v_accvgpr_write_b32 a124, v84
    v_accvgpr_write_b32 a125, v85
    v_accvgpr_write_b32 a126, v86
    v_accvgpr_write_b32 a127, v87
    s_waitcnt vmcnt(48)
    v_perm_b32 v80, v33, v32, s6
    v_perm_b32 v81, v35, v34, s6
    v_perm_b32 v82, v37, v36, s6
    v_perm_b32 v83, v39, v38, s6
    v_perm_b32 v84, v33, v32, s7
    v_perm_b32 v85, v35, v34, s7
    v_perm_b32 v86, v37, v36, s7
    v_perm_b32 v87, v39, v38, s7
    buffer_load_dword v32, v3, s[12:15], s20 offen
    buffer_load_dword v33, v4, s[12:15], s20 offen
    buffer_load_dword v34, v5, s[12:15], s20 offen
    buffer_load_dword v35, v6, s[12:15], s20 offen
    buffer_load_dword v36, v7, s[12:15], s20 offen
    buffer_load_dword v37, v8, s[12:15], s20 offen
    buffer_load_dword v38, v9, s[12:15], s20 offen
    buffer_load_dword v39, v10, s[12:15], s20 offen
    s_add_u32 s20, s20, 65536
    v_accvgpr_write_b32 a128, v80
    v_accvgpr_write_b32 a129, v81
    v_accvgpr_write_b32 a130, v82
    v_accvgpr_write_b32 a131, v83
    v_accvgpr_write_b32 a132, v84
    v_accvgpr_write_b32 a133, v85
    v_accvgpr_write_b32 a134, v86
    v_accvgpr_write_b32 a135, v87
    s_waitcnt vmcnt(48)
    v_perm_b32 v80, v41, v40, s6
    v_perm_b32 v81, v43, v42, s6
    v_perm_b32 v82, v45, v44, s6
    v_perm_b32 v83, v47, v46, s6
    v_perm_b32 v84, v41, v40, s7
    v_perm_b32 v85, v43, v42, s7
    v_perm_b32 v86, v45, v44, s7
    v_perm_b32 v87, v47, v46, s7
    buffer_load_dword v40, v3, s[12:15], s20 offen
    buffer_load_dword v41, v4, s[12:15], s20 offen
    buffer_load_dword v42, v5, s[12:15], s20 offen
    buffer_load_dword v43, v6, s[12:15], s20 offen
    buffer_load_dword v44, v7, s[12:15], s20 offen
    buffer_load_dword v45, v8, s[12:15], s20 offen
    buffer_load_dword v46, v9, s[12:15], s20 offen
    buffer_load_dword v47, v10, s[12:15], s20 offen
    s_add_u32 s20, s20, 65536
    v_accvgpr_write_b32 a136, v80
    v_accvgpr_write_b32 a137, v81
    v_accvgpr_write_b32 a138, v82
    v_accvgpr_write_b32 a139, v83
    v_accvgpr_write_b32 a140, v84
    v_accvgpr_write_b32 a141, v85
    v_accvgpr_write_b32 a142, v86
    v_accvgpr_write_b32 a143, v87
    s_waitcnt vmcnt(48)
    v_perm_b32 v80, v49, v48, s6
    v_perm_b32 v81, v51, v50, s6
    v_perm_b32 v82, v53, v52, s6
    v_perm_b32 v83, v55, v54, s6
    v_perm_b32 v84, v49, v48, s7
    v_perm_b32 v85, v51, v50, s7
    v_perm_b32 v86, v53, v52, s7
    v_perm_b32 v87, v55, v54, s7
    buffer_load_dword v48, v3, s[12:15], s20 offen
    buffer_load_dword v49, v4, s[12:15], s20 offen
    buffer_load_dword v50, v5, s[12:15], s20 offen
    buffer_load_dword v51, v6, s[12:15], s20 offen
    buffer_load_dword v52, v7, s[12:15], s20 offen
    buffer_load_dword v53, v8, s[12:15], s20 offen
    buffer_load_dword v54, v9, s[12:15], s20 offen
    buffer_load_dword v55, v10, s[12:15], s20 offen
    s_add_u32 s20, s20, 65536
    v_accvgpr_write_b32 a144, v80
    v_accvgpr_write_b32 a145, v81
    v_accvgpr_write_b32 a146, v82
    v_accvgpr_write_b32 a147, v83
    v_accvgpr_write_b32 a148, v84
    v_accvgpr_write_b32 a149, v85
    v_accvgpr_write_b32 a150, v86
    v_accvgpr_write_b32 a151, v87
    s_waitcnt vmcnt(48)
    v_perm_b32 v80, v57, v56, s6
    v_perm_b32 v81, v59, v58, s6
    v_perm_b32 v82, v61, v60, s6
    v_perm_b32 v83, v63, v62, s6
    v_perm_b32 v84, v57, v56, s7
    v_perm_b32 v85, v59, v58, s7
    v_perm_b32 v86, v61, v60, s7
    v_perm_b32 v87, v63, v62, s7
    buffer_load_dword v56, v3, s[12:15], s20 offen
    buffer_load_dword v57, v4, s[12:15], s20 offen
    buffer_load_dword v58, v5, s[12:15], s20 offen
    buffer_load_dword v59, v6, s[12:15], s20 offen
    buffer_load_dword v60, v7, s[12:15], s20 offen
    buffer_load_dword v61, v8, s[12:15], s20 offen
    buffer_load_dword v62, v9, s[12:15], s20 offen
    buffer_load_dword v63, v10, s[12:15], s20 offen
    s_add_u32 s20, s20, 65536
    v_accvgpr_write_b32 a152, v80
    v_accvgpr_write_b32 a153, v81
    v_accvgpr_write_b32 a154, v82
    v_accvgpr_write_b32 a155, v83
    v_accvgpr_write_b32 a156, v84
    v_accvgpr_write_b32 a157, v85
    v_accvgpr_write_b32 a158, v86
    v_accvgpr_write_b32 a159, v87
    s_waitcnt vmcnt(48)
    v_perm_b32 v80, v65, v64, s6
    v_perm_b32 v81, v67, v66, s6
    v_perm_b32 v82, v69, v68, s6
    v_perm_b32 v83, v71, v70, s6
    v_perm_b32 v84, v65, v64, s7
    v_perm_b32 v85, v67, v66, s7
    v_perm_b32 v86, v69, v68, s7
    v_perm_b32 v87, v71, v70, s7
    buffer_load_dword v64, v3, s[12:15], s20 offen
    buffer_load_dword v65, v4, s[12:15], s20 offen
    buffer_load_dword v66, v5, s[12:15], s20 offen
    buffer_load_dword v67, v6, s[12:15], s20 offen
    buffer_load_dword v68, v7, s[12:15], s20 offen
    buffer_load_dword v69, v8, s[12:15], s20 offen
    buffer_load_dword v70, v9, s[12:15], s20 offen
    buffer_load_dword v71, v10, s[12:15], s20 offen
    s_add_u32 s20, s20, 65536
    v_accvgpr_write_b32 a160, v80
    v_accvgpr_write_b32 a161, v81
    v_accvgpr_write_b32 a162, v82
    v_accvgpr_write_b32 a163, v83
    v_accvgpr_write_b32 a164, v84
    v_accvgpr_write_b32 a165, v85
    v_accvgpr_write_b32 a166, v86
    v_accvgpr_write_b32 a167, v87
    s_waitcnt vmcnt(48)
    v_perm_b32 v80, v17, v16, s6
    v_perm_b32 v81, v19, v18, s6
    v_perm_b32 v82, v21, v20, s6
    v_perm_b32 v83, v23, v22, s6
    v_perm_b32 v84, v17, v16, s7
    v_perm_b32 v85, v19, v18, s7
    v_perm_b32 v86, v21, v20, s7
    v_perm_b32 v87, v23, v22, s7
    v_accvgpr_write_b32 a168, v80
    v_accvgpr_write_b32 a169, v81
    v_accvgpr_write_b32 a170, v82
    v_accvgpr_write_b32 a171, v83
    v_accvgpr_write_b32 a172, v84
    v_accvgpr_write_b32 a173, v85
    v_accvgpr_write_b32 a174, v86
    v_accvgpr_write_b32 a175, v87
    s_waitcnt vmcnt(40)
    v_perm_b32 v80, v25, v24, s6
    v_perm_b32 v81, v27, v26, s6
    v_perm_b32 v82, v29, v28, s6
    v_perm_b32 v83, v31, v30, s6
    v_perm_b32 v84, v25, v24, s7
    v_perm_b32 v85, v27, v26, s7
    v_perm_b32 v86, v29, v28, s7
    v_perm_b32 v87, v31, v30, s7
    v_accvgpr_write_b32 a176, v80
    v_accvgpr_write_b32 a177, v81
    v_accvgpr_write_b32 a178, v82
    v_accvgpr_write_b32 a179, v83
    v_accvgpr_write_b32 a180, v84
    v_accvgpr_write_b32 a181, v85
    v_accvgpr_write_b32 a182, v86
    v_accvgpr_write_b32 a183, v87
    s_waitcnt vmcnt(32)
    v_perm_b32 v80, v33, v32, s6
    v_perm_b32 v81, v35, v34, s6
    v_perm_b32 v82, v37, v36, s6
    v_perm_b32 v83, v39, v38, s6
    v_perm_b32 v84, v33, v32, s7
    v_perm_b32 v85, v35, v34, s7
    v_perm_b32 v86, v37, v36, s7
    v_perm_b32 v87, v39, v38, s7
    v_accvgpr_write_b32 a184, v80
    v_accvgpr_write_b32 a185, v81
    v_accvgpr_write_b32 a186, v82
    v_accvgpr_write_b32 a187, v83
    v_accvgpr_write_b32 a188, v84
    v_accvgpr_write_b32 a189, v85
    v_accvgpr_write_b32 a190, v86
    v_accvgpr_write_b32 a191, v87
    s_waitcnt vmcnt(24)
    v_perm_b32 v80, v41, v40, s6
    v_perm_b32 v81, v43, v42, s6
    v_perm_b32 v82, v45, v44, s6
    v_perm_b32 v83, v47, v46, s6
    v_perm_b32 v84, v41, v40, s7
    v_perm_b32 v85, v43, v42, s7
    v_perm_b32 v86, v45, v44, s7
    v_perm_b32 v87, v47, v46, s7
    v_accvgpr_write_b32 a192, v80
    v_accvgpr_write_b32 a193, v81
    v_accvgpr_write_b32 a194, v82
    v_accvgpr_write_b32 a195, v83
    v_accvgpr_write_b32 a196, v84
    v_accvgpr_write_b32 a197, v85
    v_accvgpr_write_b32 a198, v86
    v_accvgpr_write_b32 a199, v87
    s_waitcnt vmcnt(16)
    v_perm_b32 v80, v49, v48, s6
    v_perm_b32 v81, v51, v50, s6
    v_perm_b32 v82, v53, v52, s6
    v_perm_b32 v83, v55, v54, s6
    v_perm_b32 v84, v49, v48, s7
    v_perm_b32 v85, v51, v50, s7
    v_perm_b32 v86, v53, v52, s7
    v_perm_b32 v87, v55, v54, s7
    v_accvgpr_write_b32 a200, v80
    v_accvgpr_write_b32 a201, v81
    v_accvgpr_write_b32 a202, v82
    v_accvgpr_write_b32 a203, v83
    v_accvgpr_write_b32 a204, v84
    v_accvgpr_write_b32 a205, v85
    v_accvgpr_write_b32 a206, v86
    v_accvgpr_write_b32 a207, v87
    s_waitcnt vmcnt(8)
    v_perm_b32 v80, v57, v56, s6
    v_perm_b32 v81, v59, v58, s6
    v_perm_b32 v82, v61, v60, s6
    v_perm_b32 v83, v63, v62, s6
    v_perm_b32 v84, v57, v56, s7
    v_perm_b32 v85, v59, v58, s7
    v_perm_b32 v86, v61, v60, s7
    v_perm_b32 v87, v63, v62, s7
    v_accvgpr_write_b32 a208, v80
    v_accvgpr_write_b32 a209, v81
    v_accvgpr_write_b32 a210, v82
    v_accvgpr_write_b32 a211, v83
    v_accvgpr_write_b32 a212, v84
    v_accvgpr_write_b32 a213, v85
    v_accvgpr_write_b32 a214, v86
    v_accvgpr_write_b32 a215, v87
    s_waitcnt vmcnt(0)
    v_perm_b32 v80, v65, v64, s6
    v_perm_b32 v81, v67, v66, s6
    v_perm_b32 v82, v69, v68, s6
    v_perm_b32 v83, v71, v70, s6
    v_perm_b32 v84, v65, v64, s7
    v_perm_b32 v85, v67, v66, s7
    v_perm_b32 v86, v69, v68, s7
    v_perm_b32 v87, v71, v70, s7
    v_accvgpr_write_b32 a216, v80
    v_accvgpr_write_b32 a217, v81
    v_accvgpr_write_b32 a218, v82
    v_accvgpr_write_b32 a219, v83
    v_accvgpr_write_b32 a220, v84
    v_accvgpr_write_b32 a221, v85
    v_accvgpr_write_b32 a222, v86
    v_accvgpr_write_b32 a223, v87
    s_cmp_eq_u32 s99, 0
    s_cbranch_scc1 L_m_g2
    s_barrier
    s_cmp_eq_u32 s99, 2
    s_cbranch_scc1 L_m_g1
    s_load_dwordx2 s[16:17], s[0:1], 0
    s_load_dwordx2 s[18:19], s[0:1], 112
    v_and_b32 v0, 63, v0
    v_and_b32 v3, 7, v0
    v_lshrrev_b32 v4, 3, v0
    v_lshlrev_b32 v1, 9, v4
    v_lshl_add_u32 v1, v3, 4, v1
    v_lshlrev_b32 v2, 4, v4
    v_lshl_add_u32 v2, v3, 10, v2
    v_mul_u32_u24 v5, 272, v3
    v_lshl_add_u32 v5, v4, 4, v5
    s_mul_i32 s4, s100, 2176
    v_add_u32 v5, s4, v5
    v_lshlrev_b32 v6, 2, v0
    v_add_u32 v6, s4, v6
    v_lshlrev_b32 v16, 5, v3
    v_add_u32 v16, 8704, v16
    s_lshl_b32 s4, s100, 3
    v_add_u32 v15, s4, v16
    v_lshrrev_b32 v3, 4, v0
    v_lshlrev_b32 v7, 17, v3
    v_and_b32 v3, 15, v0
    v_lshl_add_u32 v7, v3, 5, v7
    v_lshlrev_b32 v14, 7, v0
    s_mov_b32 s20, 0x05040100
    s_mov_b32 s21, 0x07060302
    s_lshl_b32 s25, s101, 7
    s_add_u32 s25, s25, 60895232
    s_lshl_b32 s7, s101, 13
    s_lshl_b32 s4, s100, 8
    s_add_u32 s7, s7, s4
    s_lshl_b32 s22, s101, 9
    s_lshl_b32 s4, s100, 19
    s_add_u32 s22, s22, s4
    s_add_u32 s22, s22, 119537664
    s_lshr_b32 s4, s101, 2
    s_lshl_b32 s6, s4, 15
    s_and_b32 s5, s101, 3
    s_lshl_b32 s5, s5, 7
    s_add_u32 s6, s6, s5
    s_lshl_b32 s5, s100, 13
    s_add_u32 s6, s6, s5
    s_add_u32 s6, s6, 83886080
    s_and_b32 s5, s4, 3
    s_lshl_b32 s24, s5, 11
    s_add_u32 s24, s24, 60887040
    s_lshr_b32 s26, s4, 2
    s_add_u32 s26, s26, 1
    s_mov_b32 s23, 0
    s_waitcnt lgkmcnt(0)
    s_mov_b32 s8, s18
    s_and_b32 s9, s19, 0xffff
    s_mov_b32 s10, 268435456
    s_mov_b32 s11, 0x00020000
    s_mov_b32 s12, s16
    s_and_b32 s13, s17, 0xffff
    s_mov_b32 s14, 2097152
    s_mov_b32 s15, 0x00020000
L_ln_loop:
    buffer_load_dwordx4 v[36:39], v2, s[12:15], s7 offen offset:0
    buffer_load_dwordx4 v[40:43], v2, s[12:15], s7 offen offset:128
    s_mov_b64 exec, 0xffff
    s_mov_b32 s27, 400000
L_lnp_18:
    buffer_load_dword v3, v14, s[8:11], s24 offen sc1
    s_waitcnt vmcnt(0)
    v_cmp_gt_u32 vcc, s26, v3
    s_cbranch_vccz L_lnpd_19
    s_sub_u32 s27, s27, 1
    s_cbranch_scc1 L_m_fail
    s_sleep 1
    s_cmp_ge_u32 s23, 7
    s_cbranch_scc1 L_lnp_18
    s_sleep 64
    s_branch L_lnp_18
L_lnpd_19:
    s_mov_b64 exec, -1
    s_add_u32 s4, s6, 0
    buffer_load_dwordx4 v[44:47], v1, s[8:11], s4 offen sc1
    s_add_u32 s4, s6, 4096
    buffer_load_dwordx4 v[48:51], v1, s[8:11], s4 offen sc1
    s_add_u32 s4, s6, 2097152
    buffer_load_dwordx4 v[52:55], v1, s[8:11], s4 offen sc1
    s_add_u32 s4, s6, 2101248
    buffer_load_dwordx4 v[56:59], v1, s[8:11], s4 offen sc1
    s_add_u32 s4, s6, 4194304
    buffer_load_dwordx4 v[60:63], v1, s[8:11], s4 offen sc1
    s_add_u32 s4, s6, 4198400
    buffer_load_dwordx4 v[64:67], v1, s[8:11], s4 offen sc1
    s_add_u32 s4, s6, 6291456
    buffer_load_dwordx4 v[68:71], v1, s[8:11], s4 offen sc1
    s_add_u32 s4, s6, 6295552
    buffer_load_dwordx4 v[72:75], v1, s[8:11], s4 offen sc1
    s_add_u32 s4, s6, 8388608
    buffer_load_dwordx4 v[76:79], v1, s[8:11], s4 offen sc1
    s_add_u32 s4, s6, 8392704
    buffer_load_dwordx4 v[80:83], v1, s[8:11], s4 offen sc1
    s_add_u32 s4, s6, 10485760
    buffer_load_dwordx4 v[84:87], v1, s[8:11], s4 offen sc1
    s_add_u32 s4, s6, 10489856
    buffer_load_dwordx4 v[88:91], v1, s[8:11], s4 offen sc1
    s_add_u32 s4, s6, 12582912
    buffer_load_dwordx4 v[92:95], v1, s[8:11], s4 offen sc1
    s_add_u32 s4, s6, 12587008
    buffer_load_dwordx4 v[96:99], v1, s[8:11], s4 offen sc1
    s_add_u32 s4, s6, 14680064
    buffer_load_dwordx4 v[100:103], v1, s[8:11], s4 offen sc1
    s_add_u32 s4, s6, 14684160
    buffer_load_dwordx4 v[104:107], v1, s[8:11], s4 offen sc1
    s_waitcnt vmcnt(14)
    v_lshlrev_b32 v20, 16, v44
    v_and_b32 v21, 0xffff0000, v44
    v_lshlrev_b32 v22, 16, v45
    v_and_b32 v23, 0xffff0000, v45
    v_lshlrev_b32 v24, 16, v46
    v_and_b32 v25, 0xffff0000, v46
    v_lshlrev_b32 v26, 16, v47
    v_and_b32 v27, 0xffff0000, v47
    v_lshlrev_b32 v28, 16, v48
    v_and_b32 v29, 0xffff0000, v48
    v_lshlrev_b32 v30, 16, v49
    v_and_b32 v31, 0xffff0000, v49
    v_lshlrev_b32 v32, 16, v50
    v_and_b32 v33, 0xffff0000, v50
    v_lshlrev_b32 v34, 16, v51
    v_and_b32 v35, 0xffff0000, v51
    s_waitcnt vmcnt(12)
    v_lshlrev_b32 v8, 16, v52
    v_and_b32 v9, 0xffff0000, v52
    v_pk_add_f32 v[20:21], v[20:21], v[8:9]
    v_lshlrev_b32 v8, 16, v53
    v_and_b32 v9, 0xffff0000, v53
    v_pk_add_f32 v[22:23], v[22:23], v[8:9]
    v_lshlrev_b32 v8, 16, v54
    v_and_b32 v9, 0xffff0000, v54
    v_pk_add_f32 v[24:25], v[24:25], v[8:9]
    v_lshlrev_b32 v8, 16, v55
    v_and_b32 v9, 0xffff0000, v55
    v_pk_add_f32 v[26:27], v[26:27], v[8:9]
    v_lshlrev_b32 v8, 16, v56
    v_and_b32 v9, 0xffff0000, v56
    v_pk_add_f32 v[28:29], v[28:29], v[8:9]
    v_lshlrev_b32 v8, 16, v57
    v_and_b32 v9, 0xffff0000, v57
    v_pk_add_f32 v[30:31], v[30:31], v[8:9]
    v_lshlrev_b32 v8, 16, v58
    v_and_b32 v9, 0xffff0000, v58
    v_pk_add_f32 v[32:33], v[32:33], v[8:9]
    v_lshlrev_b32 v8, 16, v59
    v_and_b32 v9, 0xffff0000, v59
    v_pk_add_f32 v[34:35], v[34:35], v[8:9]
    s_waitcnt vmcnt(10)
    v_lshlrev_b32 v8, 16, v60
    v_and_b32 v9, 0xffff0000, v60
    v_pk_add_f32 v[20:21], v[20:21], v[8:9]
    v_lshlrev_b32 v8, 16, v61
    v_and_b32 v9, 0xffff0000, v61
    v_pk_add_f32 v[22:23], v[22:23], v[8:9]
    v_lshlrev_b32 v8, 16, v62
    v_and_b32 v9, 0xffff0000, v62
    v_pk_add_f32 v[24:25], v[24:25], v[8:9]
    v_lshlrev_b32 v8, 16, v63
    v_and_b32 v9, 0xffff0000, v63
    v_pk_add_f32 v[26:27], v[26:27], v[8:9]
    v_lshlrev_b32 v8, 16, v64
    v_and_b32 v9, 0xffff0000, v64
    v_pk_add_f32 v[28:29], v[28:29], v[8:9]
    v_lshlrev_b32 v8, 16, v65
    v_and_b32 v9, 0xffff0000, v65
    v_pk_add_f32 v[30:31], v[30:31], v[8:9]
    v_lshlrev_b32 v8, 16, v66
    v_and_b32 v9, 0xffff0000, v66
    v_pk_add_f32 v[32:33], v[32:33], v[8:9]
    v_lshlrev_b32 v8, 16, v67
    v_and_b32 v9, 0xffff0000, v67
    v_pk_add_f32 v[34:35], v[34:35], v[8:9]
    s_waitcnt vmcnt(8)
    v_lshlrev_b32 v8, 16, v68
    v_and_b32 v9, 0xffff0000, v68
    v_pk_add_f32 v[20:21], v[20:21], v[8:9]
    v_lshlrev_b32 v8, 16, v69
    v_and_b32 v9, 0xffff0000, v69
    v_pk_add_f32 v[22:23], v[22:23], v[8:9]
    v_lshlrev_b32 v8, 16, v70
    v_and_b32 v9, 0xffff0000, v70
    v_pk_add_f32 v[24:25], v[24:25], v[8:9]
    v_lshlrev_b32 v8, 16, v71
    v_and_b32 v9, 0xffff0000, v71
    v_pk_add_f32 v[26:27], v[26:27], v[8:9]
    v_lshlrev_b32 v8, 16, v72
    v_and_b32 v9, 0xffff0000, v72
    v_pk_add_f32 v[28:29], v[28:29], v[8:9]
    v_lshlrev_b32 v8, 16, v73
    v_and_b32 v9, 0xffff0000, v73
    v_pk_add_f32 v[30:31], v[30:31], v[8:9]
    v_lshlrev_b32 v8, 16, v74
    v_and_b32 v9, 0xffff0000, v74
    v_pk_add_f32 v[32:33], v[32:33], v[8:9]
    v_lshlrev_b32 v8, 16, v75
    v_and_b32 v9, 0xffff0000, v75
    v_pk_add_f32 v[34:35], v[34:35], v[8:9]
    s_waitcnt vmcnt(6)
    v_lshlrev_b32 v8, 16, v76
    v_and_b32 v9, 0xffff0000, v76
    v_pk_add_f32 v[20:21], v[20:21], v[8:9]
    v_lshlrev_b32 v8, 16, v77
    v_and_b32 v9, 0xffff0000, v77
    v_pk_add_f32 v[22:23], v[22:23], v[8:9]
    v_lshlrev_b32 v8, 16, v78
    v_and_b32 v9, 0xffff0000, v78
    v_pk_add_f32 v[24:25], v[24:25], v[8:9]
    v_lshlrev_b32 v8, 16, v79
    v_and_b32 v9, 0xffff0000, v79
    v_pk_add_f32 v[26:27], v[26:27], v[8:9]
    v_lshlrev_b32 v8, 16, v80
    v_and_b32 v9, 0xffff0000, v80
    v_pk_add_f32 v[28:29], v[28:29], v[8:9]
    v_lshlrev_b32 v8, 16, v81
    v_and_b32 v9, 0xffff0000, v81
    v_pk_add_f32 v[30:31], v[30:31], v[8:9]
    v_lshlrev_b32 v8, 16, v82
    v_and_b32 v9, 0xffff0000, v82
    v_pk_add_f32 v[32:33], v[32:33], v[8:9]
    v_lshlrev_b32 v8, 16, v83
    v_and_b32 v9, 0xffff0000, v83
    v_pk_add_f32 v[34:35], v[34:35], v[8:9]
    s_waitcnt vmcnt(4)
    v_lshlrev_b32 v8, 16, v84
    v_and_b32 v9, 0xffff0000, v84
    v_pk_add_f32 v[20:21], v[20:21], v[8:9]
    v_lshlrev_b32 v8, 16, v85
    v_and_b32 v9, 0xffff0000, v85
    v_pk_add_f32 v[22:23], v[22:23], v[8:9]
    v_lshlrev_b32 v8, 16, v86
    v_and_b32 v9, 0xffff0000, v86
    v_pk_add_f32 v[24:25], v[24:25], v[8:9]
    v_lshlrev_b32 v8, 16, v87
    v_and_b32 v9, 0xffff0000, v87
    v_pk_add_f32 v[26:27], v[26:27], v[8:9]
    v_lshlrev_b32 v8, 16, v88
    v_and_b32 v9, 0xffff0000, v88
    v_pk_add_f32 v[28:29], v[28:29], v[8:9]
    v_lshlrev_b32 v8, 16, v89
    v_and_b32 v9, 0xffff0000, v89
    v_pk_add_f32 v[30:31], v[30:31], v[8:9]
    v_lshlrev_b32 v8, 16, v90
    v_and_b32 v9, 0xffff0000, v90
    v_pk_add_f32 v[32:33], v[32:33], v[8:9]
    v_lshlrev_b32 v8, 16, v91
    v_and_b32 v9, 0xffff0000, v91
    v_pk_add_f32 v[34:35], v[34:35], v[8:9]
    s_waitcnt vmcnt(2)
    v_lshlrev_b32 v8, 16, v92
    v_and_b32 v9, 0xffff0000, v92
    v_pk_add_f32 v[20:21], v[20:21], v[8:9]
    v_lshlrev_b32 v8, 16, v93
    v_and_b32 v9, 0xffff0000, v93
    v_pk_add_f32 v[22:23], v[22:23], v[8:9]
    v_lshlrev_b32 v8, 16, v94
    v_and_b32 v9, 0xffff0000, v94
    v_pk_add_f32 v[24:25], v[24:25], v[8:9]
    v_lshlrev_b32 v8, 16, v95
    v_and_b32 v9, 0xffff0000, v95
    v_pk_add_f32 v[26:27], v[26:27], v[8:9]
    v_lshlrev_b32 v8, 16, v96
    v_and_b32 v9, 0xffff0000, v96
    v_pk_add_f32 v[28:29], v[28:29], v[8:9]
    v_lshlrev_b32 v8, 16, v97
    v_and_b32 v9, 0xffff0000, v97
    v_pk_add_f32 v[30:31], v[30:31], v[8:9]
    v_lshlrev_b32 v8, 16, v98
    v_and_b32 v9, 0xffff0000, v98
    v_pk_add_f32 v[32:33], v[32:33], v[8:9]
    v_lshlrev_b32 v8, 16, v99
    v_and_b32 v9, 0xffff0000, v99
    v_pk_add_f32 v[34:35], v[34:35], v[8:9]
    s_waitcnt vmcnt(0)
    v_lshlrev_b32 v8, 16, v100
    v_and_b32 v9, 0xffff0000, v100
    v_pk_add_f32 v[20:21], v[20:21], v[8:9]
    v_lshlrev_b32 v8, 16, v101
    v_and_b32 v9, 0xffff0000, v101
    v_pk_add_f32 v[22:23], v[22:23], v[8:9]
    v_lshlrev_b32 v8, 16, v102
    v_and_b32 v9, 0xffff0000, v102
    v_pk_add_f32 v[24:25], v[24:25], v[8:9]
    v_lshlrev_b32 v8, 16, v103
    v_and_b32 v9, 0xffff0000, v103
    v_pk_add_f32 v[26:27], v[26:27], v[8:9]
    v_lshlrev_b32 v8, 16, v104
    v_and_b32 v9, 0xffff0000, v104
    v_pk_add_f32 v[28:29], v[28:29], v[8:9]
    v_lshlrev_b32 v8, 16, v105
    v_and_b32 v9, 0xffff0000, v105
    v_pk_add_f32 v[30:31], v[30:31], v[8:9]
    v_lshlrev_b32 v8, 16, v106
    v_and_b32 v9, 0xffff0000, v106
    v_pk_add_f32 v[32:33], v[32:33], v[8:9]
    v_lshlrev_b32 v8, 16, v107
    v_and_b32 v9, 0xffff0000, v107
    v_pk_add_f32 v[34:35], v[34:35], v[8:9]
    v_cvt_pk_bf16_f32 v44, v20, v21
    v_cvt_pk_bf16_f32 v45, v22, v23
    v_cvt_pk_bf16_f32 v46, v24, v25
    v_cvt_pk_bf16_f32 v47, v26, v27
    v_cvt_pk_bf16_f32 v48, v28, v29
    v_cvt_pk_bf16_f32 v49, v30, v31
    v_cvt_pk_bf16_f32 v50, v32, v33
    v_cvt_pk_bf16_f32 v51, v34, v35
    v_lshlrev_b32 v20, 16, v44
    v_and_b32 v21, 0xffff0000, v44
    v_lshlrev_b32 v22, 16, v45
    v_and_b32 v23, 0xffff0000, v45
    v_lshlrev_b32 v24, 16, v46
    v_and_b32 v25, 0xffff0000, v46
    v_lshlrev_b32 v26, 16, v47
    v_and_b32 v27, 0xffff0000, v47
    v_lshlrev_b32 v28, 16, v48
    v_and_b32 v29, 0xffff0000, v48
    v_lshlrev_b32 v30, 16, v49
    v_and_b32 v31, 0xffff0000, v49
    v_lshlrev_b32 v32, 16, v50
    v_and_b32 v33, 0xffff0000, v50
    v_lshlrev_b32 v34, 16, v51
    v_and_b32 v35, 0xffff0000, v51
    v_lshlrev_b32 v8, 16, v36
    v_and_b32 v9, 0xffff0000, v36
    v_pk_add_f32 v[20:21], v[20:21], v[8:9]
    v_lshlrev_b32 v8, 16, v37
    v_and_b32 v9, 0xffff0000, v37
    v_pk_add_f32 v[22:23], v[22:23], v[8:9]
    v_lshlrev_b32 v8, 16, v38
    v_and_b32 v9, 0xffff0000, v38
    v_pk_add_f32 v[24:25], v[24:25], v[8:9]
    v_lshlrev_b32 v8, 16, v39
    v_and_b32 v9, 0xffff0000, v39
    v_pk_add_f32 v[26:27], v[26:27], v[8:9]
    v_lshlrev_b32 v8, 16, v40
    v_and_b32 v9, 0xffff0000, v40
    v_pk_add_f32 v[28:29], v[28:29], v[8:9]
    v_lshlrev_b32 v8, 16, v41
    v_and_b32 v9, 0xffff0000, v41
    v_pk_add_f32 v[30:31], v[30:31], v[8:9]
    v_lshlrev_b32 v8, 16, v42
    v_and_b32 v9, 0xffff0000, v42
    v_pk_add_f32 v[32:33], v[32:33], v[8:9]
    v_lshlrev_b32 v8, 16, v43
    v_and_b32 v9, 0xffff0000, v43
    v_pk_add_f32 v[34:35], v[34:35], v[8:9]
    v_cvt_pk_bf16_f32 v36, v20, v21
    v_cvt_pk_bf16_f32 v37, v22, v23
    v_cvt_pk_bf16_f32 v38, v24, v25
    v_cvt_pk_bf16_f32 v39, v26, v27
    v_cvt_pk_bf16_f32 v40, v28, v29
    v_cvt_pk_bf16_f32 v41, v30, v31
    v_cvt_pk_bf16_f32 v42, v32, v33
    v_cvt_pk_bf16_f32 v43, v34, v35
    s_add_u32 s4, s7, 117440512
    buffer_store_dwordx4 v[36:39], v2, s[8:11], s4 offen offset:0 sc1
    buffer_store_dwordx4 v[40:43], v2, s[8:11], s4 offen offset:128 sc1
    v_lshlrev_b32 v20, 16, v36
    v_and_b32 v21, 0xffff0000, v36
    v_lshlrev_b32 v22, 16, v37
    v_and_b32 v23, 0xffff0000, v37
    v_lshlrev_b32 v24, 16, v38
    v_and_b32 v25, 0xffff0000, v38
    v_lshlrev_b32 v26, 16, v39
    v_and_b32 v27, 0xffff0000, v39
    v_lshlrev_b32 v28, 16, v40
    v_and_b32 v29, 0xffff0000, v40
    v_lshlrev_b32 v30, 16, v41
    v_and_b32 v31, 0xffff0000, v41
    v_lshlrev_b32 v32, 16, v42
    v_and_b32 v33, 0xffff0000, v42
    v_lshlrev_b32 v34, 16, v43
    v_and_b32 v35, 0xffff0000, v43
    v_pk_add_f32 v[8:9], v[20:21], v[22:23]
    v_pk_add_f32 v[8:9], v[8:9], v[24:25]
    v_pk_add_f32 v[8:9], v[8:9], v[26:27]
    v_pk_add_f32 v[8:9], v[8:9], v[28:29]
    v_pk_add_f32 v[8:9], v[8:9], v[30:31]
    v_pk_add_f32 v[8:9], v[8:9], v[32:33]
    v_pk_add_f32 v[8:9], v[8:9], v[34:35]
    v_add_f32 v8, v8, v9
    s_nop 1
    v_add_f32_dpp v8, v8, v8 row_ror:8 row_mask:0xf bank_mask:0xf
    v_mov_b32 v12, v8
    s_nop 1
    v_permlane16_swap_b32 v8, v12
    v_add_f32 v8, v8, v12
    v_mov_b32 v12, v8
    s_nop 1
    v_permlane32_swap_b32 v8, v12
    v_add_f32 v8, v8, v12
    ds_write_b64 v15, v[8:9] offset:0
    s_waitcnt lgkmcnt(0)
    s_barrier
    ds_read_b128 v[44:47], v16 offset:0
    ds_read_b128 v[48:51], v16 offset:16
    s_waitcnt lgkmcnt(0)
    v_pk_add_f32 v[44:45], v[44:45], v[46:47]
    v_pk_add_f32 v[48:49], v[48:49], v[50:51]
    v_pk_add_f32 v[8:9], v[44:45], v[48:49]
    v_mul_f32 v10, 0xbb000000, v8
    v_cvt_pk_bf16_f32 v10, v10, v10
    v_lshlrev_b32 v10, 16, v10
    v_mov_b32 v11, v10
    v_pk_add_f32 v[20:21], v[20:21], v[10:11]
    v_pk_add_f32 v[22:23], v[22:23], v[10:11]
    v_pk_add_f32 v[24:25], v[24:25], v[10:11]
    v_pk_add_f32 v[26:27], v[26:27], v[10:11]
    v_pk_add_f32 v[28:29], v[28:29], v[10:11]
    v_pk_add_f32 v[30:31], v[30:31], v[10:11]
    v_pk_add_f32 v[32:33], v[32:33], v[10:11]
    v_pk_add_f32 v[34:35], v[34:35], v[10:11]
    v_pk_mul_f32 v[10:11], v[20:21], v[20:21]
    v_pk_fma_f32 v[10:11], v[22:23], v[22:23], v[10:11]
    v_pk_fma_f32 v[10:11], v[24:25], v[24:25], v[10:11]
    v_pk_fma_f32 v[10:11], v[26:27], v[26:27], v[10:11]
    v_pk_fma_f32 v[10:11], v[28:29], v[28:29], v[10:11]
    v_pk_fma_f32 v[10:11], v[30:31], v[30:31], v[10:11]
    v_pk_fma_f32 v[10:11], v[32:33], v[32:33], v[10:11]
    v_pk_fma_f32 v[10:11], v[34:35], v[34:35], v[10:11]
    v_add_f32 v8, v10, v11
    s_nop 1
    v_add_f32_dpp v8, v8, v8 row_ror:8 row_mask:0xf bank_mask:0xf
    v_mov_b32 v12, v8
    s_nop 1
    v_permlane16_swap_b32 v8, v12
    v_add_f32 v8, v8, v12
    v_mov_b32 v12, v8
    s_nop 1
    v_permlane32_swap_b32 v8, v12
    v_add_f32 v8, v8, v12
    ds_write_b64 v15, v[8:9] offset:256
    s_waitcnt lgkmcnt(0)
    s_barrier
    ds_read_b128 v[44:47], v16 offset:256
    ds_read_b128 v[48:51], v16 offset:272
    s_waitcnt lgkmcnt(0)
    v_pk_add_f32 v[44:45], v[44:45], v[46:47]
    v_pk_add_f32 v[48:49], v[48:49], v[50:51]
    v_pk_add_f32 v[8:9], v[44:45], v[48:49]
    v_mul_f32 v12, 0x3b000000, v8
    v_cvt_pk_bf16_f32 v12, v12, v12
    v_lshlrev_b32 v12, 16, v12
    v_add_f32 v12, 0x3727c5ac, v12
    v_cvt_pk_bf16_f32 v12, v12, v12
    v_lshlrev_b32 v12, 16, v12
    v_sqrt_f32 v12, v12
    s_nop 0
    v_cvt_pk_bf16_f32 v12, v12, v12
    v_lshlrev_b32 v12, 16, v12
    v_rcp_f32 v8, v12
    s_nop 0
    v_mov_b32 v9, v8
    v_pk_mul_f32 v[20:21], v[20:21], v[8:9]
    v_pk_mul_f32 v[22:23], v[22:23], v[8:9]
    v_pk_mul_f32 v[24:25], v[24:25], v[8:9]
    v_pk_mul_f32 v[26:27], v[26:27], v[8:9]
    v_pk_mul_f32 v[28:29], v[28:29], v[8:9]
    v_pk_mul_f32 v[30:31], v[30:31], v[8:9]
    v_pk_mul_f32 v[32:33], v[32:33], v[8:9]
    v_pk_mul_f32 v[34:35], v[34:35], v[8:9]
    v_cvt_pk_bf16_f32 v44, v20, v21
    v_cvt_pk_bf16_f32 v45, v22, v23
    v_cvt_pk_bf16_f32 v46, v24, v25
    v_cvt_pk_bf16_f32 v47, v26, v27
    v_cvt_pk_bf16_f32 v48, v28, v29
    v_cvt_pk_bf16_f32 v49, v30, v31
    v_cvt_pk_bf16_f32 v50, v32, v33
    v_cvt_pk_bf16_f32 v51, v34, v35
    v_lshlrev_b32 v20, 16, v44
    v_and_b32 v21, 0xffff0000, v44
    v_lshlrev_b32 v22, 16, v45
    v_and_b32 v23, 0xffff0000, v45
    v_lshlrev_b32 v24, 16, v46
    v_and_b32 v25, 0xffff0000, v46
    v_lshlrev_b32 v26, 16, v47
    v_and_b32 v27, 0xffff0000, v47
    v_lshlrev_b32 v28, 16, v48
    v_and_b32 v29, 0xffff0000, v48
    v_lshlrev_b32 v30, 16, v49
    v_and_b32 v31, 0xffff0000, v49
    v_lshlrev_b32 v32, 16, v50
    v_and_b32 v33, 0xffff0000, v50
    v_lshlrev_b32 v34, 16, v51
    v_and_b32 v35, 0xffff0000, v51
    v_pk_add_f32 v[8:9], v[20:21], v[22:23]
    v_pk_add_f32 v[8:9], v[8:9], v[24:25]
    v_pk_add_f32 v[8:9], v[8:9], v[26:27]
    v_pk_add_f32 v[8:9], v[8:9], v[28:29]
    v_pk_add_f32 v[8:9], v[8:9], v[30:31]
    v_pk_add_f32 v[8:9], v[8:9], v[32:33]
    v_pk_add_f32 v[8:9], v[8:9], v[34:35]
    v_add_f32 v8, v8, v9
    v_pk_mul_f32 v[10:11], v[20:21], v[20:21]
    v_pk_fma_f32 v[10:11], v[22:23], v[22:23], v[10:11]
    v_pk_fma_f32 v[10:11], v[24:25], v[24:25], v[10:11]
    v_pk_fma_f32 v[10:11], v[26:27], v[26:27], v[10:11]
    v_pk_fma_f32 v[10:11], v[28:29], v[28:29], v[10:11]
    v_pk_fma_f32 v[10:11], v[30:31], v[30:31], v[10:11]
    v_pk_fma_f32 v[10:11], v[32:33], v[32:33], v[10:11]
    v_pk_fma_f32 v[10:11], v[34:35], v[34:35], v[10:11]
    v_add_f32 v9, v10, v11
    s_nop 1
    v_add_f32_dpp v8, v8, v8 row_ror:8 row_mask:0xf bank_mask:0xf
    v_mov_b32 v12, v8
    s_nop 1
    v_permlane16_swap_b32 v8, v12
    v_add_f32 v8, v8, v12
    v_mov_b32 v12, v8
    s_nop 1
    v_permlane32_swap_b32 v8, v12
    v_add_f32 v8, v8, v12
    s_nop 1
    v_add_f32_dpp v9, v9, v9 row_ror:8 row_mask:0xf bank_mask:0xf
    v_mov_b32 v12, v9
    s_nop 1
    v_permlane16_swap_b32 v9, v12
    v_add_f32 v9, v9, v12
    v_mov_b32 v12, v9
    s_nop 1
    v_permlane32_swap_b32 v9, v12
    v_add_f32 v9, v9, v12
    ds_write_b64 v15, v[8:9] offset:512
    s_waitcnt lgkmcnt(0)
    s_barrier
    ds_read_b128 v[44:47], v16 offset:512
    ds_read_b128 v[48:51], v16 offset:528
    s_waitcnt lgkmcnt(0)
    v_pk_add_f32 v[44:45], v[44:45], v[46:47]
    v_pk_add_f32 v[48:49], v[48:49], v[50:51]
    v_pk_add_f32 v[8:9], v[44:45], v[48:49]
    v_mul_f32 v12, 0x3b000000, v8
    v_mul_f32 v12, v12, v12
    v_mov_b32 v10, 0x3b000000
    v_fma_f32 v12, v9, v10, -v12
    v_max_f32 v12, 0, v12
    v_mul_f32 v10, 0xbb000000, v8
    v_cvt_pk_bf16_f32 v10, v10, v10
    v_lshlrev_b32 v10, 16, v10
    v_mov_b32 v11, v10
    v_pk_add_f32 v[20:21], v[20:21], v[10:11]
    v_pk_add_f32 v[22:23], v[22:23], v[10:11]
    v_pk_add_f32 v[24:25], v[24:25], v[10:11]
    v_pk_add_f32 v[26:27], v[26:27], v[10:11]
    v_pk_add_f32 v[28:29], v[28:29], v[10:11]
    v_pk_add_f32 v[30:31], v[30:31], v[10:11]
    v_pk_add_f32 v[32:33], v[32:33], v[10:11]
    v_pk_add_f32 v[34:35], v[34:35], v[10:11]
    v_cvt_pk_bf16_f32 v12, v12, v12
    v_lshlrev_b32 v12, 16, v12
    v_add_f32 v12, 0x3727c5ac, v12
    v_cvt_pk_bf16_f32 v12, v12, v12
    v_lshlrev_b32 v12, 16, v12
    v_sqrt_f32 v12, v12
    s_nop 0
    v_cvt_pk_bf16_f32 v12, v12, v12
    v_lshlrev_b32 v12, 16, v12
    v_rcp_f32 v8, v12
    s_nop 0
    v_mov_b32 v9, v8
    v_pk_mul_f32 v[20:21], v[20:21], v[8:9]
    v_pk_mul_f32 v[22:23], v[22:23], v[8:9]
    v_pk_mul_f32 v[24:25], v[24:25], v[8:9]
    v_pk_mul_f32 v[26:27], v[26:27], v[8:9]
    v_pk_mul_f32 v[28:29], v[28:29], v[8:9]
    v_pk_mul_f32 v[30:31], v[30:31], v[8:9]
    v_pk_mul_f32 v[32:33], v[32:33], v[8:9]
    v_pk_mul_f32 v[34:35], v[34:35], v[8:9]
    v_cvt_pk_bf16_f32 v44, v20, v21
    v_cvt_pk_bf16_f32 v45, v22, v23
    v_cvt_pk_bf16_f32 v46, v24, v25
    v_cvt_pk_bf16_f32 v47, v26, v27
    v_cvt_pk_bf16_f32 v48, v28, v29
    v_cvt_pk_bf16_f32 v49, v30, v31
    v_cvt_pk_bf16_f32 v50, v32, v33
    v_cvt_pk_bf16_f32 v51, v34, v35
    ds_write_b128 v5, v[44:47] offset:0
    ds_write_b128 v5, v[48:51] offset:128
    s_waitcnt lgkmcnt(0)
    ds_read_b32 v20, v6 offset:0
    ds_read_b32 v21, v6 offset:272
    ds_read_b32 v22, v6 offset:544
    ds_read_b32 v23, v6 offset:816
    ds_read_b32 v24, v6 offset:1088
    ds_read_b32 v25, v6 offset:1360
    ds_read_b32 v26, v6 offset:1632
    ds_read_b32 v27, v6 offset:1904
    s_add_u32 s23, s23, 1
    v_mov_b32 v3, s23
    s_waitcnt lgkmcnt(0)
    v_perm_b32 v52, v21, v20, s20
    v_perm_b32 v53, v23, v22, s20
    v_perm_b32 v54, v25, v24, s20
    v_perm_b32 v55, v27, v26, s20
    v_perm_b32 v56, v21, v20, s21
    v_perm_b32 v57, v23, v22, s21
    v_perm_b32 v58, v25, v24, s21
    v_perm_b32 v59, v27, v26, s21
    buffer_store_dwordx4 v[52:55], v7, s[8:11], s22 offen offset:0 sc1
    buffer_store_dwordx4 v[56:59], v7, s[8:11], s22 offen offset:16 sc1
    s_add_u32 s26, s26, 2
    s_add_u32 s7, s7, 262144
    s_add_u32 s22, s22, 16384
    s_add_u32 s6, s6, 262144
    s_waitcnt vmcnt(0)
    s_barrier
    s_cmp_lg_u32 s100, 0
    s_cbranch_scc1 L_ln_nf
    s_mov_b64 exec, 1
    buffer_store_dword v3, v14, s[8:11], s25 offen sc1
    s_mov_b64 exec, -1
L_ln_nf:
    s_cmp_lt_u32 s23, 8
    s_cbranch_scc1 L_ln_loop
    s_branch L_m_g2
L_m_g1:
    s_load_dwordx4 s[32:35], s[0:1], 64
    s_load_dwordx2 s[36:37], s[0:1], 112
    v_and_b32 v1, 63, v0
    s_sub_u32 s7, s101, 32
    s_lshr_b32 s6, s7, 2
    s_and_b32 s5, s7, 3
    s_lshl_b32 s5, s5, 2
    s_add_u32 s5, s5, s100
    s_mov_b32 s23, 0x05040100
    s_mov_b32 s24, 0x07060302
    s_waitcnt lgkmcnt(0)
    s_mov_b32 s8, s36
    s_and_b32 s9, s37, 0xffff
    s_mov_b32 s10, 268435456
    s_mov_b32 s11, 0x00020000
    s_mov_b32 s12, s32
    s_and_b32 s13, s33, 0xffff
    s_mov_b32 s14, 7340032
    s_mov_b32 s15, 0x00020000
    s_mov_b32 s16, s34
    s_and_b32 s17, s35, 0xffff
    s_mov_b32 s18, 3584
    s_mov_b32 s19, 0x00020000
    v_lshrrev_b32 v2, 5, v1
    v_lshlrev_b32 v2, 3, v2
    v_bfe_u32 v8, v1, 4, 1
    v_add_u32 v2, v2, v8
    v_mul_u32_u24 v2, 3584, v2
    v_and_b32 v8, 15, v1
    v_lshl_add_u32 v8, v8, 4, v2
    v_add_u32 v9, 7168, v8
    v_add_u32 v10, 14336, v8
    v_add_u32 v11, 21504, v8
    v_lshlrev_b32 v4, 4, v1
    v_lshlrev_b32 v5, 7, v1
    s_lshl_b32 s22, s6, 8
    s_lshl_b32 s25, s5, 17
    s_add_u32 s25, s25, 119537664
    v_mov_b64 v[176:177], 0
    v_mov_b64 v[178:179], 0
    v_mov_b64 v[180:181], 0
    v_mov_b64 v[182:183], 0
    v_mov_b64 v[184:185], 0
    v_mov_b64 v[186:187], 0
    v_mov_b64 v[188:189], 0
    v_mov_b64 v[190:191], 0
    v_mov_b64 v[192:193], 0
    v_mov_b64 v[194:195], 0
    v_mov_b64 v[196:197], 0
    v_mov_b64 v[198:199], 0
    v_mov_b64 v[200:201], 0
    v_mov_b64 v[202:203], 0
    v_mov_b64 v[204:205], 0
    v_mov_b64 v[206:207], 0
    v_mov_b64 v[208:209], 0
    v_mov_b64 v[210:211], 0
    v_mov_b64 v[212:213], 0
    v_mov_b64 v[214:215], 0
    v_mov_b64 v[216:217], 0
    v_mov_b64 v[218:219], 0
    v_mov_b64 v[220:221], 0
    v_mov_b64 v[222:223], 0
    v_mov_b64 v[224:225], 0
    v_mov_b64 v[226:227], 0
    v_mov_b64 v[228:229], 0
    v_mov_b64 v[230:231], 0
    v_mov_b64 v[232:233], 0
    v_mov_b64 v[234:235], 0
    v_mov_b64 v[236:237], 0
    v_mov_b64 v[238:239], 0
    s_mov_b32 s21, 0
    v_lshrrev_b32 v3, 5, v1
    v_and_b32 v2, 31, v1
    v_lshlrev_b32 v7, 6, v3
    v_lshlrev_b32 v6, 11, v3
    v_lshl_add_u32 v6, v2, 4, v6
    s_lshl_b32 s7, s6, 8
    buffer_load_dwordx4 v[128:131], v7, s[16:19], s7 offen offset:0
    buffer_load_dwordx4 v[132:135], v7, s[16:19], s7 offen offset:16
    buffer_load_dwordx4 v[136:139], v7, s[16:19], s7 offen offset:32
    buffer_load_dwordx4 v[140:143], v7, s[16:19], s7 offen offset:48
    buffer_load_dwordx4 v[144:147], v7, s[16:19], s7 offen offset:128
    buffer_load_dwordx4 v[148:151], v7, s[16:19], s7 offen offset:144
    buffer_load_dwordx4 v[152:155], v7, s[16:19], s7 offen offset:160
    buffer_load_dwordx4 v[156:159], v7, s[16:19], s7 offen offset:176
    v_lshrrev_b32 v160, 1, v1
    v_mul_u32_u24 v160, 3584, v160
    v_and_b32 v161, 1, v1
    v_lshl_add_u32 v160, v161, 7, v160
    s_lshl_b32 s20, s100, 6
    s_add_u32 s20, s20, 1792
    s_mul_i32 s20, s20, 3584
    s_add_u32 s20, s20, s22
    buffer_load_dword v161, v160, s[12:15], s20 offen
    s_add_u32 s20, s20, 114688
    buffer_load_dword v162, v160, s[12:15], s20 offen
    buffer_load_dwordx4 v[16:19], v8, s[12:15], s22 offen
    buffer_load_dwordx4 v[20:23], v9, s[12:15], s22 offen
    buffer_load_dwordx4 v[24:27], v10, s[12:15], s22 offen
    buffer_load_dwordx4 v[28:31], v11, s[12:15], s22 offen
    s_add_u32 s22, s22, 57344
    buffer_load_dwordx4 v[32:35], v8, s[12:15], s22 offen
    buffer_load_dwordx4 v[36:39], v9, s[12:15], s22 offen
    buffer_load_dwordx4 v[40:43], v10, s[12:15], s22 offen
    buffer_load_dwordx4 v[44:47], v11, s[12:15], s22 offen
    s_add_u32 s22, s22, 57344
    v_mov_b32 v2, 0
    s_waitcnt vmcnt(0)
    v_permlane16_swap_b32 v16, v18
    v_permlane16_swap_b32 v17, v19
    v_permlane16_swap_b32 v20, v22
    v_permlane16_swap_b32 v21, v23
    v_permlane16_swap_b32 v24, v26
    v_permlane16_swap_b32 v25, v27
    v_permlane16_swap_b32 v28, v30
    v_permlane16_swap_b32 v29, v31
    v_perm_b32 v80, v18, v16, s23
    v_perm_b32 v81, v22, v20, s23
    v_perm_b32 v82, v26, v24, s23
    v_perm_b32 v83, v30, v28, s23
    v_perm_b32 v84, v18, v16, s24
    v_perm_b32 v85, v22, v20, s24
    v_perm_b32 v86, v26, v24, s24
    v_perm_b32 v87, v30, v28, s24
    v_perm_b32 v88, v19, v17, s23
    v_perm_b32 v89, v23, v21, s23
    v_perm_b32 v90, v27, v25, s23
    v_perm_b32 v91, v31, v29, s23
    v_perm_b32 v92, v19, v17, s24
    v_perm_b32 v93, v23, v21, s24
    v_perm_b32 v94, v27, v25, s24
    v_perm_b32 v95, v31, v29, s24
    v_permlane16_swap_b32 v32, v34
    v_permlane16_swap_b32 v33, v35
    v_permlane16_swap_b32 v36, v38
    v_permlane16_swap_b32 v37, v39
    v_permlane16_swap_b32 v40, v42
    v_permlane16_swap_b32 v41, v43
    v_permlane16_swap_b32 v44, v46
    v_permlane16_swap_b32 v45, v47
    v_perm_b32 v96, v34, v32, s23
    v_perm_b32 v97, v38, v36, s23
    v_perm_b32 v98, v42, v40, s23
    v_perm_b32 v99, v46, v44, s23
    v_perm_b32 v100, v34, v32, s24
    v_perm_b32 v101, v38, v36, s24
    v_perm_b32 v102, v42, v40, s24
    v_perm_b32 v103, v46, v44, s24
    v_perm_b32 v104, v35, v33, s23
    v_perm_b32 v105, v39, v37, s23
    v_perm_b32 v106, v43, v41, s23
    v_perm_b32 v107, v47, v45, s23
    v_perm_b32 v108, v35, v33, s24
    v_perm_b32 v109, v39, v37, s24
    v_perm_b32 v110, v43, v41, s24
    v_perm_b32 v111, v47, v45, s24
    buffer_load_dwordx4 v[16:19], v8, s[12:15], s22 offen
    buffer_load_dwordx4 v[20:23], v9, s[12:15], s22 offen
    buffer_load_dwordx4 v[24:27], v10, s[12:15], s22 offen
    buffer_load_dwordx4 v[28:31], v11, s[12:15], s22 offen
    s_add_u32 s22, s22, 57344
    buffer_load_dwordx4 v[32:35], v8, s[12:15], s22 offen
    buffer_load_dwordx4 v[36:39], v9, s[12:15], s22 offen
    buffer_load_dwordx4 v[40:43], v10, s[12:15], s22 offen
    buffer_load_dwordx4 v[44:47], v11, s[12:15], s22 offen
    s_add_u32 s22, s22, 57344
    s_and_b32 s7, s21, 7
    s_lshl_b32 s27, s7, 9
    s_add_u32 s27, s27, 60895232
L_g1_loop:
    s_lshr_b32 s28, s21, 3
    s_add_u32 s28, s28, 1
    s_mov_b64 exec, 15
    v_cmp_gt_u32 vcc, s28, v2
    s_cbranch_vccz L_g1_go
    s_mov_b32 s29, 400000
L_g1p_20:
    buffer_load_dword v2, v5, s[8:11], s27 offen sc1
    s_waitcnt vmcnt(0)
    v_cmp_gt_u32 vcc, s28, v2
    s_cbranch_vccz L_g1pd_21
    s_sub_u32 s29, s29, 1
    s_cbranch_scc1 L_m_fail
    s_sleep 1
    s_cmp_ge_u32 s21, 54
    s_cbranch_scc1 L_g1p_20
    s_sleep 64
    s_branch L_g1p_20
L_g1pd_21:
L_g1_go:
    s_mov_b64 exec, -1
    buffer_load_dwordx4 v[112:115], v4, s[8:11], s25 offen sc1
    buffer_load_dwordx4 v[116:119], v4, s[8:11], s25 offen offset:1024 sc1
    s_add_u32 s25, s25, 2048
    s_add_u32 s21, s21, 1
    s_and_b32 s7, s21, 7
    s_lshl_b32 s27, s7, 9
    s_add_u32 s27, s27, 60895232
    s_mov_b64 exec, 15
    buffer_load_dword v2, v5, s[8:11], s27 offen sc1
    s_mov_b64 exec, -1
    s_waitcnt vmcnt(1)
    v_mfma_f32_32x32x16_bf16 v[176:191], v[80:83], v[112:115], v[176:191]
    v_mfma_f32_32x32x16_bf16 v[192:207], v[84:87], v[112:115], v[192:207]
    v_mfma_f32_32x32x16_bf16 v[208:223], v[88:91], v[112:115], v[208:223]
    v_mfma_f32_32x32x16_bf16 v[224:239], v[92:95], v[112:115], v[224:239]
    v_mfma_f32_32x32x16_bf16 v[176:191], v[96:99], v[116:119], v[176:191]
    v_mfma_f32_32x32x16_bf16 v[192:207], v[100:103], v[116:119], v[192:207]
    v_mfma_f32_32x32x16_bf16 v[208:223], v[104:107], v[116:119], v[208:223]
    v_mfma_f32_32x32x16_bf16 v[224:239], v[108:111], v[116:119], v[224:239]
    s_cmp_ge_u32 s21, 64
    s_cbranch_scc1 L_g1_end
    v_permlane16_swap_b32 v16, v18
    v_permlane16_swap_b32 v17, v19
    v_permlane16_swap_b32 v20, v22
    v_permlane16_swap_b32 v21, v23
    v_permlane16_swap_b32 v24, v26
    v_permlane16_swap_b32 v25, v27
    v_permlane16_swap_b32 v28, v30
    v_permlane16_swap_b32 v29, v31
    v_perm_b32 v80, v18, v16, s23
    v_perm_b32 v81, v22, v20, s23
    v_perm_b32 v82, v26, v24, s23
    v_perm_b32 v83, v30, v28, s23
    v_perm_b32 v84, v18, v16, s24
    v_perm_b32 v85, v22, v20, s24
    v_perm_b32 v86, v26, v24, s24
    v_perm_b32 v87, v30, v28, s24
    v_perm_b32 v88, v19, v17, s23
    v_perm_b32 v89, v23, v21, s23
    v_perm_b32 v90, v27, v25, s23
    v_perm_b32 v91, v31, v29, s23
    v_perm_b32 v92, v19, v17, s24
    v_perm_b32 v93, v23, v21, s24
    v_perm_b32 v94, v27, v25, s24
    v_perm_b32 v95, v31, v29, s24
    v_permlane16_swap_b32 v32, v34
    v_permlane16_swap_b32 v33, v35
    v_permlane16_swap_b32 v36, v38
    v_permlane16_swap_b32 v37, v39
    v_permlane16_swap_b32 v40, v42
    v_permlane16_swap_b32 v41, v43
    v_permlane16_swap_b32 v44, v46
    v_permlane16_swap_b32 v45, v47
    v_perm_b32 v96, v34, v32, s23
    v_perm_b32 v97, v38, v36, s23
    v_perm_b32 v98, v42, v40, s23
    v_perm_b32 v99, v46, v44, s23
    v_perm_b32 v100, v34, v32, s24
    v_perm_b32 v101, v38, v36, s24
    v_perm_b32 v102, v42, v40, s24
    v_perm_b32 v103, v46, v44, s24
    v_perm_b32 v104, v35, v33, s23
    v_perm_b32 v105, v39, v37, s23
    v_perm_b32 v106, v43, v41, s23
    v_perm_b32 v107, v47, v45, s23
    v_perm_b32 v108, v35, v33, s24
    v_perm_b32 v109, v39, v37, s24
    v_perm_b32 v110, v43, v41, s24
    v_perm_b32 v111, v47, v45, s24
    s_waitcnt vmcnt(0)
    buffer_load_dwordx4 v[16:19], v8, s[12:15], s22 offen
    buffer_load_dwordx4 v[20:23], v9, s[12:15], s22 offen
    buffer_load_dwordx4 v[24:27], v10, s[12:15], s22 offen
    buffer_load_dwordx4 v[28:31], v11, s[12:15], s22 offen
    s_add_u32 s22, s22, 57344
    buffer_load_dwordx4 v[32:35], v8, s[12:15], s22 offen
    buffer_load_dwordx4 v[36:39], v9, s[12:15], s22 offen
    buffer_load_dwordx4 v[40:43], v10, s[12:15], s22 offen
    buffer_load_dwordx4 v[44:47], v11, s[12:15], s22 offen
    s_add_u32 s22, s22, 57344
    s_branch L_g1_loop
L_g1_end:
    s_waitcnt vmcnt(0)
    s_mov_b32 s26, 0x40135761
    v_mov_b32 v2, 0x3dd2d3e8
    s_mul_i32 s7, s5, 114688
    s_lshl_b32 s20, s6, 13
    s_add_u32 s7, s7, s20
    s_add_u32 s7, s7, 123731968
    s_nop 7
    v_lshlrev_b32 v48, 16, v128
    v_and_b32 v49, 0xffff0000, v128
    v_lshlrev_b32 v50, 16, v129
    v_and_b32 v51, 0xffff0000, v129
    v_lshlrev_b32 v52, 16, v130
    v_and_b32 v53, 0xffff0000, v130
    v_lshlrev_b32 v54, 16, v131
    v_and_b32 v55, 0xffff0000, v131
    v_lshlrev_b32 v56, 16, v132
    v_and_b32 v57, 0xffff0000, v132
    v_lshlrev_b32 v58, 16, v133
    v_and_b32 v59, 0xffff0000, v133
    v_lshlrev_b32 v60, 16, v134
    v_and_b32 v61, 0xffff0000, v134
    v_lshlrev_b32 v62, 16, v135
    v_and_b32 v63, 0xffff0000, v135
    v_add_f32 v64, v176, v48
    v_add_f32 v65, v192, v49
    v_add_f32 v66, v208, v50
    v_add_f32 v67, v224, v51
    v_add_f32 v68, v184, v52
    v_add_f32 v69, v200, v53
    v_add_f32 v70, v216, v54
    v_add_f32 v71, v232, v55
    v_add_f32 v72, v177, v56
    v_add_f32 v73, v193, v57
    v_add_f32 v74, v209, v58
    v_add_f32 v75, v225, v59
    v_add_f32 v76, v185, v60
    v_add_f32 v77, v201, v61
    v_add_f32 v78, v217, v62
    v_add_f32 v79, v233, v63
    v_mul_f32 v80, v64, v64
    v_mul_f32 v81, v65, v65
    v_mul_f32 v82, v66, v66
    v_mul_f32 v83, v67, v67
    v_mul_f32 v84, v68, v68
    v_mul_f32 v85, v69, v69
    v_mul_f32 v86, v70, v70
    v_mul_f32 v87, v71, v71
    v_mul_f32 v88, v72, v72
    v_mul_f32 v89, v73, v73
    v_mul_f32 v90, v74, v74
    v_mul_f32 v91, v75, v75
    v_mul_f32 v92, v76, v76
    v_mul_f32 v93, v77, v77
    v_mul_f32 v94, v78, v78
    v_mul_f32 v95, v79, v79
    v_fma_f32 v80, v80, v2, s26
    v_fma_f32 v81, v81, v2, s26
    v_fma_f32 v82, v82, v2, s26
    v_fma_f32 v83, v83, v2, s26
    v_fma_f32 v84, v84, v2, s26
    v_fma_f32 v85, v85, v2, s26
    v_fma_f32 v86, v86, v2, s26
    v_fma_f32 v87, v87, v2, s26
    v_fma_f32 v88, v88, v2, s26
    v_fma_f32 v89, v89, v2, s26
    v_fma_f32 v90, v90, v2, s26
    v_fma_f32 v91, v91, v2, s26
    v_fma_f32 v92, v92, v2, s26
    v_fma_f32 v93, v93, v2, s26
    v_fma_f32 v94, v94, v2, s26
    v_fma_f32 v95, v95, v2, s26
    v_mul_f32_e64 v80, -v64, v80
    v_mul_f32_e64 v81, -v65, v81
    v_mul_f32_e64 v82, -v66, v82
    v_mul_f32_e64 v83, -v67, v83
    v_mul_f32_e64 v84, -v68, v84
    v_mul_f32_e64 v85, -v69, v85
    v_mul_f32_e64 v86, -v70, v86
    v_mul_f32_e64 v87, -v71, v87
    v_mul_f32_e64 v88, -v72, v88
    v_mul_f32_e64 v89, -v73, v89
    v_mul_f32_e64 v90, -v74, v90
    v_mul_f32_e64 v91, -v75, v91
    v_mul_f32_e64 v92, -v76, v92
    v_mul_f32_e64 v93, -v77, v93
    v_mul_f32_e64 v94, -v78, v94
    v_mul_f32_e64 v95, -v79, v95
    v_exp_f32 v80, v80
    v_exp_f32 v81, v81
    v_exp_f32 v82, v82
    v_exp_f32 v83, v83
    v_exp_f32 v84, v84
    v_exp_f32 v85, v85
    v_exp_f32 v86, v86
    v_exp_f32 v87, v87
    v_exp_f32 v88, v88
    v_exp_f32 v89, v89
    v_exp_f32 v90, v90
    v_exp_f32 v91, v91
    v_exp_f32 v92, v92
    v_exp_f32 v93, v93
    v_exp_f32 v94, v94
    v_exp_f32 v95, v95
    v_add_f32 v80, 1.0, v80
    v_add_f32 v81, 1.0, v81
    v_add_f32 v82, 1.0, v82
    v_add_f32 v83, 1.0, v83
    v_add_f32 v84, 1.0, v84
    v_add_f32 v85, 1.0, v85
    v_add_f32 v86, 1.0, v86
    v_add_f32 v87, 1.0, v87
    v_add_f32 v88, 1.0, v88
    v_add_f32 v89, 1.0, v89
    v_add_f32 v90, 1.0, v90
    v_add_f32 v91, 1.0, v91
    v_add_f32 v92, 1.0, v92
    v_add_f32 v93, 1.0, v93
    v_add_f32 v94, 1.0, v94
    v_add_f32 v95, 1.0, v95
    v_rcp_f32 v80, v80
    v_rcp_f32 v81, v81
    v_rcp_f32 v82, v82
    v_rcp_f32 v83, v83
    v_rcp_f32 v84, v84
    v_rcp_f32 v85, v85
    v_rcp_f32 v86, v86
    v_rcp_f32 v87, v87
    v_rcp_f32 v88, v88
    v_rcp_f32 v89, v89
    v_rcp_f32 v90, v90
    v_rcp_f32 v91, v91
    v_rcp_f32 v92, v92
    v_rcp_f32 v93, v93
    v_rcp_f32 v94, v94
    v_rcp_f32 v95, v95
    v_mul_f32 v64, v64, v80
    v_mul_f32 v65, v65, v81
    v_mul_f32 v66, v66, v82
    v_mul_f32 v67, v67, v83
    v_mul_f32 v68, v68, v84
    v_mul_f32 v69, v69, v85
    v_mul_f32 v70, v70, v86
    v_mul_f32 v71, v71, v87
    v_mul_f32 v72, v72, v88
    v_mul_f32 v73, v73, v89
    v_mul_f32 v74, v74, v90
    v_mul_f32 v75, v75, v91
    v_mul_f32 v76, v76, v92
    v_mul_f32 v77, v77, v93
    v_mul_f32 v78, v78, v94
    v_mul_f32 v79, v79, v95
    v_cvt_pk_bf16_f32 v96, v64, v65
    v_cvt_pk_bf16_f32 v97, v66, v67
    v_cvt_pk_bf16_f32 v98, v68, v69
    v_cvt_pk_bf16_f32 v99, v70, v71
    v_cvt_pk_bf16_f32 v100, v72, v73
    v_cvt_pk_bf16_f32 v101, v74, v75
    v_cvt_pk_bf16_f32 v102, v76, v77
    v_cvt_pk_bf16_f32 v103, v78, v79
    buffer_store_dwordx4 v[96:99], v6, s[8:11], s7 offen offset:0 sc1
    buffer_store_dwordx4 v[100:103], v6, s[8:11], s7 offen offset:512 sc1
    v_lshlrev_b32 v48, 16, v136
    v_and_b32 v49, 0xffff0000, v136
    v_lshlrev_b32 v50, 16, v137
    v_and_b32 v51, 0xffff0000, v137
    v_lshlrev_b32 v52, 16, v138
    v_and_b32 v53, 0xffff0000, v138
    v_lshlrev_b32 v54, 16, v139
    v_and_b32 v55, 0xffff0000, v139
    v_lshlrev_b32 v56, 16, v140
    v_and_b32 v57, 0xffff0000, v140
    v_lshlrev_b32 v58, 16, v141
    v_and_b32 v59, 0xffff0000, v141
    v_lshlrev_b32 v60, 16, v142
    v_and_b32 v61, 0xffff0000, v142
    v_lshlrev_b32 v62, 16, v143
    v_and_b32 v63, 0xffff0000, v143
    v_add_f32 v64, v178, v48
    v_add_f32 v65, v194, v49
    v_add_f32 v66, v210, v50
    v_add_f32 v67, v226, v51
    v_add_f32 v68, v186, v52
    v_add_f32 v69, v202, v53
    v_add_f32 v70, v218, v54
    v_add_f32 v71, v234, v55
    v_add_f32 v72, v179, v56
    v_add_f32 v73, v195, v57
    v_add_f32 v74, v211, v58
    v_add_f32 v75, v227, v59
    v_add_f32 v76, v187, v60
    v_add_f32 v77, v203, v61
    v_add_f32 v78, v219, v62
    v_add_f32 v79, v235, v63
    v_mul_f32 v80, v64, v64
    v_mul_f32 v81, v65, v65
    v_mul_f32 v82, v66, v66
    v_mul_f32 v83, v67, v67
    v_mul_f32 v84, v68, v68
    v_mul_f32 v85, v69, v69
    v_mul_f32 v86, v70, v70
    v_mul_f32 v87, v71, v71
    v_mul_f32 v88, v72, v72
    v_mul_f32 v89, v73, v73
    v_mul_f32 v90, v74, v74
    v_mul_f32 v91, v75, v75
    v_mul_f32 v92, v76, v76
    v_mul_f32 v93, v77, v77
    v_mul_f32 v94, v78, v78
    v_mul_f32 v95, v79, v79
    v_fma_f32 v80, v80, v2, s26
    v_fma_f32 v81, v81, v2, s26
    v_fma_f32 v82, v82, v2, s26
    v_fma_f32 v83, v83, v2, s26
    v_fma_f32 v84, v84, v2, s26
    v_fma_f32 v85, v85, v2, s26
    v_fma_f32 v86, v86, v2, s26
    v_fma_f32 v87, v87, v2, s26
    v_fma_f32 v88, v88, v2, s26
    v_fma_f32 v89, v89, v2, s26
    v_fma_f32 v90, v90, v2, s26
    v_fma_f32 v91, v91, v2, s26
    v_fma_f32 v92, v92, v2, s26
    v_fma_f32 v93, v93, v2, s26
    v_fma_f32 v94, v94, v2, s26
    v_fma_f32 v95, v95, v2, s26
    v_mul_f32_e64 v80, -v64, v80
    v_mul_f32_e64 v81, -v65, v81
    v_mul_f32_e64 v82, -v66, v82
    v_mul_f32_e64 v83, -v67, v83
    v_mul_f32_e64 v84, -v68, v84
    v_mul_f32_e64 v85, -v69, v85
    v_mul_f32_e64 v86, -v70, v86
    v_mul_f32_e64 v87, -v71, v87
    v_mul_f32_e64 v88, -v72, v88
    v_mul_f32_e64 v89, -v73, v89
    v_mul_f32_e64 v90, -v74, v90
    v_mul_f32_e64 v91, -v75, v91
    v_mul_f32_e64 v92, -v76, v92
    v_mul_f32_e64 v93, -v77, v93
    v_mul_f32_e64 v94, -v78, v94
    v_mul_f32_e64 v95, -v79, v95
    v_exp_f32 v80, v80
    v_exp_f32 v81, v81
    v_exp_f32 v82, v82
    v_exp_f32 v83, v83
    v_exp_f32 v84, v84
    v_exp_f32 v85, v85
    v_exp_f32 v86, v86
    v_exp_f32 v87, v87
    v_exp_f32 v88, v88
    v_exp_f32 v89, v89
    v_exp_f32 v90, v90
    v_exp_f32 v91, v91
    v_exp_f32 v92, v92
    v_exp_f32 v93, v93
    v_exp_f32 v94, v94
    v_exp_f32 v95, v95
    v_add_f32 v80, 1.0, v80
    v_add_f32 v81, 1.0, v81
    v_add_f32 v82, 1.0, v82
    v_add_f32 v83, 1.0, v83
    v_add_f32 v84, 1.0, v84
    v_add_f32 v85, 1.0, v85
    v_add_f32 v86, 1.0, v86
    v_add_f32 v87, 1.0, v87
    v_add_f32 v88, 1.0, v88
    v_add_f32 v89, 1.0, v89
    v_add_f32 v90, 1.0, v90
    v_add_f32 v91, 1.0, v91
    v_add_f32 v92, 1.0, v92
    v_add_f32 v93, 1.0, v93
    v_add_f32 v94, 1.0, v94
    v_add_f32 v95, 1.0, v95
    v_rcp_f32 v80, v80
    v_rcp_f32 v81, v81
    v_rcp_f32 v82, v82
    v_rcp_f32 v83, v83
    v_rcp_f32 v84, v84
    v_rcp_f32 v85, v85
    v_rcp_f32 v86, v86
    v_rcp_f32 v87, v87
    v_rcp_f32 v88, v88
    v_rcp_f32 v89, v89
    v_rcp_f32 v90, v90
    v_rcp_f32 v91, v91
    v_rcp_f32 v92, v92
    v_rcp_f32 v93, v93
    v_rcp_f32 v94, v94
    v_rcp_f32 v95, v95
    v_mul_f32 v64, v64, v80
    v_mul_f32 v65, v65, v81
    v_mul_f32 v66, v66, v82
    v_mul_f32 v67, v67, v83
    v_mul_f32 v68, v68, v84
    v_mul_f32 v69, v69, v85
    v_mul_f32 v70, v70, v86
    v_mul_f32 v71, v71, v87
    v_mul_f32 v72, v72, v88
    v_mul_f32 v73, v73, v89
    v_mul_f32 v74, v74, v90
    v_mul_f32 v75, v75, v91
    v_mul_f32 v76, v76, v92
    v_mul_f32 v77, v77, v93
    v_mul_f32 v78, v78, v94
    v_mul_f32 v79, v79, v95
    v_cvt_pk_bf16_f32 v104, v64, v65
    v_cvt_pk_bf16_f32 v105, v66, v67
    v_cvt_pk_bf16_f32 v106, v68, v69
    v_cvt_pk_bf16_f32 v107, v70, v71
    v_cvt_pk_bf16_f32 v108, v72, v73
    v_cvt_pk_bf16_f32 v109, v74, v75
    v_cvt_pk_bf16_f32 v110, v76, v77
    v_cvt_pk_bf16_f32 v111, v78, v79
    buffer_store_dwordx4 v[104:107], v6, s[8:11], s7 offen offset:1024 sc1
    buffer_store_dwordx4 v[108:111], v6, s[8:11], s7 offen offset:1536 sc1
    s_add_u32 s7, s7, 4096
    v_lshlrev_b32 v48, 16, v144
    v_and_b32 v49, 0xffff0000, v144
    v_lshlrev_b32 v50, 16, v145
    v_and_b32 v51, 0xffff0000, v145
    v_lshlrev_b32 v52, 16, v146
    v_and_b32 v53, 0xffff0000, v146
    v_lshlrev_b32 v54, 16, v147
    v_and_b32 v55, 0xffff0000, v147
    v_lshlrev_b32 v56, 16, v148
    v_and_b32 v57, 0xffff0000, v148
    v_lshlrev_b32 v58, 16, v149
    v_and_b32 v59, 0xffff0000, v149
    v_lshlrev_b32 v60, 16, v150
    v_and_b32 v61, 0xffff0000, v150
    v_lshlrev_b32 v62, 16, v151
    v_and_b32 v63, 0xffff0000, v151
    v_add_f32 v64, v180, v48
    v_add_f32 v65, v196, v49
    v_add_f32 v66, v212, v50
    v_add_f32 v67, v228, v51
    v_add_f32 v68, v188, v52
    v_add_f32 v69, v204, v53
    v_add_f32 v70, v220, v54
    v_add_f32 v71, v236, v55
    v_add_f32 v72, v181, v56
    v_add_f32 v73, v197, v57
    v_add_f32 v74, v213, v58
    v_add_f32 v75, v229, v59
    v_add_f32 v76, v189, v60
    v_add_f32 v77, v205, v61
    v_add_f32 v78, v221, v62
    v_add_f32 v79, v237, v63
    v_mul_f32 v80, v64, v64
    v_mul_f32 v81, v65, v65
    v_mul_f32 v82, v66, v66
    v_mul_f32 v83, v67, v67
    v_mul_f32 v84, v68, v68
    v_mul_f32 v85, v69, v69
    v_mul_f32 v86, v70, v70
    v_mul_f32 v87, v71, v71
    v_mul_f32 v88, v72, v72
    v_mul_f32 v89, v73, v73
    v_mul_f32 v90, v74, v74
    v_mul_f32 v91, v75, v75
    v_mul_f32 v92, v76, v76
    v_mul_f32 v93, v77, v77
    v_mul_f32 v94, v78, v78
    v_mul_f32 v95, v79, v79
    v_fma_f32 v80, v80, v2, s26
    v_fma_f32 v81, v81, v2, s26
    v_fma_f32 v82, v82, v2, s26
    v_fma_f32 v83, v83, v2, s26
    v_fma_f32 v84, v84, v2, s26
    v_fma_f32 v85, v85, v2, s26
    v_fma_f32 v86, v86, v2, s26
    v_fma_f32 v87, v87, v2, s26
    v_fma_f32 v88, v88, v2, s26
    v_fma_f32 v89, v89, v2, s26
    v_fma_f32 v90, v90, v2, s26
    v_fma_f32 v91, v91, v2, s26
    v_fma_f32 v92, v92, v2, s26
    v_fma_f32 v93, v93, v2, s26
    v_fma_f32 v94, v94, v2, s26
    v_fma_f32 v95, v95, v2, s26
    v_mul_f32_e64 v80, -v64, v80
    v_mul_f32_e64 v81, -v65, v81
    v_mul_f32_e64 v82, -v66, v82
    v_mul_f32_e64 v83, -v67, v83
    v_mul_f32_e64 v84, -v68, v84
    v_mul_f32_e64 v85, -v69, v85
    v_mul_f32_e64 v86, -v70, v86
    v_mul_f32_e64 v87, -v71, v87
    v_mul_f32_e64 v88, -v72, v88
    v_mul_f32_e64 v89, -v73, v89
    v_mul_f32_e64 v90, -v74, v90
    v_mul_f32_e64 v91, -v75, v91
    v_mul_f32_e64 v92, -v76, v92
    v_mul_f32_e64 v93, -v77, v93
    v_mul_f32_e64 v94, -v78, v94
    v_mul_f32_e64 v95, -v79, v95
    v_exp_f32 v80, v80
    v_exp_f32 v81, v81
    v_exp_f32 v82, v82
    v_exp_f32 v83, v83
    v_exp_f32 v84, v84
    v_exp_f32 v85, v85
    v_exp_f32 v86, v86
    v_exp_f32 v87, v87
    v_exp_f32 v88, v88
    v_exp_f32 v89, v89
    v_exp_f32 v90, v90
    v_exp_f32 v91, v91
    v_exp_f32 v92, v92
    v_exp_f32 v93, v93
    v_exp_f32 v94, v94
    v_exp_f32 v95, v95
    v_add_f32 v80, 1.0, v80
    v_add_f32 v81, 1.0, v81
    v_add_f32 v82, 1.0, v82
    v_add_f32 v83, 1.0, v83
    v_add_f32 v84, 1.0, v84
    v_add_f32 v85, 1.0, v85
    v_add_f32 v86, 1.0, v86
    v_add_f32 v87, 1.0, v87
    v_add_f32 v88, 1.0, v88
    v_add_f32 v89, 1.0, v89
    v_add_f32 v90, 1.0, v90
    v_add_f32 v91, 1.0, v91
    v_add_f32 v92, 1.0, v92
    v_add_f32 v93, 1.0, v93
    v_add_f32 v94, 1.0, v94
    v_add_f32 v95, 1.0, v95
    v_rcp_f32 v80, v80
    v_rcp_f32 v81, v81
    v_rcp_f32 v82, v82
    v_rcp_f32 v83, v83
    v_rcp_f32 v84, v84
    v_rcp_f32 v85, v85
    v_rcp_f32 v86, v86
    v_rcp_f32 v87, v87
    v_rcp_f32 v88, v88
    v_rcp_f32 v89, v89
    v_rcp_f32 v90, v90
    v_rcp_f32 v91, v91
    v_rcp_f32 v92, v92
    v_rcp_f32 v93, v93
    v_rcp_f32 v94, v94
    v_rcp_f32 v95, v95
    v_mul_f32 v64, v64, v80
    v_mul_f32 v65, v65, v81
    v_mul_f32 v66, v66, v82
    v_mul_f32 v67, v67, v83
    v_mul_f32 v68, v68, v84
    v_mul_f32 v69, v69, v85
    v_mul_f32 v70, v70, v86
    v_mul_f32 v71, v71, v87
    v_mul_f32 v72, v72, v88
    v_mul_f32 v73, v73, v89
    v_mul_f32 v74, v74, v90
    v_mul_f32 v75, v75, v91
    v_mul_f32 v76, v76, v92
    v_mul_f32 v77, v77, v93
    v_mul_f32 v78, v78, v94
    v_mul_f32 v79, v79, v95
    v_cvt_pk_bf16_f32 v112, v64, v65
    v_cvt_pk_bf16_f32 v113, v66, v67
    v_cvt_pk_bf16_f32 v114, v68, v69
    v_cvt_pk_bf16_f32 v115, v70, v71
    v_cvt_pk_bf16_f32 v116, v72, v73
    v_cvt_pk_bf16_f32 v117, v74, v75
    v_cvt_pk_bf16_f32 v118, v76, v77
    v_cvt_pk_bf16_f32 v119, v78, v79
    buffer_store_dwordx4 v[112:115], v6, s[8:11], s7 offen offset:0 sc1
    buffer_store_dwordx4 v[116:119], v6, s[8:11], s7 offen offset:512 sc1
    v_lshlrev_b32 v48, 16, v152
    v_and_b32 v49, 0xffff0000, v152
    v_lshlrev_b32 v50, 16, v153
    v_and_b32 v51, 0xffff0000, v153
    v_lshlrev_b32 v52, 16, v154
    v_and_b32 v53, 0xffff0000, v154
    v_lshlrev_b32 v54, 16, v155
    v_and_b32 v55, 0xffff0000, v155
    v_lshlrev_b32 v56, 16, v156
    v_and_b32 v57, 0xffff0000, v156
    v_lshlrev_b32 v58, 16, v157
    v_and_b32 v59, 0xffff0000, v157
    v_lshlrev_b32 v60, 16, v158
    v_and_b32 v61, 0xffff0000, v158
    v_lshlrev_b32 v62, 16, v159
    v_and_b32 v63, 0xffff0000, v159
    v_add_f32 v64, v182, v48
    v_add_f32 v65, v198, v49
    v_add_f32 v66, v214, v50
    v_add_f32 v67, v230, v51
    v_add_f32 v68, v190, v52
    v_add_f32 v69, v206, v53
    v_add_f32 v70, v222, v54
    v_add_f32 v71, v238, v55
    v_add_f32 v72, v183, v56
    v_add_f32 v73, v199, v57
    v_add_f32 v74, v215, v58
    v_add_f32 v75, v231, v59
    v_add_f32 v76, v191, v60
    v_add_f32 v77, v207, v61
    v_add_f32 v78, v223, v62
    v_add_f32 v79, v239, v63
    v_mul_f32 v80, v64, v64
    v_mul_f32 v81, v65, v65
    v_mul_f32 v82, v66, v66
    v_mul_f32 v83, v67, v67
    v_mul_f32 v84, v68, v68
    v_mul_f32 v85, v69, v69
    v_mul_f32 v86, v70, v70
    v_mul_f32 v87, v71, v71
    v_mul_f32 v88, v72, v72
    v_mul_f32 v89, v73, v73
    v_mul_f32 v90, v74, v74
    v_mul_f32 v91, v75, v75
    v_mul_f32 v92, v76, v76
    v_mul_f32 v93, v77, v77
    v_mul_f32 v94, v78, v78
    v_mul_f32 v95, v79, v79
    v_fma_f32 v80, v80, v2, s26
    v_fma_f32 v81, v81, v2, s26
    v_fma_f32 v82, v82, v2, s26
    v_fma_f32 v83, v83, v2, s26
    v_fma_f32 v84, v84, v2, s26
    v_fma_f32 v85, v85, v2, s26
    v_fma_f32 v86, v86, v2, s26
    v_fma_f32 v87, v87, v2, s26
    v_fma_f32 v88, v88, v2, s26
    v_fma_f32 v89, v89, v2, s26
    v_fma_f32 v90, v90, v2, s26
    v_fma_f32 v91, v91, v2, s26
    v_fma_f32 v92, v92, v2, s26
    v_fma_f32 v93, v93, v2, s26
    v_fma_f32 v94, v94, v2, s26
    v_fma_f32 v95, v95, v2, s26
    v_mul_f32_e64 v80, -v64, v80
    v_mul_f32_e64 v81, -v65, v81
    v_mul_f32_e64 v82, -v66, v82
    v_mul_f32_e64 v83, -v67, v83
    v_mul_f32_e64 v84, -v68, v84
    v_mul_f32_e64 v85, -v69, v85
    v_mul_f32_e64 v86, -v70, v86
    v_mul_f32_e64 v87, -v71, v87
    v_mul_f32_e64 v88, -v72, v88
    v_mul_f32_e64 v89, -v73, v89
    v_mul_f32_e64 v90, -v74, v90
    v_mul_f32_e64 v91, -v75, v91
    v_mul_f32_e64 v92, -v76, v92
    v_mul_f32_e64 v93, -v77, v93
    v_mul_f32_e64 v94, -v78, v94
    v_mul_f32_e64 v95, -v79, v95
    v_exp_f32 v80, v80
    v_exp_f32 v81, v81
    v_exp_f32 v82, v82
    v_exp_f32 v83, v83
    v_exp_f32 v84, v84
    v_exp_f32 v85, v85
    v_exp_f32 v86, v86
    v_exp_f32 v87, v87
    v_exp_f32 v88, v88
    v_exp_f32 v89, v89
    v_exp_f32 v90, v90
    v_exp_f32 v91, v91
    v_exp_f32 v92, v92
    v_exp_f32 v93, v93
    v_exp_f32 v94, v94
    v_exp_f32 v95, v95
    v_add_f32 v80, 1.0, v80
    v_add_f32 v81, 1.0, v81
    v_add_f32 v82, 1.0, v82
    v_add_f32 v83, 1.0, v83
    v_add_f32 v84, 1.0, v84
    v_add_f32 v85, 1.0, v85
    v_add_f32 v86, 1.0, v86
    v_add_f32 v87, 1.0, v87
    v_add_f32 v88, 1.0, v88
    v_add_f32 v89, 1.0, v89
    v_add_f32 v90, 1.0, v90
    v_add_f32 v91, 1.0, v91
    v_add_f32 v92, 1.0, v92
    v_add_f32 v93, 1.0, v93
    v_add_f32 v94, 1.0, v94
    v_add_f32 v95, 1.0, v95
    v_rcp_f32 v80, v80
    v_rcp_f32 v81, v81
    v_rcp_f32 v82, v82
    v_rcp_f32 v83, v83
    v_rcp_f32 v84, v84
    v_rcp_f32 v85, v85
    v_rcp_f32 v86, v86
    v_rcp_f32 v87, v87
    v_rcp_f32 v88, v88
    v_rcp_f32 v89, v89
    v_rcp_f32 v90, v90
    v_rcp_f32 v91, v91
    v_rcp_f32 v92, v92
    v_rcp_f32 v93, v93
    v_rcp_f32 v94, v94
    v_rcp_f32 v95, v95
    v_mul_f32 v64, v64, v80
    v_mul_f32 v65, v65, v81
    v_mul_f32 v66, v66, v82
    v_mul_f32 v67, v67, v83
    v_mul_f32 v68, v68, v84
    v_mul_f32 v69, v69, v85
    v_mul_f32 v70, v70, v86
    v_mul_f32 v71, v71, v87
    v_mul_f32 v72, v72, v88
    v_mul_f32 v73, v73, v89
    v_mul_f32 v74, v74, v90
    v_mul_f32 v75, v75, v91
    v_mul_f32 v76, v76, v92
    v_mul_f32 v77, v77, v93
    v_mul_f32 v78, v78, v94
    v_mul_f32 v79, v79, v95
    v_cvt_pk_bf16_f32 v120, v64, v65
    v_cvt_pk_bf16_f32 v121, v66, v67
    v_cvt_pk_bf16_f32 v122, v68, v69
    v_cvt_pk_bf16_f32 v123, v70, v71
    v_cvt_pk_bf16_f32 v124, v72, v73
    v_cvt_pk_bf16_f32 v125, v74, v75
    v_cvt_pk_bf16_f32 v126, v76, v77
    v_cvt_pk_bf16_f32 v127, v78, v79
    buffer_store_dwordx4 v[120:123], v6, s[8:11], s7 offen offset:1024 sc1
    buffer_store_dwordx4 v[124:127], v6, s[8:11], s7 offen offset:1536 sc1
    s_add_u32 s7, s7, 4096
    s_lshl_b32 s7, s6, 4
    s_add_u32 s7, s7, s5
    s_lshl_b32 s7, s7, 7
    s_add_u32 s7, s7, 60903424
    v_mov_b32 v2, 1
    s_waitcnt vmcnt(0)
    s_mov_b64 exec, 1
    buffer_store_dword v2, v5, s[8:11], s7 offen sc1
    s_mov_b64 exec, -1
L_m_g2:
    v_mbcnt_lo_u32_b32 v0, -1, 0
    v_mbcnt_hi_u32_b32 v0, -1, v0
    s_lshl_b32 s3, s100, 6
    v_add_u32 v0, s3, v0
    s_load_dwordx4 s[32:35], s[0:1], 88
    s_load_dwordx2 s[36:37], s[0:1], 112
    v_and_b32 v1, 63, v0
    s_and_b32 s6, s98, 7
    s_lshr_b32 s7, s98, 3
    v_and_b32 v2, 51, v1
    v_bfe_u32 v3, v1, 2, 1
    v_lshl_add_u32 v2, v3, 3, v2
    v_bfe_u32 v3, v1, 3, 1
    v_lshl_add_u32 v2, v3, 2, v2
    v_lshlrev_b32 v4, 4, v2
    s_mul_i32 s20, s6, 229376
    s_mul_i32 s4, s100, 28672
    s_add_u32 s20, s20, s4
    s_add_u32 s20, s20, 123731968
    s_add_u32 s21, s20, 114688
    s_mul_i32 s4, s100, 7
    s_lshr_b32 s4, s4, 1
    v_lshrrev_b32 v2, 1, v1
    v_add_u32 v2, s4, v2
    v_min_u32 v2, 13, v2
    v_and_b32 v3, 1, v1
    v_lshl_add_u32 v2, v2, 4, v3
    v_lshlrev_b32 v8, 7, v2
    s_lshl_b32 s5, s6, 8
    s_add_u32 s5, s5, 60903424
    v_lshrrev_b32 v3, 5, v1
    v_and_b32 v2, 31, v1
    v_lshlrev_b32 v7, 2, v2
    v_lshlrev_b32 v6, 11, v2
    v_lshl_add_u32 v6, v3, 4, v6
    s_lshl_b32 s22, s7, 16
    s_and_b32 s4, s100, 1
    s_lshl_b32 s23, s4, 10
    s_add_u32 s22, s22, s23
    s_lshl_b32 s23, s6, 7
    s_add_u32 s22, s22, s23
    s_lshr_b32 s23, s100, 1
    s_lshl_b32 s23, s23, 6
    s_add_u32 s22, s22, s23
    s_add_u32 s23, s22, 117440512
    s_lshl_b32 s4, s4, 1
    s_lshl_b32 s7, s7, 7
    s_add_u32 s7, s7, s4
    s_waitcnt lgkmcnt(0)
    s_mov_b32 s8, s36
    s_and_b32 s9, s37, 0xffff
    s_mov_b32 s10, 268435456
    s_mov_b32 s11, 0x00020000
    s_mov_b32 s12, s32
    s_and_b32 s13, s33, 0xffff
    s_mov_b32 s14, 4096
    s_mov_b32 s15, 0x00020000
    s_mov_b32 s28, s34
    s_and_b32 s29, s35, 0xffff
    s_mov_b32 s30, 2097152
    s_mov_b32 s31, 0x00020000
    buffer_load_ushort v184, v7, s[12:15], s7 offen
    s_mov_b64 exec, 1
    s_mov_b32 s25, 64
    s_mov_b32 s26, 60882944
    v_mov_b32 v3, 0
    s_mov_b32 s24, 400000
L_g2r_22:
    buffer_load_dword v2, v3, s[8:11], s26 offen sc1
    s_waitcnt vmcnt(0)
    v_cmp_gt_u32 vcc, s25, v2
    s_cbranch_vccz L_g2rd_23
    s_sub_u32 s24, s24, 1
    s_cbranch_scc1 L_m_fail
    s_sleep 127
    s_branch L_g2r_22
L_g2rd_23:
    s_mov_b64 exec, 0x3ff
    s_mov_b32 s24, 400000
L_g2f_24:
    buffer_load_dword v2, v8, s[8:11], s5 offen sc1
    s_waitcnt vmcnt(0)
    v_cmp_eq_u32 vcc, 0, v2
    s_cbranch_vccz L_g2fd_25
    s_sub_u32 s24, s24, 1
    s_cbranch_scc1 L_m_fail
    s_sleep 2
    s_branch L_g2f_24
L_g2fd_25:
    s_mov_b64 exec, -1
    buffer_load_dwordx4 v[16:19], v4, s[8:11], s20 offen offset:0 sc1
    buffer_load_dwordx4 v[20:23], v4, s[8:11], s21 offen offset:0 sc1
    buffer_load_dwordx4 v[24:27], v4, s[8:11], s20 offen offset:1024 sc1
    buffer_load_dwordx4 v[28:31], v4, s[8:11], s21 offen offset:1024 sc1
    buffer_load_dwordx4 v[32:35], v4, s[8:11], s20 offen offset:2048 sc1
    buffer_load_dwordx4 v[36:39], v4, s[8:11], s21 offen offset:2048 sc1
    buffer_load_dwordx4 v[40:43], v4, s[8:11], s20 offen offset:3072 sc1
    buffer_load_dwordx4 v[44:47], v4, s[8:11], s21 offen offset:3072 sc1
    s_add_u32 s20, s20, 4096
    s_add_u32 s21, s21, 4096
    buffer_load_dwordx4 v[48:51], v4, s[8:11], s20 offen offset:0 sc1
    buffer_load_dwordx4 v[52:55], v4, s[8:11], s21 offen offset:0 sc1
    buffer_load_dwordx4 v[56:59], v4, s[8:11], s20 offen offset:1024 sc1
    buffer_load_dwordx4 v[60:63], v4, s[8:11], s21 offen offset:1024 sc1
    buffer_load_dwordx4 v[64:67], v4, s[8:11], s20 offen offset:2048 sc1
    buffer_load_dwordx4 v[68:71], v4, s[8:11], s21 offen offset:2048 sc1
    buffer_load_dwordx4 v[72:75], v4, s[8:11], s20 offen offset:3072 sc1
    buffer_load_dwordx4 v[76:79], v4, s[8:11], s21 offen offset:3072 sc1
    s_add_u32 s20, s20, 4096
    s_add_u32 s21, s21, 4096
    buffer_load_dwordx4 v[80:83], v4, s[8:11], s20 offen offset:0 sc1
    buffer_load_dwordx4 v[84:87], v4, s[8:11], s21 offen offset:0 sc1
    buffer_load_dwordx4 v[88:91], v4, s[8:11], s20 offen offset:1024 sc1
    buffer_load_dwordx4 v[92:95], v4, s[8:11], s21 offen offset:1024 sc1
    buffer_load_dwordx4 v[96:99], v4, s[8:11], s20 offen offset:2048 sc1
    buffer_load_dwordx4 v[100:103], v4, s[8:11], s21 offen offset:2048 sc1
    buffer_load_dwordx4 v[104:107], v4, s[8:11], s20 offen offset:3072 sc1
    buffer_load_dwordx4 v[108:111], v4, s[8:11], s21 offen offset:3072 sc1
    s_add_u32 s20, s20, 4096
    s_add_u32 s21, s21, 4096
    buffer_load_dwordx4 v[112:115], v4, s[8:11], s20 offen offset:0 sc1
    buffer_load_dwordx4 v[116:119], v4, s[8:11], s21 offen offset:0 sc1
    buffer_load_dwordx4 v[120:123], v4, s[8:11], s20 offen offset:1024 sc1
    buffer_load_dwordx4 v[124:127], v4, s[8:11], s21 offen offset:1024 sc1
    buffer_load_dwordx4 v[128:131], v4, s[8:11], s20 offen offset:2048 sc1
    buffer_load_dwordx4 v[132:135], v4, s[8:11], s21 offen offset:2048 sc1
    buffer_load_dwordx4 v[136:139], v4, s[8:11], s20 offen offset:3072 sc1
    buffer_load_dwordx4 v[140:143], v4, s[8:11], s21 offen offset:3072 sc1
    s_add_u32 s20, s20, 4096
    s_add_u32 s21, s21, 4096
    buffer_load_dwordx4 v[144:147], v4, s[8:11], s20 offen offset:0 sc1
    buffer_load_dwordx4 v[148:151], v4, s[8:11], s21 offen offset:0 sc1
    buffer_load_dwordx4 v[152:155], v4, s[8:11], s20 offen offset:1024 sc1
    buffer_load_dwordx4 v[156:159], v4, s[8:11], s21 offen offset:1024 sc1
    buffer_load_dwordx4 v[160:163], v4, s[8:11], s20 offen offset:2048 sc1
    buffer_load_dwordx4 v[164:167], v4, s[8:11], s21 offen offset:2048 sc1
    buffer_load_dwordx4 v[168:171], v4, s[8:11], s20 offen offset:3072 sc1
    buffer_load_dwordx4 v[172:175], v4, s[8:11], s21 offen offset:3072 sc1
    s_waitcnt vmcnt(38)
    v_mfma_f32_32x32x16_bf16 v[192:207], v[16:19], a[0:3], 0
    v_mfma_f32_32x32x16_bf16 v[208:223], v[16:19], a[4:7], 0
    v_mfma_f32_32x32x16_bf16 v[224:239], v[20:23], a[0:3], 0
    v_mfma_f32_32x32x16_bf16 v[240:255], v[20:23], a[4:7], 0
    s_add_u32 s20, s20, 4096
    s_add_u32 s21, s21, 4096
    buffer_load_dwordx4 v[16:19], v4, s[8:11], s20 offen offset:0 sc1
    buffer_load_dwordx4 v[20:23], v4, s[8:11], s21 offen offset:0 sc1
    s_waitcnt vmcnt(38)
    v_mfma_f32_32x32x16_bf16 v[192:207], v[24:27], a[8:11], v[192:207]
    v_mfma_f32_32x32x16_bf16 v[208:223], v[24:27], a[12:15], v[208:223]
    v_mfma_f32_32x32x16_bf16 v[224:239], v[28:31], a[8:11], v[224:239]
    v_mfma_f32_32x32x16_bf16 v[240:255], v[28:31], a[12:15], v[240:255]
    buffer_load_dwordx4 v[24:27], v4, s[8:11], s20 offen offset:1024 sc1
    buffer_load_dwordx4 v[28:31], v4, s[8:11], s21 offen offset:1024 sc1
    s_waitcnt vmcnt(38)
    v_mfma_f32_32x32x16_bf16 v[192:207], v[32:35], a[16:19], v[192:207]
    v_mfma_f32_32x32x16_bf16 v[208:223], v[32:35], a[20:23], v[208:223]
    v_mfma_f32_32x32x16_bf16 v[224:239], v[36:39], a[16:19], v[224:239]
    v_mfma_f32_32x32x16_bf16 v[240:255], v[36:39], a[20:23], v[240:255]
    buffer_load_dwordx4 v[32:35], v4, s[8:11], s20 offen offset:2048 sc1
    buffer_load_dwordx4 v[36:39], v4, s[8:11], s21 offen offset:2048 sc1
    s_waitcnt vmcnt(38)
    v_mfma_f32_32x32x16_bf16 v[192:207], v[40:43], a[24:27], v[192:207]
    v_mfma_f32_32x32x16_bf16 v[208:223], v[40:43], a[28:31], v[208:223]
    v_mfma_f32_32x32x16_bf16 v[224:239], v[44:47], a[24:27], v[224:239]
    v_mfma_f32_32x32x16_bf16 v[240:255], v[44:47], a[28:31], v[240:255]
    buffer_load_dwordx4 v[40:43], v4, s[8:11], s20 offen offset:3072 sc1
    buffer_load_dwordx4 v[44:47], v4, s[8:11], s21 offen offset:3072 sc1
    s_waitcnt vmcnt(38)
    v_mfma_f32_32x32x16_bf16 v[192:207], v[48:51], a[32:35], v[192:207]
    v_mfma_f32_32x32x16_bf16 v[208:223], v[48:51], a[36:39], v[208:223]
    v_mfma_f32_32x32x16_bf16 v[224:239], v[52:55], a[32:35], v[224:239]
    v_mfma_f32_32x32x16_bf16 v[240:255], v[52:55], a[36:39], v[240:255]
    s_add_u32 s20, s20, 4096
    s_add_u32 s21, s21, 4096
    buffer_load_dwordx4 v[48:51], v4, s[8:11], s20 offen offset:0 sc1
    buffer_load_dwordx4 v[52:55], v4, s[8:11], s21 offen offset:0 sc1
    s_waitcnt vmcnt(38)
    v_mfma_f32_32x32x16_bf16 v[192:207], v[56:59], a[40:43], v[192:207]
    v_mfma_f32_32x32x16_bf16 v[208:223], v[56:59], a[44:47], v[208:223]
    v_mfma_f32_32x32x16_bf16 v[224:239], v[60:63], a[40:43], v[224:239]
    v_mfma_f32_32x32x16_bf16 v[240:255], v[60:63], a[44:47], v[240:255]
    buffer_load_dwordx4 v[56:59], v4, s[8:11], s20 offen offset:1024 sc1
    buffer_load_dwordx4 v[60:63], v4, s[8:11], s21 offen offset:1024 sc1
    s_waitcnt vmcnt(38)
    v_mfma_f32_32x32x16_bf16 v[192:207], v[64:67], a[48:51], v[192:207]
    v_mfma_f32_32x32x16_bf16 v[208:223], v[64:67], a[52:55], v[208:223]
    v_mfma_f32_32x32x16_bf16 v[224:239], v[68:71], a[48:51], v[224:239]
    v_mfma_f32_32x32x16_bf16 v[240:255], v[68:71], a[52:55], v[240:255]
    buffer_load_dwordx4 v[64:67], v4, s[8:11], s20 offen offset:2048 sc1
    buffer_load_dwordx4 v[68:71], v4, s[8:11], s21 offen offset:2048 sc1
    s_waitcnt vmcnt(38)
    v_mfma_f32_32x32x16_bf16 v[192:207], v[72:75], a[56:59], v[192:207]
    v_mfma_f32_32x32x16_bf16 v[208:223], v[72:75], a[60:63], v[208:223]
    v_mfma_f32_32x32x16_bf16 v[224:239], v[76:79], a[56:59], v[224:239]
    v_mfma_f32_32x32x16_bf16 v[240:255], v[76:79], a[60:63], v[240:255]
    buffer_load_dwordx4 v[72:75], v4, s[8:11], s20 offen offset:3072 sc1
    buffer_load_dwordx4 v[76:79], v4, s[8:11], s21 offen offset:3072 sc1
    s_waitcnt vmcnt(38)
    v_mfma_f32_32x32x16_bf16 v[192:207], v[80:83], a[64:67], v[192:207]
    v_mfma_f32_32x32x16_bf16 v[208:223], v[80:83], a[68:71], v[208:223]
    v_mfma_f32_32x32x16_bf16 v[224:239], v[84:87], a[64:67], v[224:239]
    v_mfma_f32_32x32x16_bf16 v[240:255], v[84:87], a[68:71], v[240:255]
    buffer_load_dwordx4 v[176:179], v6, s[8:11], s23 offen sc1
    buffer_load_dwordx4 v[180:183], v6, s[8:11], s23 offen offset:32 sc1
    s_waitcnt vmcnt(38)
    v_mfma_f32_32x32x16_bf16 v[192:207], v[88:91], a[72:75], v[192:207]
    v_mfma_f32_32x32x16_bf16 v[208:223], v[88:91], a[76:79], v[208:223]
    v_mfma_f32_32x32x16_bf16 v[224:239], v[92:95], a[72:75], v[224:239]
    v_mfma_f32_32x32x16_bf16 v[240:255], v[92:95], a[76:79], v[240:255]
    s_waitcnt vmcnt(36)
    v_mfma_f32_32x32x16_bf16 v[192:207], v[96:99], a[80:83], v[192:207]
    v_mfma_f32_32x32x16_bf16 v[208:223], v[96:99], a[84:87], v[208:223]
    v_mfma_f32_32x32x16_bf16 v[224:239], v[100:103], a[80:83], v[224:239]
    v_mfma_f32_32x32x16_bf16 v[240:255], v[100:103], a[84:87], v[240:255]
    s_waitcnt vmcnt(34)
    v_mfma_f32_32x32x16_bf16 v[192:207], v[104:107], a[88:91], v[192:207]
    v_mfma_f32_32x32x16_bf16 v[208:223], v[104:107], a[92:95], v[208:223]
    v_mfma_f32_32x32x16_bf16 v[224:239], v[108:111], a[88:91], v[224:239]
    v_mfma_f32_32x32x16_bf16 v[240:255], v[108:111], a[92:95], v[240:255]
    s_waitcnt vmcnt(32)
    v_mfma_f32_32x32x16_bf16 v[192:207], v[112:115], a[96:99], v[192:207]
    v_mfma_f32_32x32x16_bf16 v[208:223], v[112:115], a[100:103], v[208:223]
    v_mfma_f32_32x32x16_bf16 v[224:239], v[116:119], a[96:99], v[224:239]
    v_mfma_f32_32x32x16_bf16 v[240:255], v[116:119], a[100:103], v[240:255]
    s_waitcnt vmcnt(30)
    v_mfma_f32_32x32x16_bf16 v[192:207], v[120:123], a[104:107], v[192:207]
    v_mfma_f32_32x32x16_bf16 v[208:223], v[120:123], a[108:111], v[208:223]
    v_mfma_f32_32x32x16_bf16 v[224:239], v[124:127], a[104:107], v[224:239]
    v_mfma_f32_32x32x16_bf16 v[240:255], v[124:127], a[108:111], v[240:255]
    s_waitcnt vmcnt(28)
    v_mfma_f32_32x32x16_bf16 v[192:207], v[128:131], a[112:115], v[192:207]
    v_mfma_f32_32x32x16_bf16 v[208:223], v[128:131], a[116:119], v[208:223]
    v_mfma_f32_32x32x16_bf16 v[224:239], v[132:135], a[112:115], v[224:239]
    v_mfma_f32_32x32x16_bf16 v[240:255], v[132:135], a[116:119], v[240:255]
    s_waitcnt vmcnt(26)
    v_mfma_f32_32x32x16_bf16 v[192:207], v[136:139], a[120:123], v[192:207]
    v_mfma_f32_32x32x16_bf16 v[208:223], v[136:139], a[124:127], v[208:223]
    v_mfma_f32_32x32x16_bf16 v[224:239], v[140:143], a[120:123], v[224:239]
    v_mfma_f32_32x32x16_bf16 v[240:255], v[140:143], a[124:127], v[240:255]
    s_waitcnt vmcnt(24)
    v_mfma_f32_32x32x16_bf16 v[192:207], v[144:147], a[128:131], v[192:207]
    v_mfma_f32_32x32x16_bf16 v[208:223], v[144:147], a[132:135], v[208:223]
    v_mfma_f32_32x32x16_bf16 v[224:239], v[148:151], a[128:131], v[224:239]
    v_mfma_f32_32x32x16_bf16 v[240:255], v[148:151], a[132:135], v[240:255]
    s_waitcnt vmcnt(22)
    v_mfma_f32_32x32x16_bf16 v[192:207], v[152:155], a[136:139], v[192:207]
    v_mfma_f32_32x32x16_bf16 v[208:223], v[152:155], a[140:143], v[208:223]
    v_mfma_f32_32x32x16_bf16 v[224:239], v[156:159], a[136:139], v[224:239]
    v_mfma_f32_32x32x16_bf16 v[240:255], v[156:159], a[140:143], v[240:255]
    s_waitcnt vmcnt(20)
    v_mfma_f32_32x32x16_bf16 v[192:207], v[160:163], a[144:147], v[192:207]
    v_mfma_f32_32x32x16_bf16 v[208:223], v[160:163], a[148:151], v[208:223]
    v_mfma_f32_32x32x16_bf16 v[224:239], v[164:167], a[144:147], v[224:239]
    v_mfma_f32_32x32x16_bf16 v[240:255], v[164:167], a[148:151], v[240:255]
    s_waitcnt vmcnt(18)
    v_mfma_f32_32x32x16_bf16 v[192:207], v[168:171], a[152:155], v[192:207]
    v_mfma_f32_32x32x16_bf16 v[208:223], v[168:171], a[156:159], v[208:223]
    v_mfma_f32_32x32x16_bf16 v[224:239], v[172:175], a[152:155], v[224:239]
    v_mfma_f32_32x32x16_bf16 v[240:255], v[172:175], a[156:159], v[240:255]
    s_waitcnt vmcnt(16)
    v_mfma_f32_32x32x16_bf16 v[192:207], v[16:19], a[160:163], v[192:207]
    v_mfma_f32_32x32x16_bf16 v[208:223], v[16:19], a[164:167], v[208:223]
    v_mfma_f32_32x32x16_bf16 v[224:239], v[20:23], a[160:163], v[224:239]
    v_mfma_f32_32x32x16_bf16 v[240:255], v[20:23], a[164:167], v[240:255]
    s_waitcnt vmcnt(14)
    v_mfma_f32_32x32x16_bf16 v[192:207], v[24:27], a[168:171], v[192:207]
    v_mfma_f32_32x32x16_bf16 v[208:223], v[24:27], a[172:175], v[208:223]
    v_mfma_f32_32x32x16_bf16 v[224:239], v[28:31], a[168:171], v[224:239]
    v_mfma_f32_32x32x16_bf16 v[240:255], v[28:31], a[172:175], v[240:255]
    s_waitcnt vmcnt(12)
    v_mfma_f32_32x32x16_bf16 v[192:207], v[32:35], a[176:179], v[192:207]
    v_mfma_f32_32x32x16_bf16 v[208:223], v[32:35], a[180:183], v[208:223]
    v_mfma_f32_32x32x16_bf16 v[224:239], v[36:39], a[176:179], v[224:239]
    v_mfma_f32_32x32x16_bf16 v[240:255], v[36:39], a[180:183], v[240:255]
    s_waitcnt vmcnt(10)
    v_mfma_f32_32x32x16_bf16 v[192:207], v[40:43], a[184:187], v[192:207]
    v_mfma_f32_32x32x16_bf16 v[208:223], v[40:43], a[188:191], v[208:223]
    v_mfma_f32_32x32x16_bf16 v[224:239], v[44:47], a[184:187], v[224:239]
    v_mfma_f32_32x32x16_bf16 v[240:255], v[44:47], a[188:191], v[240:255]
    s_waitcnt vmcnt(8)
    v_mfma_f32_32x32x16_bf16 v[192:207], v[48:51], a[192:195], v[192:207]
    v_mfma_f32_32x32x16_bf16 v[208:223], v[48:51], a[196:199], v[208:223]
    v_mfma_f32_32x32x16_bf16 v[224:239], v[52:55], a[192:195], v[224:239]
    v_mfma_f32_32x32x16_bf16 v[240:255], v[52:55], a[196:199], v[240:255]
    s_waitcnt vmcnt(6)
    v_mfma_f32_32x32x16_bf16 v[192:207], v[56:59], a[200:203], v[192:207]
    v_mfma_f32_32x32x16_bf16 v[208:223], v[56:59], a[204:207], v[208:223]
    v_mfma_f32_32x32x16_bf16 v[224:239], v[60:63], a[200:203], v[224:239]
    v_mfma_f32_32x32x16_bf16 v[240:255], v[60:63], a[204:207], v[240:255]
    s_waitcnt vmcnt(4)
    v_mfma_f32_32x32x16_bf16 v[192:207], v[64:67], a[208:211], v[192:207]
    v_mfma_f32_32x32x16_bf16 v[208:223], v[64:67], a[212:215], v[208:223]
    v_mfma_f32_32x32x16_bf16 v[224:239], v[68:71], a[208:211], v[224:239]
    v_mfma_f32_32x32x16_bf16 v[240:255], v[68:71], a[212:215], v[240:255]
    s_waitcnt vmcnt(2)
    v_mfma_f32_32x32x16_bf16 v[192:207], v[72:75], a[216:219], v[192:207]
    v_mfma_f32_32x32x16_bf16 v[208:223], v[72:75], a[220:223], v[208:223]
    v_mfma_f32_32x32x16_bf16 v[224:239], v[76:79], a[216:219], v[224:239]
    v_mfma_f32_32x32x16_bf16 v[240:255], v[76:79], a[220:223], v[240:255]
    v_lshlrev_b32 v2, 4, v1
    s_lshl_b32 s4, s100, 14
    v_add_u32 v5, s4, v2
    s_barrier
    s_nop 7
    ds_write_b128 v5, v[192:195] offset:0
    ds_write_b128 v5, v[196:199] offset:1024
    ds_write_b128 v5, v[200:203] offset:2048
    ds_write_b128 v5, v[204:207] offset:3072
    ds_write_b128 v5, v[208:211] offset:4096
    ds_write_b128 v5, v[212:215] offset:5120
    ds_write_b128 v5, v[216:219] offset:6144
    ds_write_b128 v5, v[220:223] offset:7168
    ds_write_b128 v5, v[224:227] offset:8192
    ds_write_b128 v5, v[228:231] offset:9216
    ds_write_b128 v5, v[232:235] offset:10240
    ds_write_b128 v5, v[236:239] offset:11264
    ds_write_b128 v5, v[240:243] offset:12288
    ds_write_b128 v5, v[244:247] offset:13312
    ds_write_b128 v5, v[248:251] offset:14336
    ds_write_b128 v5, v[252:255] offset:15360
    s_lshl_b32 s4, s100, 12
    v_add_u32 v5, s4, v2
    s_waitcnt lgkmcnt(0)
    s_barrier
    ds_read_b128 v[16:19], v5 offset:0
    ds_read_b128 v[20:23], v5 offset:1024
    ds_read_b128 v[24:27], v5 offset:2048
    ds_read_b128 v[28:31], v5 offset:3072
    ds_read_b128 v[32:35], v5 offset:16384
    ds_read_b128 v[36:39], v5 offset:17408
    ds_read_b128 v[40:43], v5 offset:18432
    ds_read_b128 v[44:47], v5 offset:19456
    ds_read_b128 v[48:51], v5 offset:32768
    ds_read_b128 v[52:55], v5 offset:33792
    ds_read_b128 v[56:59], v5 offset:34816
    ds_read_b128 v[60:63], v5 offset:35840
    ds_read_b128 v[64:67], v5 offset:49152
    ds_read_b128 v[68:71], v5 offset:50176
    ds_read_b128 v[72:75], v5 offset:51200
    ds_read_b128 v[76:79], v5 offset:52224
    s_waitcnt lgkmcnt(0)
    v_pk_add_f32 v[16:17], v[16:17], v[32:33]
    v_pk_add_f32 v[48:49], v[48:49], v[64:65]
    v_pk_add_f32 v[18:19], v[18:19], v[34:35]
    v_pk_add_f32 v[50:51], v[50:51], v[66:67]
    v_pk_add_f32 v[20:21], v[20:21], v[36:37]
    v_pk_add_f32 v[52:53], v[52:53], v[68:69]
    v_pk_add_f32 v[22:23], v[22:23], v[38:39]
    v_pk_add_f32 v[54:55], v[54:55], v[70:71]
    v_pk_add_f32 v[24:25], v[24:25], v[40:41]
    v_pk_add_f32 v[56:57], v[56:57], v[72:73]
    v_pk_add_f32 v[26:27], v[26:27], v[42:43]
    v_pk_add_f32 v[58:59], v[58:59], v[74:75]
    v_pk_add_f32 v[28:29], v[28:29], v[44:45]
    v_pk_add_f32 v[60:61], v[60:61], v[76:77]
    v_pk_add_f32 v[30:31], v[30:31], v[46:47]
    v_pk_add_f32 v[62:63], v[62:63], v[78:79]
    v_pk_add_f32 v[16:17], v[16:17], v[48:49]
    v_pk_add_f32 v[18:19], v[18:19], v[50:51]
    v_pk_add_f32 v[20:21], v[20:21], v[52:53]
    v_pk_add_f32 v[22:23], v[22:23], v[54:55]
    v_pk_add_f32 v[24:25], v[24:25], v[56:57]
    v_pk_add_f32 v[26:27], v[26:27], v[58:59]
    v_pk_add_f32 v[28:29], v[28:29], v[60:61]
    v_pk_add_f32 v[30:31], v[30:31], v[62:63]
    s_waitcnt vmcnt(0)
    v_cvt_pk_bf16_f32 v32, v16, v17
    v_cvt_pk_bf16_f32 v33, v18, v19
    v_cvt_pk_bf16_f32 v34, v20, v21
    v_cvt_pk_bf16_f32 v35, v22, v23
    v_cvt_pk_bf16_f32 v36, v24, v25
    v_cvt_pk_bf16_f32 v37, v26, v27
    v_cvt_pk_bf16_f32 v38, v28, v29
    v_cvt_pk_bf16_f32 v39, v30, v31
    v_lshlrev_b32 v16, 16, v32
    v_and_b32 v17, 0xffff0000, v32
    v_lshlrev_b32 v18, 16, v33
    v_and_b32 v19, 0xffff0000, v33
    v_lshlrev_b32 v20, 16, v34
    v_and_b32 v21, 0xffff0000, v34
    v_lshlrev_b32 v22, 16, v35
    v_and_b32 v23, 0xffff0000, v35
    v_lshlrev_b32 v24, 16, v36
    v_and_b32 v25, 0xffff0000, v36
    v_lshlrev_b32 v26, 16, v37
    v_and_b32 v27, 0xffff0000, v37
    v_lshlrev_b32 v28, 16, v38
    v_and_b32 v29, 0xffff0000, v38
    v_lshlrev_b32 v30, 16, v39
    v_and_b32 v31, 0xffff0000, v39
    v_lshlrev_b32 v184, 16, v184
    v_add_f32 v16, v16, v184
    v_add_f32 v17, v17, v184
    v_add_f32 v18, v18, v184
    v_add_f32 v19, v19, v184
    v_add_f32 v20, v20, v184
    v_add_f32 v21, v21, v184
    v_add_f32 v22, v22, v184
    v_add_f32 v23, v23, v184
    v_add_f32 v24, v24, v184
    v_add_f32 v25, v25, v184
    v_add_f32 v26, v26, v184
    v_add_f32 v27, v27, v184
    v_add_f32 v28, v28, v184
    v_add_f32 v29, v29, v184
    v_add_f32 v30, v30, v184
    v_add_f32 v31, v31, v184
    v_cvt_pk_bf16_f32 v32, v16, v17
    v_cvt_pk_bf16_f32 v33, v18, v19
    v_cvt_pk_bf16_f32 v34, v20, v21
    v_cvt_pk_bf16_f32 v35, v22, v23
    v_cvt_pk_bf16_f32 v36, v24, v25
    v_cvt_pk_bf16_f32 v37, v26, v27
    v_cvt_pk_bf16_f32 v38, v28, v29
    v_cvt_pk_bf16_f32 v39, v30, v31
    v_lshlrev_b32 v16, 16, v32
    v_and_b32 v17, 0xffff0000, v32
    v_lshlrev_b32 v18, 16, v33
    v_and_b32 v19, 0xffff0000, v33
    v_lshlrev_b32 v20, 16, v34
    v_and_b32 v21, 0xffff0000, v34
    v_lshlrev_b32 v22, 16, v35
    v_and_b32 v23, 0xffff0000, v35
    v_lshlrev_b32 v24, 16, v36
    v_and_b32 v25, 0xffff0000, v36
    v_lshlrev_b32 v26, 16, v37
    v_and_b32 v27, 0xffff0000, v37
    v_lshlrev_b32 v28, 16, v38
    v_and_b32 v29, 0xffff0000, v38
    v_lshlrev_b32 v30, 16, v39
    v_and_b32 v31, 0xffff0000, v39
    v_lshlrev_b32 v32, 16, v176
    v_and_b32 v33, 0xffff0000, v176
    v_lshlrev_b32 v34, 16, v177
    v_and_b32 v35, 0xffff0000, v177
    v_lshlrev_b32 v36, 16, v178
    v_and_b32 v37, 0xffff0000, v178
    v_lshlrev_b32 v38, 16, v179
    v_and_b32 v39, 0xffff0000, v179
    v_lshlrev_b32 v40, 16, v180
    v_and_b32 v41, 0xffff0000, v180
    v_lshlrev_b32 v42, 16, v181
    v_and_b32 v43, 0xffff0000, v181
    v_lshlrev_b32 v44, 16, v182
    v_and_b32 v45, 0xffff0000, v182
    v_lshlrev_b32 v46, 16, v183
    v_and_b32 v47, 0xffff0000, v183
    v_add_f32 v16, v16, v32
    v_add_f32 v17, v17, v33
    v_add_f32 v18, v18, v34
    v_add_f32 v19, v19, v35
    v_add_f32 v20, v20, v36
    v_add_f32 v21, v21, v37
    v_add_f32 v22, v22, v38
    v_add_f32 v23, v23, v39
    v_add_f32 v24, v24, v40
    v_add_f32 v25, v25, v41
    v_add_f32 v26, v26, v42
    v_add_f32 v27, v27, v43
    v_add_f32 v28, v28, v44
    v_add_f32 v29, v29, v45
    v_add_f32 v30, v30, v46
    v_add_f32 v31, v31, v47
    v_cvt_pk_bf16_f32 v48, v16, v17
    v_cvt_pk_bf16_f32 v49, v18, v19
    v_cvt_pk_bf16_f32 v50, v20, v21
    v_cvt_pk_bf16_f32 v51, v22, v23
    v_cvt_pk_bf16_f32 v52, v24, v25
    v_cvt_pk_bf16_f32 v53, v26, v27
    v_cvt_pk_bf16_f32 v54, v28, v29
    v_cvt_pk_bf16_f32 v55, v30, v31
    buffer_store_dwordx4 v[48:51], v6, s[28:31], s22 offen offset:0
    buffer_store_dwordx4 v[52:55], v6, s[28:31], s22 offen offset:32
    s_waitcnt vmcnt(0)
    s_endpgm
L_m_exit:
    s_endpgm
L_m_fail:
    s_endpgm
L_m_rec:
    s_load_dwordx4 s[44:47], s[0:1], 16
    s_load_dwordx4 s[48:51], s[0:1], 32
    s_load_dwordx4 s[52:55], s[0:1], 104
    s_load_dwordx2 s[56:57], s[0:1], 8
    s_mov_b32 s4, s100
    s_mov_b32 s5, s2
    s_waitcnt lgkmcnt(0)
    s_mov_b32 s8, s54
    s_and_b32 s9, s55, 0xffff
    s_mov_b32 s10, 268435456
    s_mov_b32 s11, 0x00020000
    s_mov_b32 s16, s52
    s_and_b32 s17, s53, 0xffff
    s_mov_b32 s18, 256
    s_mov_b32 s19, 0x00020000
    v_lshlrev_b32 v1, 4, v0
    v_mov_b32 v4, 0
    v_mov_b32 v5, 0
    v_mov_b32 v6, 0
    v_mov_b32 v7, 0
    v_mov_b32 v8, -1
    v_mov_b32 v9, -1
    v_mov_b32 v10, -1
    v_mov_b32 v11, -1
    s_lshl_b32 s35, s5, 12
    s_add_u32 s36, s35, 60817408
    buffer_store_dwordx4 v[4:7], v1, s[8:11], s36 offen sc1
    s_lshl_b32 s35, s5, 13
    s_add_u32 s36, s35, 58720256
    buffer_store_dwordx4 v[4:7], v1, s[8:11], s36 offen sc1
    s_add_u32 s36, s35, 58724352
    buffer_store_dwordx4 v[4:7], v1, s[8:11], s36 offen sc1
    s_lshl_b32 s35, s5, 14
    s_add_u32 s36, s35, 59777024
    buffer_store_dwordx4 v[8:11], v1, s[8:11], s36 offen sc1
    s_add_u32 s36, s35, 59781120
    buffer_store_dwordx4 v[8:11], v1, s[8:11], s36 offen sc1
    s_add_u32 s36, s35, 59785216
    buffer_store_dwordx4 v[8:11], v1, s[8:11], s36 offen sc1
    s_add_u32 s36, s35, 59789312
    buffer_store_dwordx4 v[8:11], v1, s[8:11], s36 offen sc1
    s_nop 1
    v_and_b32 v64, 63, v0
    v_and_b32 v65, 15, v64
    v_lshrrev_b32 v66, 4, v64
    v_lshrrev_b32 v67, 2, v65
    v_and_b32 v68, 1, v65
    v_lshl_add_u32 v76, v67, 1, v68
    v_bfe_u32 v77, v65, 1, 1
    v_mul_u32_u24 v67, 0xAAAA, v77
    v_add_u32 v0, 0x4444, v67
    s_lshl_b32 s35, s4, 15
    v_lshl_add_u32 v1, v64, 4, s35
    s_xor_b32 s35, s4, 0
    s_lshl_b32 s35, s35, 10
    s_add_u32 s35, s35, 147456
    v_lshl_add_u32 v2, v64, 4, s35
    s_xor_b32 s35, s4, 1
    s_lshl_b32 s35, s35, 10
    s_add_u32 s35, s35, 147456
    v_lshl_add_u32 v3, v64, 4, s35
    s_xor_b32 s35, s4, 2
    s_lshl_b32 s35, s35, 10
    s_add_u32 s35, s35, 147456
    v_lshl_add_u32 v4, v64, 4, s35
    s_xor_b32 s35, s4, 3
    s_lshl_b32 s35, s35, 10
    s_add_u32 s35, s35, 147456
    v_lshl_add_u32 v5, v64, 4, s35
    s_mov_b32 s35, 131072
    v_lshl_add_u32 v6, v64, 4, s35
    s_lshl_b32 s35, s4, 6
    s_add_u32 s35, s35, 155648
    v_mul_u32_u24 v67, 576, v66
    v_lshl_add_u32 v67, v65, 2, v67
    v_add_u32 v7, s35, v67
    v_and_b32 v67, 7, v65
    v_mul_u32_u24 v67, 288, v67
    v_lshl_add_u32 v67, v66, 4, v67
    v_add_u32 v8, 155648, v67
    s_lshl_b32 s35, s4, 6
    s_add_u32 s35, s35, 160256
    v_add_u32 v10, s35, v67
    v_mul_u32_u24 v69, 288, v76
    v_lshl_add_u32 v67, v66, 4, v69
    v_add_u32 v9, 157952, v67
    v_lshl_add_u32 v69, v66, 5, v69
    v_lshl_add_u32 v69, v77, 4, v69
    v_add_u32 v11, 160256, v69
    v_lshlrev_b32 v70, 10, v76
    v_lshl_add_u32 v70, v66, 5, v70
    v_lshl_add_u32 v70, v77, 4, v70
    v_lshrrev_b32 v67, 3, v65
    v_lshlrev_b32 v67, 13, v67
    v_lshl_add_u32 v67, v66, 11, v67
    v_and_b32 v68, 7, v65
    v_lshl_add_u32 v12, v68, 3, v67
    v_lshrrev_b32 v67, 1, v66
    v_lshlrev_b32 v67, 4, v67
    v_and_b32 v68, 1, v66
    v_lshl_add_u32 v67, v68, 2, v67
    v_lshl_add_u32 v67, v77, 5, v67
    v_and_b32 v68, 1, v65
    v_lshl_add_u32 v67, v68, 3, v67
    v_mov_b32 v68, 0x40000000
    v_cmp_gt_u32 vcc, 4, v65
    s_nop 1
    v_cndmask_b32 v13, v68, v67, vcc
    v_and_b32 v68, 1, v65
    v_lshlrev_b32 v68, 4, v68
    v_mov_b32 v69, 0x3f80
    v_lshlrev_b32 v69, v68, v69
    v_bfe_u32 v67, v65, 2, 1
    v_bfe_u32 v68, v65, 3, 1
    v_lshl_add_u32 v67, v67, 1, v68
    v_cmp_eq_u32 vcc, 0, v67
    s_nop 1
    v_cndmask_b32 v96, 0, v69, vcc
    v_cmp_eq_u32 vcc, 1, v67
    s_nop 1
    v_cndmask_b32 v97, 0, v69, vcc
    v_cmp_eq_u32 vcc, 2, v67
    s_nop 1
    v_cndmask_b32 v98, 0, v69, vcc
    v_cmp_eq_u32 vcc, 3, v67
    s_nop 1
    v_cndmask_b32 v99, 0, v69, vcc
    v_lshlrev_b32 v67, 4, v64
    v_add_u32 v67, 162816, v67
    ds_write_b128 v67, v[96:99]
    v_lshlrev_b32 v68, 4, v65
    v_lshl_add_u32 v71, v66, 13, v68
    v_lshrrev_b32 v67, 5, v64
    v_and_b32 v68, 31, v64
    v_lshlrev_b32 v68, 4, v68
    v_lshl_add_u32 v72, v67, 10, v68
    v_lshrrev_b32 v67, 1, v66
    v_lshlrev_b32 v67, 4, v67
    v_and_b32 v68, 1, v66
    v_lshl_add_u32 v67, v68, 2, v67
    v_lshlrev_b32 v68, 2, v65
    v_lshl_add_u32 v73, v67, 8, v68
    s_lshl_b32 s35, s4, 6
    v_add_u32 v73, s35, v73
    v_lshl_add_u32 v74, v67, 9, v68
    s_lshl_b32 s35, s4, 6
    v_add_u32 v74, s35, v74
    s_mov_b32 s32, 0x05040100
    s_mov_b32 s33, 0x07060302
    s_mov_b32 s38, 0xfffefffe
    s_mov_b32 s40, 0x3f803f80
    s_mov_b32 s41, 0x3f803f80
    s_mov_b32 s39, 0x41800000
    s_mov_b32 s31, 0x3e0293ee
    s_lshl_b32 s43, s4, 15
    s_lshl_b32 s35, s5, 13
    s_sub_u32 s35, s35, s43
    s_lshl_b32 s36, s4, 10
    s_add_u32 s20, s35, s36
    s_add_u32 s20, s20, 16777216
    s_lshl_b32 s36, s4, 11
    s_add_u32 s21, s35, s36
    s_add_u32 s21, s21, 33554432
    s_mov_b32 s88, s5
    s_mov_b32 s89, s4
    s_lshl_b32 s26, s88, 13
    s_lshl_b32 s36, s89, 11
    s_add_u32 s26, s26, s36
    s_sub_u32 s26, s26, s43
    s_add_u32 s26, s26, 58720256
    s_lshl_b32 s36, s4, 10
    s_sub_u32 s29, s36, s43
    s_add_u32 s29, s29, 59768832
    s_add_u32 s42, s29, 4096
    s_lshl_b32 s35, s5, 12
    s_lshl_b32 s36, s4, 10
    s_add_u32 s22, s35, s36
    s_sub_u32 s22, s22, s43
    s_add_u32 s22, s22, 100663296
    s_lshl_b32 s35, s5, 6
    s_lshl_b32 s36, s4, 14
    s_add_u32 s35, s35, s36
    s_add_u32 s24, s35, 58720256
    s_add_u32 s25, s35, 58785792
    s_add_u32 s86, s35, 58851328
    s_add_u32 s87, s35, 58916864
    s_lshl_b32 s28, s88, 8
    s_lshl_b32 s35, s89, 6
    s_add_u32 s28, s28, s35
    s_add_u32 s28, s28, 59777024
    s_lshl_b32 s30, s4, 10
    s_add_u32 s30, s30, 131072
    s_lshl_b32 s35, s5, 6
    s_sub_u32 s35, s35, s43
    s_add_u32 s58, s35, 60817408
    s_lshl_b32 s35, s5, 7
    s_add_u32 s59, s35, 60882944
    s_lshl_b32 s35, s5, 2
    s_add_u32 s35, s35, s4
    s_and_b32 s35, s35, 63
    s_lshl_b32 s35, s35, 7
    s_sub_u32 s35, s35, s43
    s_add_u32 s90, s35, 59777024
    s_cmp_eq_u32 s4, 0
    s_cselect_b32 s96, 1, 0
    s_mov_b32 s97, 0
    s_mov_b32 s6, 0
    s_mov_b32 s7, 1
    s_mov_b32 s64, s44
    s_and_b32 s65, s45, 0xffff
    s_mov_b32 s66, 4194304
    s_mov_b32 s67, 0x00020000
    s_mov_b32 s68, s46
    s_and_b32 s69, s47, 0xffff
    s_mov_b32 s70, 4194304
    s_mov_b32 s71, 0x00020000
    s_mov_b32 s72, s48
    s_and_b32 s73, s49, 0xffff
    s_mov_b32 s74, 4194304
    s_mov_b32 s75, 0x00020000
    s_mov_b32 s76, s50
    s_and_b32 s77, s51, 0xffff
    s_mov_b32 s78, 4194304
    s_mov_b32 s79, 0x00020000
    s_mov_b32 s12, s56
    s_and_b32 s13, s57, 0xffff
    s_mov_b32 s14, 8192
    s_mov_b32 s15, 0x00020000
    s_lshl_b32 s35, s5, 8
    s_lshl_b32 s36, s4, 19
    s_add_u32 s80, s35, s36
    s_lshl_b32 s35, s5, 17
    s_lshl_b32 s36, s4, 15
    s_add_u32 s81, s35, s36
    s_xor_b32 s35, s4, 0
    s_lshl_b32 s82, s35, 15
    s_xor_b32 s35, s4, 1
    s_lshl_b32 s83, s35, 15
    s_xor_b32 s35, s4, 2
    s_lshl_b32 s84, s35, 15
    s_xor_b32 s35, s4, 3
    s_lshl_b32 s85, s35, 15
    s_lshl_b32 s35, s4, 7
    buffer_load_dwordx4 v[16:19], v70, s[12:15], s35 offen
    buffer_load_dwordx4 v[20:23], v70, s[12:15], s35 offen offset:512
    s_add_u32 m0, s43, 0
    s_add_u32 s35, s80, 0
    buffer_load_dwordx4 v71, s[68:71], s35 offen lds
    s_add_u32 m0, s43, 1024
    s_add_u32 s35, s80, 32768
    buffer_load_dwordx4 v71, s[68:71], s35 offen lds
    s_add_u32 m0, s43, 2048
    s_add_u32 s35, s80, 65536
    buffer_load_dwordx4 v71, s[68:71], s35 offen lds
    s_add_u32 m0, s43, 3072
    s_add_u32 s35, s80, 98304
    buffer_load_dwordx4 v71, s[68:71], s35 offen lds
    s_add_u32 m0, s43, 4096
    s_add_u32 s35, s80, 131072
    buffer_load_dwordx4 v71, s[68:71], s35 offen lds
    s_add_u32 m0, s43, 5120
    s_add_u32 s35, s80, 163840
    buffer_load_dwordx4 v71, s[68:71], s35 offen lds
    s_add_u32 m0, s43, 6144
    s_add_u32 s35, s80, 196608
    buffer_load_dwordx4 v71, s[68:71], s35 offen lds
    s_add_u32 m0, s43, 7168
    s_add_u32 s35, s80, 229376
    buffer_load_dwordx4 v71, s[68:71], s35 offen lds
    s_add_u32 m0, s43, 8192
    s_add_u32 s35, s80, 262144
    buffer_load_dwordx4 v71, s[68:71], s35 offen lds
    s_add_u32 m0, s43, 9216
    s_add_u32 s35, s80, 294912
    buffer_load_dwordx4 v71, s[68:71], s35 offen lds
    s_add_u32 m0, s43, 10240
    s_add_u32 s35, s80, 327680
    buffer_load_dwordx4 v71, s[68:71], s35 offen lds
    s_add_u32 m0, s43, 11264
    s_add_u32 s35, s80, 360448
    buffer_load_dwordx4 v71, s[68:71], s35 offen lds
    s_add_u32 m0, s43, 12288
    s_add_u32 s35, s80, 393216
    buffer_load_dwordx4 v71, s[68:71], s35 offen lds
    s_add_u32 m0, s43, 13312
    s_add_u32 s35, s80, 425984
    buffer_load_dwordx4 v71, s[68:71], s35 offen lds
    s_add_u32 m0, s43, 14336
    s_add_u32 s35, s80, 458752
    buffer_load_dwordx4 v71, s[68:71], s35 offen lds
    s_add_u32 m0, s43, 15360
    s_add_u32 s35, s80, 491520
    buffer_load_dwordx4 v71, s[68:71], s35 offen lds
    s_add_u32 m0, s43, 16384
    s_add_u32 s35, s80, 2097152
    buffer_load_dwordx4 v71, s[68:71], s35 offen lds
    s_add_u32 m0, s43, 17408
    s_add_u32 s35, s80, 2129920
    buffer_load_dwordx4 v71, s[68:71], s35 offen lds
    s_add_u32 m0, s43, 18432
    s_add_u32 s35, s80, 2162688
    buffer_load_dwordx4 v71, s[68:71], s35 offen lds
    s_add_u32 m0, s43, 19456
    s_add_u32 s35, s80, 2195456
    buffer_load_dwordx4 v71, s[68:71], s35 offen lds
    s_add_u32 m0, s43, 20480
    s_add_u32 s35, s80, 2228224
    buffer_load_dwordx4 v71, s[68:71], s35 offen lds
    s_add_u32 m0, s43, 21504
    s_add_u32 s35, s80, 2260992
    buffer_load_dwordx4 v71, s[68:71], s35 offen lds
    s_add_u32 m0, s43, 22528
    s_add_u32 s35, s80, 2293760
    buffer_load_dwordx4 v71, s[68:71], s35 offen lds
    s_add_u32 m0, s43, 23552
    s_add_u32 s35, s80, 2326528
    buffer_load_dwordx4 v71, s[68:71], s35 offen lds
    s_add_u32 m0, s43, 24576
    s_add_u32 s35, s80, 2359296
    buffer_load_dwordx4 v71, s[68:71], s35 offen lds
    s_add_u32 m0, s43, 25600
    s_add_u32 s35, s80, 2392064
    buffer_load_dwordx4 v71, s[68:71], s35 offen lds
    s_add_u32 m0, s43, 26624
    s_add_u32 s35, s80, 2424832
    buffer_load_dwordx4 v71, s[68:71], s35 offen lds
    s_add_u32 m0, s43, 27648
    s_add_u32 s35, s80, 2457600
    buffer_load_dwordx4 v71, s[68:71], s35 offen lds
    s_add_u32 m0, s43, 28672
    s_add_u32 s35, s80, 2490368
    buffer_load_dwordx4 v71, s[68:71], s35 offen lds
    s_add_u32 m0, s43, 29696
    s_add_u32 s35, s80, 2523136
    buffer_load_dwordx4 v71, s[68:71], s35 offen lds
    s_add_u32 m0, s43, 30720
    s_add_u32 s35, s80, 2555904
    buffer_load_dwordx4 v71, s[68:71], s35 offen lds
    s_add_u32 m0, s43, 31744
    s_add_u32 s35, s80, 2588672
    buffer_load_dwordx4 v71, s[68:71], s35 offen lds
    s_waitcnt vmcnt(16)
    s_barrier
    v_mov_b32 v14, 1
    v_mov_b32 v15, 0
    s_mov_b64 exec, s[96:97]
    buffer_atomic_add v14, v15, s[16:19], 0 offen offset:40
    s_mov_b64 exec, -1
    v_min_u32 v16, -2, v16
    v_min_u32 v17, -2, v17
    v_min_u32 v18, -2, v18
    v_min_u32 v19, -2, v19
    v_min_u32 v20, -2, v20
    v_min_u32 v21, -2, v21
    v_min_u32 v22, -2, v22
    v_min_u32 v23, -2, v23
    buffer_store_dwordx4 v[16:19], v1, s[8:11], s29 offen sc1
    buffer_store_dwordx4 v[20:23], v1, s[8:11], s42 offen sc1
    v_add_u32 v75, s82, v73
    ds_read2st64_b32 v[24:25], v75 offset0:0 offset1:1
    ds_read2st64_b32 v[26:27], v75 offset0:8 offset1:9
    ds_read2st64_b32 v[28:29], v75 offset0:2 offset1:3
    ds_read2st64_b32 v[30:31], v75 offset0:10 offset1:11
    ds_read2st64_b32 v[32:33], v75 offset0:32 offset1:33
    ds_read2st64_b32 v[34:35], v75 offset0:40 offset1:41
    ds_read2st64_b32 v[36:37], v75 offset0:34 offset1:35
    ds_read2st64_b32 v[38:39], v75 offset0:42 offset1:43
    v_add_u32 v75, s83, v73
    ds_read2st64_b32 v[40:41], v75 offset0:0 offset1:1
    ds_read2st64_b32 v[42:43], v75 offset0:8 offset1:9
    ds_read2st64_b32 v[44:45], v75 offset0:2 offset1:3
    ds_read2st64_b32 v[46:47], v75 offset0:10 offset1:11
    ds_read2st64_b32 v[48:49], v75 offset0:32 offset1:33
    ds_read2st64_b32 v[50:51], v75 offset0:40 offset1:41
    ds_read2st64_b32 v[52:53], v75 offset0:34 offset1:35
    ds_read2st64_b32 v[54:55], v75 offset0:42 offset1:43
    s_waitcnt lgkmcnt(0)
    v_add_u32 v75, s84, v73
    ds_read2st64_b32 v[80:81], v75 offset0:0 offset1:1
    ds_read2st64_b32 v[82:83], v75 offset0:8 offset1:9
    ds_read2st64_b32 v[84:85], v75 offset0:2 offset1:3
    ds_read2st64_b32 v[86:87], v75 offset0:10 offset1:11
    ds_read2st64_b32 v[88:89], v75 offset0:32 offset1:33
    ds_read2st64_b32 v[90:91], v75 offset0:40 offset1:41
    ds_read2st64_b32 v[92:93], v75 offset0:34 offset1:35
    ds_read2st64_b32 v[94:95], v75 offset0:42 offset1:43
    v_add_u32 v75, s85, v73
    ds_read2st64_b32 v[96:97], v75 offset0:0 offset1:1
    ds_read2st64_b32 v[98:99], v75 offset0:8 offset1:9
    ds_read2st64_b32 v[100:101], v75 offset0:2 offset1:3
    ds_read2st64_b32 v[102:103], v75 offset0:10 offset1:11
    ds_read2st64_b32 v[104:105], v75 offset0:32 offset1:33
    ds_read2st64_b32 v[106:107], v75 offset0:40 offset1:41
    ds_read2st64_b32 v[108:109], v75 offset0:34 offset1:35
    ds_read2st64_b32 v[110:111], v75 offset0:42 offset1:43
    s_waitcnt lgkmcnt(0)
    s_barrier
    s_add_u32 m0, s43, 0
    s_add_u32 s35, s80, 0
    buffer_load_dwordx4 v71, s[72:75], s35 offen lds
    s_add_u32 m0, s43, 1024
    s_add_u32 s35, s80, 32768
    buffer_load_dwordx4 v71, s[72:75], s35 offen lds
    s_add_u32 m0, s43, 2048
    s_add_u32 s35, s80, 65536
    buffer_load_dwordx4 v71, s[72:75], s35 offen lds
    s_add_u32 m0, s43, 3072
    s_add_u32 s35, s80, 98304
    buffer_load_dwordx4 v71, s[72:75], s35 offen lds
    s_add_u32 m0, s43, 4096
    s_add_u32 s35, s80, 131072
    buffer_load_dwordx4 v71, s[72:75], s35 offen lds
    s_add_u32 m0, s43, 5120
    s_add_u32 s35, s80, 163840
    buffer_load_dwordx4 v71, s[72:75], s35 offen lds
    s_add_u32 m0, s43, 6144
    s_add_u32 s35, s80, 196608
    buffer_load_dwordx4 v71, s[72:75], s35 offen lds
    s_add_u32 m0, s43, 7168
    s_add_u32 s35, s80, 229376
    buffer_load_dwordx4 v71, s[72:75], s35 offen lds
    s_add_u32 m0, s43, 8192
    s_add_u32 s35, s80, 262144
    buffer_load_dwordx4 v71, s[72:75], s35 offen lds
    s_add_u32 m0, s43, 9216
    s_add_u32 s35, s80, 294912
    buffer_load_dwordx4 v71, s[72:75], s35 offen lds
    s_add_u32 m0, s43, 10240
    s_add_u32 s35, s80, 327680
    buffer_load_dwordx4 v71, s[72:75], s35 offen lds
    s_add_u32 m0, s43, 11264
    s_add_u32 s35, s80, 360448
    buffer_load_dwordx4 v71, s[72:75], s35 offen lds
    s_add_u32 m0, s43, 12288
    s_add_u32 s35, s80, 393216
    buffer_load_dwordx4 v71, s[72:75], s35 offen lds
    s_add_u32 m0, s43, 13312
    s_add_u32 s35, s80, 425984
    buffer_load_dwordx4 v71, s[72:75], s35 offen lds
    s_add_u32 m0, s43, 14336
    s_add_u32 s35, s80, 458752
    buffer_load_dwordx4 v71, s[72:75], s35 offen lds
    s_add_u32 m0, s43, 15360
    s_add_u32 s35, s80, 491520
    buffer_load_dwordx4 v71, s[72:75], s35 offen lds
    v_perm_b32 v112, v25, v24, s32
    v_perm_b32 v120, v25, v24, s33
    v_perm_b32 v113, v27, v26, s32
    v_perm_b32 v121, v27, v26, s33
    v_perm_b32 v114, v29, v28, s32
    v_perm_b32 v122, v29, v28, s33
    v_perm_b32 v115, v31, v30, s32
    v_perm_b32 v123, v31, v30, s33
    v_perm_b32 v116, v33, v32, s32
    v_perm_b32 v124, v33, v32, s33
    v_perm_b32 v117, v35, v34, s32
    v_perm_b32 v125, v35, v34, s33
    v_perm_b32 v118, v37, v36, s32
    v_perm_b32 v126, v37, v36, s33
    v_perm_b32 v119, v39, v38, s32
    v_perm_b32 v127, v39, v38, s33
    v_accvgpr_write_b32 a0, v112
    v_accvgpr_write_b32 a1, v113
    v_accvgpr_write_b32 a2, v114
    v_accvgpr_write_b32 a3, v115
    v_accvgpr_write_b32 a4, v116
    v_accvgpr_write_b32 a5, v117
    v_accvgpr_write_b32 a6, v118
    v_accvgpr_write_b32 a7, v119
    v_accvgpr_write_b32 a8, v120
    v_accvgpr_write_b32 a9, v121
    v_accvgpr_write_b32 a10, v122
    v_accvgpr_write_b32 a11, v123
    v_accvgpr_write_b32 a12, v124
    v_accvgpr_write_b32 a13, v125
    v_accvgpr_write_b32 a14, v126
    v_accvgpr_write_b32 a15, v127
    v_perm_b32 v112, v41, v40, s32
    v_perm_b32 v120, v41, v40, s33
    v_perm_b32 v113, v43, v42, s32
    v_perm_b32 v121, v43, v42, s33
    v_perm_b32 v114, v45, v44, s32
    v_perm_b32 v122, v45, v44, s33
    v_perm_b32 v115, v47, v46, s32
    v_perm_b32 v123, v47, v46, s33
    v_perm_b32 v116, v49, v48, s32
    v_perm_b32 v124, v49, v48, s33
    v_perm_b32 v117, v51, v50, s32
    v_perm_b32 v125, v51, v50, s33
    v_perm_b32 v118, v53, v52, s32
    v_perm_b32 v126, v53, v52, s33
    v_perm_b32 v119, v55, v54, s32
    v_perm_b32 v127, v55, v54, s33
    v_accvgpr_write_b32 a16, v112
    v_accvgpr_write_b32 a17, v113
    v_accvgpr_write_b32 a18, v114
    v_accvgpr_write_b32 a19, v115
    v_accvgpr_write_b32 a20, v116
    v_accvgpr_write_b32 a21, v117
    v_accvgpr_write_b32 a22, v118
    v_accvgpr_write_b32 a23, v119
    v_accvgpr_write_b32 a24, v120
    v_accvgpr_write_b32 a25, v121
    v_accvgpr_write_b32 a26, v122
    v_accvgpr_write_b32 a27, v123
    v_accvgpr_write_b32 a28, v124
    v_accvgpr_write_b32 a29, v125
    v_accvgpr_write_b32 a30, v126
    v_accvgpr_write_b32 a31, v127
    v_perm_b32 v112, v81, v80, s32
    v_perm_b32 v120, v81, v80, s33
    v_perm_b32 v113, v83, v82, s32
    v_perm_b32 v121, v83, v82, s33
    v_perm_b32 v114, v85, v84, s32
    v_perm_b32 v122, v85, v84, s33
    v_perm_b32 v115, v87, v86, s32
    v_perm_b32 v123, v87, v86, s33
    v_perm_b32 v116, v89, v88, s32
    v_perm_b32 v124, v89, v88, s33
    v_perm_b32 v117, v91, v90, s32
    v_perm_b32 v125, v91, v90, s33
    v_perm_b32 v118, v93, v92, s32
    v_perm_b32 v126, v93, v92, s33
    v_perm_b32 v119, v95, v94, s32
    v_perm_b32 v127, v95, v94, s33
    v_accvgpr_write_b32 a32, v112
    v_accvgpr_write_b32 a33, v113
    v_accvgpr_write_b32 a34, v114
    v_accvgpr_write_b32 a35, v115
    v_accvgpr_write_b32 a36, v116
    v_accvgpr_write_b32 a37, v117
    v_accvgpr_write_b32 a38, v118
    v_accvgpr_write_b32 a39, v119
    v_accvgpr_write_b32 a40, v120
    v_accvgpr_write_b32 a41, v121
    v_accvgpr_write_b32 a42, v122
    v_accvgpr_write_b32 a43, v123
    v_accvgpr_write_b32 a44, v124
    v_accvgpr_write_b32 a45, v125
    v_accvgpr_write_b32 a46, v126
    v_accvgpr_write_b32 a47, v127
    v_perm_b32 v112, v97, v96, s32
    v_perm_b32 v120, v97, v96, s33
    v_perm_b32 v113, v99, v98, s32
    v_perm_b32 v121, v99, v98, s33
    v_perm_b32 v114, v101, v100, s32
    v_perm_b32 v122, v101, v100, s33
    v_perm_b32 v115, v103, v102, s32
    v_perm_b32 v123, v103, v102, s33
    v_perm_b32 v116, v105, v104, s32
    v_perm_b32 v124, v105, v104, s33
    v_perm_b32 v117, v107, v106, s32
    v_perm_b32 v125, v107, v106, s33
    v_perm_b32 v118, v109, v108, s32
    v_perm_b32 v126, v109, v108, s33
    v_perm_b32 v119, v111, v110, s32
    v_perm_b32 v127, v111, v110, s33
    v_accvgpr_write_b32 a48, v112
    v_accvgpr_write_b32 a49, v113
    v_accvgpr_write_b32 a50, v114
    v_accvgpr_write_b32 a51, v115
    v_accvgpr_write_b32 a52, v116
    v_accvgpr_write_b32 a53, v117
    v_accvgpr_write_b32 a54, v118
    v_accvgpr_write_b32 a55, v119
    v_accvgpr_write_b32 a56, v120
    v_accvgpr_write_b32 a57, v121
    v_accvgpr_write_b32 a58, v122
    v_accvgpr_write_b32 a59, v123
    v_accvgpr_write_b32 a60, v124
    v_accvgpr_write_b32 a61, v125
    v_accvgpr_write_b32 a62, v126
    v_accvgpr_write_b32 a63, v127
    s_waitcnt vmcnt(16)
    s_barrier
    v_add_u32 v75, s82, v73
    ds_read2st64_b32 v[24:25], v75 offset0:64 offset1:65
    ds_read2st64_b32 v[26:27], v75 offset0:72 offset1:73
    ds_read2st64_b32 v[28:29], v75 offset0:66 offset1:67
    ds_read2st64_b32 v[30:31], v75 offset0:74 offset1:75
    ds_read2st64_b32 v[32:33], v75 offset0:96 offset1:97
    ds_read2st64_b32 v[34:35], v75 offset0:104 offset1:105
    ds_read2st64_b32 v[36:37], v75 offset0:98 offset1:99
    ds_read2st64_b32 v[38:39], v75 offset0:106 offset1:107
    v_add_u32 v75, s83, v73
    ds_read2st64_b32 v[40:41], v75 offset0:64 offset1:65
    ds_read2st64_b32 v[42:43], v75 offset0:72 offset1:73
    ds_read2st64_b32 v[44:45], v75 offset0:66 offset1:67
    ds_read2st64_b32 v[46:47], v75 offset0:74 offset1:75
    ds_read2st64_b32 v[48:49], v75 offset0:96 offset1:97
    ds_read2st64_b32 v[50:51], v75 offset0:104 offset1:105
    ds_read2st64_b32 v[52:53], v75 offset0:98 offset1:99
    ds_read2st64_b32 v[54:55], v75 offset0:106 offset1:107
    s_waitcnt lgkmcnt(0)
    v_add_u32 v75, s84, v73
    ds_read2st64_b32 v[80:81], v75 offset0:64 offset1:65
    ds_read2st64_b32 v[82:83], v75 offset0:72 offset1:73
    ds_read2st64_b32 v[84:85], v75 offset0:66 offset1:67
    ds_read2st64_b32 v[86:87], v75 offset0:74 offset1:75
    ds_read2st64_b32 v[88:89], v75 offset0:96 offset1:97
    ds_read2st64_b32 v[90:91], v75 offset0:104 offset1:105
    ds_read2st64_b32 v[92:93], v75 offset0:98 offset1:99
    ds_read2st64_b32 v[94:95], v75 offset0:106 offset1:107
    v_add_u32 v75, s85, v73
    ds_read2st64_b32 v[96:97], v75 offset0:64 offset1:65
    ds_read2st64_b32 v[98:99], v75 offset0:72 offset1:73
    ds_read2st64_b32 v[100:101], v75 offset0:66 offset1:67
    ds_read2st64_b32 v[102:103], v75 offset0:74 offset1:75
    ds_read2st64_b32 v[104:105], v75 offset0:96 offset1:97
    ds_read2st64_b32 v[106:107], v75 offset0:104 offset1:105
    ds_read2st64_b32 v[108:109], v75 offset0:98 offset1:99
    ds_read2st64_b32 v[110:111], v75 offset0:106 offset1:107
    s_waitcnt lgkmcnt(0)
    s_barrier
    s_add_u32 m0, s43, 16384
    s_add_u32 s35, s80, 2097152
    buffer_load_dwordx4 v71, s[72:75], s35 offen lds
    s_add_u32 m0, s43, 17408
    s_add_u32 s35, s80, 2129920
    buffer_load_dwordx4 v71, s[72:75], s35 offen lds
    s_add_u32 m0, s43, 18432
    s_add_u32 s35, s80, 2162688
    buffer_load_dwordx4 v71, s[72:75], s35 offen lds
    s_add_u32 m0, s43, 19456
    s_add_u32 s35, s80, 2195456
    buffer_load_dwordx4 v71, s[72:75], s35 offen lds
    s_add_u32 m0, s43, 20480
    s_add_u32 s35, s80, 2228224
    buffer_load_dwordx4 v71, s[72:75], s35 offen lds
    s_add_u32 m0, s43, 21504
    s_add_u32 s35, s80, 2260992
    buffer_load_dwordx4 v71, s[72:75], s35 offen lds
    s_add_u32 m0, s43, 22528
    s_add_u32 s35, s80, 2293760
    buffer_load_dwordx4 v71, s[72:75], s35 offen lds
    s_add_u32 m0, s43, 23552
    s_add_u32 s35, s80, 2326528
    buffer_load_dwordx4 v71, s[72:75], s35 offen lds
    s_add_u32 m0, s43, 24576
    s_add_u32 s35, s80, 2359296
    buffer_load_dwordx4 v71, s[72:75], s35 offen lds
    s_add_u32 m0, s43, 25600
    s_add_u32 s35, s80, 2392064
    buffer_load_dwordx4 v71, s[72:75], s35 offen lds
    s_add_u32 m0, s43, 26624
    s_add_u32 s35, s80, 2424832
    buffer_load_dwordx4 v71, s[72:75], s35 offen lds
    s_add_u32 m0, s43, 27648
    s_add_u32 s35, s80, 2457600
    buffer_load_dwordx4 v71, s[72:75], s35 offen lds
    s_add_u32 m0, s43, 28672
    s_add_u32 s35, s80, 2490368
    buffer_load_dwordx4 v71, s[72:75], s35 offen lds
    s_add_u32 m0, s43, 29696
    s_add_u32 s35, s80, 2523136
    buffer_load_dwordx4 v71, s[72:75], s35 offen lds
    s_add_u32 m0, s43, 30720
    s_add_u32 s35, s80, 2555904
    buffer_load_dwordx4 v71, s[72:75], s35 offen lds
    s_add_u32 m0, s43, 31744
    s_add_u32 s35, s80, 2588672
    buffer_load_dwordx4 v71, s[72:75], s35 offen lds
    v_perm_b32 v112, v25, v24, s32
    v_perm_b32 v120, v25, v24, s33
    v_perm_b32 v113, v27, v26, s32
    v_perm_b32 v121, v27, v26, s33
    v_perm_b32 v114, v29, v28, s32
    v_perm_b32 v122, v29, v28, s33
    v_perm_b32 v115, v31, v30, s32
    v_perm_b32 v123, v31, v30, s33
    v_perm_b32 v116, v33, v32, s32
    v_perm_b32 v124, v33, v32, s33
    v_perm_b32 v117, v35, v34, s32
    v_perm_b32 v125, v35, v34, s33
    v_perm_b32 v118, v37, v36, s32
    v_perm_b32 v126, v37, v36, s33
    v_perm_b32 v119, v39, v38, s32
    v_perm_b32 v127, v39, v38, s33
    v_accvgpr_write_b32 a64, v112
    v_accvgpr_write_b32 a65, v113
    v_accvgpr_write_b32 a66, v114
    v_accvgpr_write_b32 a67, v115
    v_accvgpr_write_b32 a68, v116
    v_accvgpr_write_b32 a69, v117
    v_accvgpr_write_b32 a70, v118
    v_accvgpr_write_b32 a71, v119
    v_accvgpr_write_b32 a72, v120
    v_accvgpr_write_b32 a73, v121
    v_accvgpr_write_b32 a74, v122
    v_accvgpr_write_b32 a75, v123
    v_accvgpr_write_b32 a76, v124
    v_accvgpr_write_b32 a77, v125
    v_accvgpr_write_b32 a78, v126
    v_accvgpr_write_b32 a79, v127
    v_perm_b32 v112, v41, v40, s32
    v_perm_b32 v120, v41, v40, s33
    v_perm_b32 v113, v43, v42, s32
    v_perm_b32 v121, v43, v42, s33
    v_perm_b32 v114, v45, v44, s32
    v_perm_b32 v122, v45, v44, s33
    v_perm_b32 v115, v47, v46, s32
    v_perm_b32 v123, v47, v46, s33
    v_perm_b32 v116, v49, v48, s32
    v_perm_b32 v124, v49, v48, s33
    v_perm_b32 v117, v51, v50, s32
    v_perm_b32 v125, v51, v50, s33
    v_perm_b32 v118, v53, v52, s32
    v_perm_b32 v126, v53, v52, s33
    v_perm_b32 v119, v55, v54, s32
    v_perm_b32 v127, v55, v54, s33
    v_accvgpr_write_b32 a80, v112
    v_accvgpr_write_b32 a81, v113
    v_accvgpr_write_b32 a82, v114
    v_accvgpr_write_b32 a83, v115
    v_accvgpr_write_b32 a84, v116
    v_accvgpr_write_b32 a85, v117
    v_accvgpr_write_b32 a86, v118
    v_accvgpr_write_b32 a87, v119
    v_accvgpr_write_b32 a88, v120
    v_accvgpr_write_b32 a89, v121
    v_accvgpr_write_b32 a90, v122
    v_accvgpr_write_b32 a91, v123
    v_accvgpr_write_b32 a92, v124
    v_accvgpr_write_b32 a93, v125
    v_accvgpr_write_b32 a94, v126
    v_accvgpr_write_b32 a95, v127
    v_perm_b32 v112, v81, v80, s32
    v_perm_b32 v120, v81, v80, s33
    v_perm_b32 v113, v83, v82, s32
    v_perm_b32 v121, v83, v82, s33
    v_perm_b32 v114, v85, v84, s32
    v_perm_b32 v122, v85, v84, s33
    v_perm_b32 v115, v87, v86, s32
    v_perm_b32 v123, v87, v86, s33
    v_perm_b32 v116, v89, v88, s32
    v_perm_b32 v124, v89, v88, s33
    v_perm_b32 v117, v91, v90, s32
    v_perm_b32 v125, v91, v90, s33
    v_perm_b32 v118, v93, v92, s32
    v_perm_b32 v126, v93, v92, s33
    v_perm_b32 v119, v95, v94, s32
    v_perm_b32 v127, v95, v94, s33
    v_accvgpr_write_b32 a96, v112
    v_accvgpr_write_b32 a97, v113
    v_accvgpr_write_b32 a98, v114
    v_accvgpr_write_b32 a99, v115
    v_accvgpr_write_b32 a100, v116
    v_accvgpr_write_b32 a101, v117
    v_accvgpr_write_b32 a102, v118
    v_accvgpr_write_b32 a103, v119
    v_accvgpr_write_b32 a104, v120
    v_accvgpr_write_b32 a105, v121
    v_accvgpr_write_b32 a106, v122
    v_accvgpr_write_b32 a107, v123
    v_accvgpr_write_b32 a108, v124
    v_accvgpr_write_b32 a109, v125
    v_accvgpr_write_b32 a110, v126
    v_accvgpr_write_b32 a111, v127
    v_perm_b32 v112, v97, v96, s32
    v_perm_b32 v120, v97, v96, s33
    v_perm_b32 v113, v99, v98, s32
    v_perm_b32 v121, v99, v98, s33
    v_perm_b32 v114, v101, v100, s32
    v_perm_b32 v122, v101, v100, s33
    v_perm_b32 v115, v103, v102, s32
    v_perm_b32 v123, v103, v102, s33
    v_perm_b32 v116, v105, v104, s32
    v_perm_b32 v124, v105, v104, s33
    v_perm_b32 v117, v107, v106, s32
    v_perm_b32 v125, v107, v106, s33
    v_perm_b32 v118, v109, v108, s32
    v_perm_b32 v126, v109, v108, s33
    v_perm_b32 v119, v111, v110, s32
    v_perm_b32 v127, v111, v110, s33
    v_accvgpr_write_b32 a112, v112
    v_accvgpr_write_b32 a113, v113
    v_accvgpr_write_b32 a114, v114
    v_accvgpr_write_b32 a115, v115
    v_accvgpr_write_b32 a116, v116
    v_accvgpr_write_b32 a117, v117
    v_accvgpr_write_b32 a118, v118
    v_accvgpr_write_b32 a119, v119
    v_accvgpr_write_b32 a120, v120
    v_accvgpr_write_b32 a121, v121
    v_accvgpr_write_b32 a122, v122
    v_accvgpr_write_b32 a123, v123
    v_accvgpr_write_b32 a124, v124
    v_accvgpr_write_b32 a125, v125
    v_accvgpr_write_b32 a126, v126
    v_accvgpr_write_b32 a127, v127
    s_waitcnt vmcnt(16)
    s_barrier
    v_add_u32 v75, s82, v73
    ds_read2st64_b32 v[24:25], v75 offset0:0 offset1:1
    ds_read2st64_b32 v[26:27], v75 offset0:8 offset1:9
    ds_read2st64_b32 v[28:29], v75 offset0:2 offset1:3
    ds_read2st64_b32 v[30:31], v75 offset0:10 offset1:11
    ds_read2st64_b32 v[32:33], v75 offset0:32 offset1:33
    ds_read2st64_b32 v[34:35], v75 offset0:40 offset1:41
    ds_read2st64_b32 v[36:37], v75 offset0:34 offset1:35
    ds_read2st64_b32 v[38:39], v75 offset0:42 offset1:43
    v_add_u32 v75, s83, v73
    ds_read2st64_b32 v[40:41], v75 offset0:0 offset1:1
    ds_read2st64_b32 v[42:43], v75 offset0:8 offset1:9
    ds_read2st64_b32 v[44:45], v75 offset0:2 offset1:3
    ds_read2st64_b32 v[46:47], v75 offset0:10 offset1:11
    ds_read2st64_b32 v[48:49], v75 offset0:32 offset1:33
    ds_read2st64_b32 v[50:51], v75 offset0:40 offset1:41
    ds_read2st64_b32 v[52:53], v75 offset0:34 offset1:35
    ds_read2st64_b32 v[54:55], v75 offset0:42 offset1:43
    s_waitcnt lgkmcnt(0)
    v_add_u32 v75, s84, v73
    ds_read2st64_b32 v[80:81], v75 offset0:0 offset1:1
    ds_read2st64_b32 v[82:83], v75 offset0:8 offset1:9
    ds_read2st64_b32 v[84:85], v75 offset0:2 offset1:3
    ds_read2st64_b32 v[86:87], v75 offset0:10 offset1:11
    ds_read2st64_b32 v[88:89], v75 offset0:32 offset1:33
    ds_read2st64_b32 v[90:91], v75 offset0:40 offset1:41
    ds_read2st64_b32 v[92:93], v75 offset0:34 offset1:35
    ds_read2st64_b32 v[94:95], v75 offset0:42 offset1:43
    v_add_u32 v75, s85, v73
    ds_read2st64_b32 v[96:97], v75 offset0:0 offset1:1
    ds_read2st64_b32 v[98:99], v75 offset0:8 offset1:9
    ds_read2st64_b32 v[100:101], v75 offset0:2 offset1:3
    ds_read2st64_b32 v[102:103], v75 offset0:10 offset1:11
    ds_read2st64_b32 v[104:105], v75 offset0:32 offset1:33
    ds_read2st64_b32 v[106:107], v75 offset0:40 offset1:41
    ds_read2st64_b32 v[108:109], v75 offset0:34 offset1:35
    ds_read2st64_b32 v[110:111], v75 offset0:42 offset1:43
    s_waitcnt lgkmcnt(0)
    s_barrier
    s_add_u32 m0, s43, 0
    s_add_u32 s35, s80, 2097152
    buffer_load_dwordx4 v71, s[64:67], s35 offen lds
    s_add_u32 m0, s43, 1024
    s_add_u32 s35, s80, 2129920
    buffer_load_dwordx4 v71, s[64:67], s35 offen lds
    s_add_u32 m0, s43, 2048
    s_add_u32 s35, s80, 2162688
    buffer_load_dwordx4 v71, s[64:67], s35 offen lds
    s_add_u32 m0, s43, 3072
    s_add_u32 s35, s80, 2195456
    buffer_load_dwordx4 v71, s[64:67], s35 offen lds
    s_add_u32 m0, s43, 4096
    s_add_u32 s35, s80, 2228224
    buffer_load_dwordx4 v71, s[64:67], s35 offen lds
    s_add_u32 m0, s43, 5120
    s_add_u32 s35, s80, 2260992
    buffer_load_dwordx4 v71, s[64:67], s35 offen lds
    s_add_u32 m0, s43, 6144
    s_add_u32 s35, s80, 2293760
    buffer_load_dwordx4 v71, s[64:67], s35 offen lds
    s_add_u32 m0, s43, 7168
    s_add_u32 s35, s80, 2326528
    buffer_load_dwordx4 v71, s[64:67], s35 offen lds
    s_add_u32 m0, s43, 8192
    s_add_u32 s35, s80, 2359296
    buffer_load_dwordx4 v71, s[64:67], s35 offen lds
    s_add_u32 m0, s43, 9216
    s_add_u32 s35, s80, 2392064
    buffer_load_dwordx4 v71, s[64:67], s35 offen lds
    s_add_u32 m0, s43, 10240
    s_add_u32 s35, s80, 2424832
    buffer_load_dwordx4 v71, s[64:67], s35 offen lds
    s_add_u32 m0, s43, 11264
    s_add_u32 s35, s80, 2457600
    buffer_load_dwordx4 v71, s[64:67], s35 offen lds
    s_add_u32 m0, s43, 12288
    s_add_u32 s35, s80, 2490368
    buffer_load_dwordx4 v71, s[64:67], s35 offen lds
    s_add_u32 m0, s43, 13312
    s_add_u32 s35, s80, 2523136
    buffer_load_dwordx4 v71, s[64:67], s35 offen lds
    s_add_u32 m0, s43, 14336
    s_add_u32 s35, s80, 2555904
    buffer_load_dwordx4 v71, s[64:67], s35 offen lds
    s_add_u32 m0, s43, 15360
    s_add_u32 s35, s80, 2588672
    buffer_load_dwordx4 v71, s[64:67], s35 offen lds
    v_perm_b32 v112, v25, v24, s32
    v_perm_b32 v120, v25, v24, s33
    v_perm_b32 v113, v27, v26, s32
    v_perm_b32 v121, v27, v26, s33
    v_perm_b32 v114, v29, v28, s32
    v_perm_b32 v122, v29, v28, s33
    v_perm_b32 v115, v31, v30, s32
    v_perm_b32 v123, v31, v30, s33
    v_perm_b32 v116, v33, v32, s32
    v_perm_b32 v124, v33, v32, s33
    v_perm_b32 v117, v35, v34, s32
    v_perm_b32 v125, v35, v34, s33
    v_perm_b32 v118, v37, v36, s32
    v_perm_b32 v126, v37, v36, s33
    v_perm_b32 v119, v39, v38, s32
    v_perm_b32 v127, v39, v38, s33
    v_accvgpr_write_b32 a128, v112
    v_accvgpr_write_b32 a129, v113
    v_accvgpr_write_b32 a130, v114
    v_accvgpr_write_b32 a131, v115
    v_accvgpr_write_b32 a132, v116
    v_accvgpr_write_b32 a133, v117
    v_accvgpr_write_b32 a134, v118
    v_accvgpr_write_b32 a135, v119
    v_accvgpr_write_b32 a136, v120
    v_accvgpr_write_b32 a137, v121
    v_accvgpr_write_b32 a138, v122
    v_accvgpr_write_b32 a139, v123
    v_accvgpr_write_b32 a140, v124
    v_accvgpr_write_b32 a141, v125
    v_accvgpr_write_b32 a142, v126
    v_accvgpr_write_b32 a143, v127
    v_perm_b32 v112, v41, v40, s32
    v_perm_b32 v120, v41, v40, s33
    v_perm_b32 v113, v43, v42, s32
    v_perm_b32 v121, v43, v42, s33
    v_perm_b32 v114, v45, v44, s32
    v_perm_b32 v122, v45, v44, s33
    v_perm_b32 v115, v47, v46, s32
    v_perm_b32 v123, v47, v46, s33
    v_perm_b32 v116, v49, v48, s32
    v_perm_b32 v124, v49, v48, s33
    v_perm_b32 v117, v51, v50, s32
    v_perm_b32 v125, v51, v50, s33
    v_perm_b32 v118, v53, v52, s32
    v_perm_b32 v126, v53, v52, s33
    v_perm_b32 v119, v55, v54, s32
    v_perm_b32 v127, v55, v54, s33
    v_accvgpr_write_b32 a144, v112
    v_accvgpr_write_b32 a145, v113
    v_accvgpr_write_b32 a146, v114
    v_accvgpr_write_b32 a147, v115
    v_accvgpr_write_b32 a148, v116
    v_accvgpr_write_b32 a149, v117
    v_accvgpr_write_b32 a150, v118
    v_accvgpr_write_b32 a151, v119
    v_accvgpr_write_b32 a152, v120
    v_accvgpr_write_b32 a153, v121
    v_accvgpr_write_b32 a154, v122
    v_accvgpr_write_b32 a155, v123
    v_accvgpr_write_b32 a156, v124
    v_accvgpr_write_b32 a157, v125
    v_accvgpr_write_b32 a158, v126
    v_accvgpr_write_b32 a159, v127
    v_perm_b32 v112, v81, v80, s32
    v_perm_b32 v120, v81, v80, s33
    v_perm_b32 v113, v83, v82, s32
    v_perm_b32 v121, v83, v82, s33
    v_perm_b32 v114, v85, v84, s32
    v_perm_b32 v122, v85, v84, s33
    v_perm_b32 v115, v87, v86, s32
    v_perm_b32 v123, v87, v86, s33
    v_perm_b32 v116, v89, v88, s32
    v_perm_b32 v124, v89, v88, s33
    v_perm_b32 v117, v91, v90, s32
    v_perm_b32 v125, v91, v90, s33
    v_perm_b32 v118, v93, v92, s32
    v_perm_b32 v126, v93, v92, s33
    v_perm_b32 v119, v95, v94, s32
    v_perm_b32 v127, v95, v94, s33
    v_accvgpr_write_b32 a160, v112
    v_accvgpr_write_b32 a161, v113
    v_accvgpr_write_b32 a162, v114
    v_accvgpr_write_b32 a163, v115
    v_accvgpr_write_b32 a164, v116
    v_accvgpr_write_b32 a165, v117
    v_accvgpr_write_b32 a166, v118
    v_accvgpr_write_b32 a167, v119
    v_accvgpr_write_b32 a168, v120
    v_accvgpr_write_b32 a169, v121
    v_accvgpr_write_b32 a170, v122
    v_accvgpr_write_b32 a171, v123
    v_accvgpr_write_b32 a172, v124
    v_accvgpr_write_b32 a173, v125
    v_accvgpr_write_b32 a174, v126
    v_accvgpr_write_b32 a175, v127
    v_perm_b32 v112, v97, v96, s32
    v_perm_b32 v120, v97, v96, s33
    v_perm_b32 v113, v99, v98, s32
    v_perm_b32 v121, v99, v98, s33
    v_perm_b32 v114, v101, v100, s32
    v_perm_b32 v122, v101, v100, s33
    v_perm_b32 v115, v103, v102, s32
    v_perm_b32 v123, v103, v102, s33
    v_perm_b32 v116, v105, v104, s32
    v_perm_b32 v124, v105, v104, s33
    v_perm_b32 v117, v107, v106, s32
    v_perm_b32 v125, v107, v106, s33
    v_perm_b32 v118, v109, v108, s32
    v_perm_b32 v126, v109, v108, s33
    v_perm_b32 v119, v111, v110, s32
    v_perm_b32 v127, v111, v110, s33
    v_accvgpr_write_b32 a176, v112
    v_accvgpr_write_b32 a177, v113
    v_accvgpr_write_b32 a178, v114
    v_accvgpr_write_b32 a179, v115
    v_accvgpr_write_b32 a180, v116
    v_accvgpr_write_b32 a181, v117
    v_accvgpr_write_b32 a182, v118
    v_accvgpr_write_b32 a183, v119
    v_accvgpr_write_b32 a184, v120
    v_accvgpr_write_b32 a185, v121
    v_accvgpr_write_b32 a186, v122
    v_accvgpr_write_b32 a187, v123
    v_accvgpr_write_b32 a188, v124
    v_accvgpr_write_b32 a189, v125
    v_accvgpr_write_b32 a190, v126
    v_accvgpr_write_b32 a191, v127
    s_waitcnt vmcnt(16)
    s_barrier
    v_add_u32 v75, s82, v73
    ds_read2st64_b32 v[24:25], v75 offset0:64 offset1:65
    ds_read2st64_b32 v[26:27], v75 offset0:72 offset1:73
    ds_read2st64_b32 v[28:29], v75 offset0:66 offset1:67
    ds_read2st64_b32 v[30:31], v75 offset0:74 offset1:75
    ds_read2st64_b32 v[32:33], v75 offset0:96 offset1:97
    ds_read2st64_b32 v[34:35], v75 offset0:104 offset1:105
    ds_read2st64_b32 v[36:37], v75 offset0:98 offset1:99
    ds_read2st64_b32 v[38:39], v75 offset0:106 offset1:107
    v_add_u32 v75, s83, v73
    ds_read2st64_b32 v[40:41], v75 offset0:64 offset1:65
    ds_read2st64_b32 v[42:43], v75 offset0:72 offset1:73
    ds_read2st64_b32 v[44:45], v75 offset0:66 offset1:67
    ds_read2st64_b32 v[46:47], v75 offset0:74 offset1:75
    ds_read2st64_b32 v[48:49], v75 offset0:96 offset1:97
    ds_read2st64_b32 v[50:51], v75 offset0:104 offset1:105
    ds_read2st64_b32 v[52:53], v75 offset0:98 offset1:99
    ds_read2st64_b32 v[54:55], v75 offset0:106 offset1:107
    s_waitcnt lgkmcnt(0)
    v_add_u32 v75, s84, v73
    ds_read2st64_b32 v[80:81], v75 offset0:64 offset1:65
    ds_read2st64_b32 v[82:83], v75 offset0:72 offset1:73
    ds_read2st64_b32 v[84:85], v75 offset0:66 offset1:67
    ds_read2st64_b32 v[86:87], v75 offset0:74 offset1:75
    ds_read2st64_b32 v[88:89], v75 offset0:96 offset1:97
    ds_read2st64_b32 v[90:91], v75 offset0:104 offset1:105
    ds_read2st64_b32 v[92:93], v75 offset0:98 offset1:99
    ds_read2st64_b32 v[94:95], v75 offset0:106 offset1:107
    v_add_u32 v75, s85, v73
    ds_read2st64_b32 v[96:97], v75 offset0:64 offset1:65
    ds_read2st64_b32 v[98:99], v75 offset0:72 offset1:73
    ds_read2st64_b32 v[100:101], v75 offset0:66 offset1:67
    ds_read2st64_b32 v[102:103], v75 offset0:74 offset1:75
    ds_read2st64_b32 v[104:105], v75 offset0:96 offset1:97
    ds_read2st64_b32 v[106:107], v75 offset0:104 offset1:105
    ds_read2st64_b32 v[108:109], v75 offset0:98 offset1:99
    ds_read2st64_b32 v[110:111], v75 offset0:106 offset1:107
    s_waitcnt lgkmcnt(0)
    s_barrier
    s_add_u32 m0, s43, 16384
    s_add_u32 s35, s81, 0
    buffer_load_dwordx4 v72, s[76:79], s35 offen lds
    s_add_u32 m0, s43, 17408
    s_add_u32 s35, s81, 2048
    buffer_load_dwordx4 v72, s[76:79], s35 offen lds
    s_add_u32 m0, s43, 18432
    s_add_u32 s35, s81, 4096
    buffer_load_dwordx4 v72, s[76:79], s35 offen lds
    s_add_u32 m0, s43, 19456
    s_add_u32 s35, s81, 6144
    buffer_load_dwordx4 v72, s[76:79], s35 offen lds
    s_add_u32 m0, s43, 20480
    s_add_u32 s35, s81, 8192
    buffer_load_dwordx4 v72, s[76:79], s35 offen lds
    s_add_u32 m0, s43, 21504
    s_add_u32 s35, s81, 10240
    buffer_load_dwordx4 v72, s[76:79], s35 offen lds
    s_add_u32 m0, s43, 22528
    s_add_u32 s35, s81, 12288
    buffer_load_dwordx4 v72, s[76:79], s35 offen lds
    s_add_u32 m0, s43, 23552
    s_add_u32 s35, s81, 14336
    buffer_load_dwordx4 v72, s[76:79], s35 offen lds
    s_add_u32 m0, s43, 24576
    s_add_u32 s35, s81, 16384
    buffer_load_dwordx4 v72, s[76:79], s35 offen lds
    s_add_u32 m0, s43, 25600
    s_add_u32 s35, s81, 18432
    buffer_load_dwordx4 v72, s[76:79], s35 offen lds
    s_add_u32 m0, s43, 26624
    s_add_u32 s35, s81, 20480
    buffer_load_dwordx4 v72, s[76:79], s35 offen lds
    s_add_u32 m0, s43, 27648
    s_add_u32 s35, s81, 22528
    buffer_load_dwordx4 v72, s[76:79], s35 offen lds
    s_add_u32 m0, s43, 28672
    s_add_u32 s35, s81, 24576
    buffer_load_dwordx4 v72, s[76:79], s35 offen lds
    s_add_u32 m0, s43, 29696
    s_add_u32 s35, s81, 26624
    buffer_load_dwordx4 v72, s[76:79], s35 offen lds
    s_add_u32 m0, s43, 30720
    s_add_u32 s35, s81, 28672
    buffer_load_dwordx4 v72, s[76:79], s35 offen lds
    s_add_u32 m0, s43, 31744
    s_add_u32 s35, s81, 30720
    buffer_load_dwordx4 v72, s[76:79], s35 offen lds
    v_perm_b32 v112, v25, v24, s32
    v_perm_b32 v120, v25, v24, s33
    v_perm_b32 v113, v27, v26, s32
    v_perm_b32 v121, v27, v26, s33
    v_perm_b32 v114, v29, v28, s32
    v_perm_b32 v122, v29, v28, s33
    v_perm_b32 v115, v31, v30, s32
    v_perm_b32 v123, v31, v30, s33
    v_perm_b32 v116, v33, v32, s32
    v_perm_b32 v124, v33, v32, s33
    v_perm_b32 v117, v35, v34, s32
    v_perm_b32 v125, v35, v34, s33
    v_perm_b32 v118, v37, v36, s32
    v_perm_b32 v126, v37, v36, s33
    v_perm_b32 v119, v39, v38, s32
    v_perm_b32 v127, v39, v38, s33
    v_accvgpr_write_b32 a192, v112
    v_accvgpr_write_b32 a193, v113
    v_accvgpr_write_b32 a194, v114
    v_accvgpr_write_b32 a195, v115
    v_accvgpr_write_b32 a196, v116
    v_accvgpr_write_b32 a197, v117
    v_accvgpr_write_b32 a198, v118
    v_accvgpr_write_b32 a199, v119
    v_accvgpr_write_b32 a200, v120
    v_accvgpr_write_b32 a201, v121
    v_accvgpr_write_b32 a202, v122
    v_accvgpr_write_b32 a203, v123
    v_accvgpr_write_b32 a204, v124
    v_accvgpr_write_b32 a205, v125
    v_accvgpr_write_b32 a206, v126
    v_accvgpr_write_b32 a207, v127
    v_perm_b32 v112, v41, v40, s32
    v_perm_b32 v120, v41, v40, s33
    v_perm_b32 v113, v43, v42, s32
    v_perm_b32 v121, v43, v42, s33
    v_perm_b32 v114, v45, v44, s32
    v_perm_b32 v122, v45, v44, s33
    v_perm_b32 v115, v47, v46, s32
    v_perm_b32 v123, v47, v46, s33
    v_perm_b32 v116, v49, v48, s32
    v_perm_b32 v124, v49, v48, s33
    v_perm_b32 v117, v51, v50, s32
    v_perm_b32 v125, v51, v50, s33
    v_perm_b32 v118, v53, v52, s32
    v_perm_b32 v126, v53, v52, s33
    v_perm_b32 v119, v55, v54, s32
    v_perm_b32 v127, v55, v54, s33
    v_accvgpr_write_b32 a208, v112
    v_accvgpr_write_b32 a209, v113
    v_accvgpr_write_b32 a210, v114
    v_accvgpr_write_b32 a211, v115
    v_accvgpr_write_b32 a212, v116
    v_accvgpr_write_b32 a213, v117
    v_accvgpr_write_b32 a214, v118
    v_accvgpr_write_b32 a215, v119
    v_accvgpr_write_b32 a216, v120
    v_accvgpr_write_b32 a217, v121
    v_accvgpr_write_b32 a218, v122
    v_accvgpr_write_b32 a219, v123
    v_accvgpr_write_b32 a220, v124
    v_accvgpr_write_b32 a221, v125
    v_accvgpr_write_b32 a222, v126
    v_accvgpr_write_b32 a223, v127
    v_perm_b32 v112, v81, v80, s32
    v_perm_b32 v120, v81, v80, s33
    v_perm_b32 v113, v83, v82, s32
    v_perm_b32 v121, v83, v82, s33
    v_perm_b32 v114, v85, v84, s32
    v_perm_b32 v122, v85, v84, s33
    v_perm_b32 v115, v87, v86, s32
    v_perm_b32 v123, v87, v86, s33
    v_perm_b32 v116, v89, v88, s32
    v_perm_b32 v124, v89, v88, s33
    v_perm_b32 v117, v91, v90, s32
    v_perm_b32 v125, v91, v90, s33
    v_perm_b32 v118, v93, v92, s32
    v_perm_b32 v126, v93, v92, s33
    v_perm_b32 v119, v95, v94, s32
    v_perm_b32 v127, v95, v94, s33
    v_accvgpr_write_b32 a224, v112
    v_accvgpr_write_b32 a225, v113
    v_accvgpr_write_b32 a226, v114
    v_accvgpr_write_b32 a227, v115
    v_accvgpr_write_b32 a228, v116
    v_accvgpr_write_b32 a229, v117
    v_accvgpr_write_b32 a230, v118
    v_accvgpr_write_b32 a231, v119
    v_accvgpr_write_b32 a232, v120
    v_accvgpr_write_b32 a233, v121
    v_accvgpr_write_b32 a234, v122
    v_accvgpr_write_b32 a235, v123
    v_accvgpr_write_b32 a236, v124
    v_accvgpr_write_b32 a237, v125
    v_accvgpr_write_b32 a238, v126
    v_accvgpr_write_b32 a239, v127
    v_perm_b32 v112, v97, v96, s32
    v_perm_b32 v120, v97, v96, s33
    v_perm_b32 v113, v99, v98, s32
    v_perm_b32 v121, v99, v98, s33
    v_perm_b32 v114, v101, v100, s32
    v_perm_b32 v122, v101, v100, s33
    v_perm_b32 v115, v103, v102, s32
    v_perm_b32 v123, v103, v102, s33
    v_perm_b32 v116, v105, v104, s32
    v_perm_b32 v124, v105, v104, s33
    v_perm_b32 v117, v107, v106, s32
    v_perm_b32 v125, v107, v106, s33
    v_perm_b32 v118, v109, v108, s32
    v_perm_b32 v126, v109, v108, s33
    v_perm_b32 v119, v111, v110, s32
    v_perm_b32 v127, v111, v110, s33
    v_accvgpr_write_b32 a240, v112
    v_accvgpr_write_b32 a241, v113
    v_accvgpr_write_b32 a242, v114
    v_accvgpr_write_b32 a243, v115
    v_accvgpr_write_b32 a244, v116
    v_accvgpr_write_b32 a245, v117
    v_accvgpr_write_b32 a246, v118
    v_accvgpr_write_b32 a247, v119
    v_accvgpr_write_b32 a248, v120
    v_accvgpr_write_b32 a249, v121
    v_accvgpr_write_b32 a250, v122
    v_accvgpr_write_b32 a251, v123
    v_accvgpr_write_b32 a252, v124
    v_accvgpr_write_b32 a253, v125
    v_accvgpr_write_b32 a254, v126
    v_accvgpr_write_b32 a255, v127
    s_waitcnt vmcnt(16)
    s_barrier
    buffer_load_dword v78, v15, s[16:19], 0 offen offset:40 sc1
    v_add_u32 v75, s82, v73
    ds_read2st64_b32 v[24:25], v75 offset0:0 offset1:1
    ds_read2st64_b32 v[26:27], v75 offset0:8 offset1:9
    ds_read2st64_b32 v[28:29], v75 offset0:2 offset1:3
    ds_read2st64_b32 v[30:31], v75 offset0:10 offset1:11
    ds_read2st64_b32 v[32:33], v75 offset0:32 offset1:33
    ds_read2st64_b32 v[34:35], v75 offset0:40 offset1:41
    ds_read2st64_b32 v[36:37], v75 offset0:34 offset1:35
    ds_read2st64_b32 v[38:39], v75 offset0:42 offset1:43
    v_add_u32 v75, s83, v73
    ds_read2st64_b32 v[40:41], v75 offset0:0 offset1:1
    ds_read2st64_b32 v[42:43], v75 offset0:8 offset1:9
    ds_read2st64_b32 v[44:45], v75 offset0:2 offset1:3
    ds_read2st64_b32 v[46:47], v75 offset0:10 offset1:11
    ds_read2st64_b32 v[48:49], v75 offset0:32 offset1:33
    ds_read2st64_b32 v[50:51], v75 offset0:40 offset1:41
    ds_read2st64_b32 v[52:53], v75 offset0:34 offset1:35
    ds_read2st64_b32 v[54:55], v75 offset0:42 offset1:43
    s_waitcnt lgkmcnt(0)
    v_add_u32 v75, s84, v73
    ds_read2st64_b32 v[80:81], v75 offset0:0 offset1:1
    ds_read2st64_b32 v[82:83], v75 offset0:8 offset1:9
    ds_read2st64_b32 v[84:85], v75 offset0:2 offset1:3
    ds_read2st64_b32 v[86:87], v75 offset0:10 offset1:11
    ds_read2st64_b32 v[88:89], v75 offset0:32 offset1:33
    ds_read2st64_b32 v[90:91], v75 offset0:40 offset1:41
    ds_read2st64_b32 v[92:93], v75 offset0:34 offset1:35
    ds_read2st64_b32 v[94:95], v75 offset0:42 offset1:43
    v_add_u32 v75, s85, v73
    ds_read2st64_b32 v[96:97], v75 offset0:0 offset1:1
    ds_read2st64_b32 v[98:99], v75 offset0:8 offset1:9
    ds_read2st64_b32 v[100:101], v75 offset0:2 offset1:3
    ds_read2st64_b32 v[102:103], v75 offset0:10 offset1:11
    ds_read2st64_b32 v[104:105], v75 offset0:32 offset1:33
    ds_read2st64_b32 v[106:107], v75 offset0:40 offset1:41
    ds_read2st64_b32 v[108:109], v75 offset0:34 offset1:35
    ds_read2st64_b32 v[110:111], v75 offset0:42 offset1:43
    s_waitcnt lgkmcnt(0)
    s_barrier
    s_add_u32 m0, s43, 0
    s_add_u32 s35, s80, 0
    buffer_load_dwordx4 v71, s[64:67], s35 offen lds
    s_add_u32 m0, s43, 1024
    s_add_u32 s35, s80, 32768
    buffer_load_dwordx4 v71, s[64:67], s35 offen lds
    s_add_u32 m0, s43, 2048
    s_add_u32 s35, s80, 65536
    buffer_load_dwordx4 v71, s[64:67], s35 offen lds
    s_add_u32 m0, s43, 3072
    s_add_u32 s35, s80, 98304
    buffer_load_dwordx4 v71, s[64:67], s35 offen lds
    s_add_u32 m0, s43, 4096
    s_add_u32 s35, s80, 131072
    buffer_load_dwordx4 v71, s[64:67], s35 offen lds
    s_add_u32 m0, s43, 5120
    s_add_u32 s35, s80, 163840
    buffer_load_dwordx4 v71, s[64:67], s35 offen lds
    s_add_u32 m0, s43, 6144
    s_add_u32 s35, s80, 196608
    buffer_load_dwordx4 v71, s[64:67], s35 offen lds
    s_add_u32 m0, s43, 7168
    s_add_u32 s35, s80, 229376
    buffer_load_dwordx4 v71, s[64:67], s35 offen lds
    s_add_u32 m0, s43, 8192
    s_add_u32 s35, s80, 262144
    buffer_load_dwordx4 v71, s[64:67], s35 offen lds
    s_add_u32 m0, s43, 9216
    s_add_u32 s35, s80, 294912
    buffer_load_dwordx4 v71, s[64:67], s35 offen lds
    s_add_u32 m0, s43, 10240
    s_add_u32 s35, s80, 327680
    buffer_load_dwordx4 v71, s[64:67], s35 offen lds
    s_add_u32 m0, s43, 11264
    s_add_u32 s35, s80, 360448
    buffer_load_dwordx4 v71, s[64:67], s35 offen lds
    s_add_u32 m0, s43, 12288
    s_add_u32 s35, s80, 393216
    buffer_load_dwordx4 v71, s[64:67], s35 offen lds
    s_add_u32 m0, s43, 13312
    s_add_u32 s35, s80, 425984
    buffer_load_dwordx4 v71, s[64:67], s35 offen lds
    s_add_u32 m0, s43, 14336
    s_add_u32 s35, s80, 458752
    buffer_load_dwordx4 v71, s[64:67], s35 offen lds
    s_add_u32 m0, s43, 15360
    s_add_u32 s35, s80, 491520
    buffer_load_dwordx4 v71, s[64:67], s35 offen lds
    v_perm_b32 v128, v25, v24, s32
    v_perm_b32 v136, v25, v24, s33
    v_perm_b32 v129, v27, v26, s32
    v_perm_b32 v137, v27, v26, s33
    v_perm_b32 v130, v29, v28, s32
    v_perm_b32 v138, v29, v28, s33
    v_perm_b32 v131, v31, v30, s32
    v_perm_b32 v139, v31, v30, s33
    v_perm_b32 v132, v33, v32, s32
    v_perm_b32 v140, v33, v32, s33
    v_perm_b32 v133, v35, v34, s32
    v_perm_b32 v141, v35, v34, s33
    v_perm_b32 v134, v37, v36, s32
    v_perm_b32 v142, v37, v36, s33
    v_perm_b32 v135, v39, v38, s32
    v_perm_b32 v143, v39, v38, s33
    v_perm_b32 v144, v41, v40, s32
    v_perm_b32 v152, v41, v40, s33
    v_perm_b32 v145, v43, v42, s32
    v_perm_b32 v153, v43, v42, s33
    v_perm_b32 v146, v45, v44, s32
    v_perm_b32 v154, v45, v44, s33
    v_perm_b32 v147, v47, v46, s32
    v_perm_b32 v155, v47, v46, s33
    v_perm_b32 v148, v49, v48, s32
    v_perm_b32 v156, v49, v48, s33
    v_perm_b32 v149, v51, v50, s32
    v_perm_b32 v157, v51, v50, s33
    v_perm_b32 v150, v53, v52, s32
    v_perm_b32 v158, v53, v52, s33
    v_perm_b32 v151, v55, v54, s32
    v_perm_b32 v159, v55, v54, s33
    v_perm_b32 v160, v81, v80, s32
    v_perm_b32 v168, v81, v80, s33
    v_perm_b32 v161, v83, v82, s32
    v_perm_b32 v169, v83, v82, s33
    v_perm_b32 v162, v85, v84, s32
    v_perm_b32 v170, v85, v84, s33
    v_perm_b32 v163, v87, v86, s32
    v_perm_b32 v171, v87, v86, s33
    v_perm_b32 v164, v89, v88, s32
    v_perm_b32 v172, v89, v88, s33
    v_perm_b32 v165, v91, v90, s32
    v_perm_b32 v173, v91, v90, s33
    v_perm_b32 v166, v93, v92, s32
    v_perm_b32 v174, v93, v92, s33
    v_perm_b32 v167, v95, v94, s32
    v_perm_b32 v175, v95, v94, s33
    v_perm_b32 v176, v97, v96, s32
    v_perm_b32 v184, v97, v96, s33
    v_perm_b32 v177, v99, v98, s32
    v_perm_b32 v185, v99, v98, s33
    v_perm_b32 v178, v101, v100, s32
    v_perm_b32 v186, v101, v100, s33
    v_perm_b32 v179, v103, v102, s32
    v_perm_b32 v187, v103, v102, s33
    v_perm_b32 v180, v105, v104, s32
    v_perm_b32 v188, v105, v104, s33
    v_perm_b32 v181, v107, v106, s32
    v_perm_b32 v189, v107, v106, s33
    v_perm_b32 v182, v109, v108, s32
    v_perm_b32 v190, v109, v108, s33
    v_perm_b32 v183, v111, v110, s32
    v_perm_b32 v191, v111, v110, s33
    s_waitcnt vmcnt(16)
    s_barrier
    s_mov_b32 s34, 400000
L_rec_gate:
    v_readfirstlane_b32 s35, v78
    s_cmp_ge_u32 s35, 32
    s_cbranch_scc1 L_rec_gok
    buffer_load_dword v78, v15, s[16:19], 0 offen offset:40 sc1
    s_waitcnt vmcnt(0)
    s_sub_u32 s34, s34, 1
    s_cbranch_scc1 L_rec_fail
    s_branch L_rec_gate
L_rec_gok:
    buffer_load_dword v79, v15, s[16:19], 0 offen sc1
    buffer_load_dword v70, v1, s[8:11], s58 offen sc1
    buffer_load_dword v78, v1, s[8:11], s58 offen offset:2048 sc1
    v_add_u32 v75, 16384, v74
    ds_read2st64_b32 v[24:25], v75 offset0:0 offset1:2
    ds_read2st64_b32 v[26:27], v75 offset0:16 offset1:18
    ds_read2st64_b32 v[28:29], v75 offset0:4 offset1:6
    ds_read2st64_b32 v[30:31], v75 offset0:20 offset1:22
    ds_read2st64_b32 v[32:33], v75 offset0:128 offset1:130
    ds_read2st64_b32 v[34:35], v75 offset0:144 offset1:146
    ds_read2st64_b32 v[36:37], v75 offset0:132 offset1:134
    ds_read2st64_b32 v[38:39], v75 offset0:148 offset1:150
    v_add_u32 v75, 81920, v74
    ds_read2st64_b32 v[40:41], v75 offset0:0 offset1:2
    ds_read2st64_b32 v[42:43], v75 offset0:16 offset1:18
    ds_read2st64_b32 v[44:45], v75 offset0:4 offset1:6
    ds_read2st64_b32 v[46:47], v75 offset0:20 offset1:22
    ds_read2st64_b32 v[48:49], v75 offset0:128 offset1:130
    ds_read2st64_b32 v[50:51], v75 offset0:144 offset1:146
    ds_read2st64_b32 v[52:53], v75 offset0:132 offset1:134
    ds_read2st64_b32 v[54:55], v75 offset0:148 offset1:150
    s_waitcnt lgkmcnt(0)
    v_add_u32 v75, 16640, v74
    ds_read2st64_b32 v[80:81], v75 offset0:0 offset1:2
    ds_read2st64_b32 v[82:83], v75 offset0:16 offset1:18
    ds_read2st64_b32 v[84:85], v75 offset0:4 offset1:6
    ds_read2st64_b32 v[86:87], v75 offset0:20 offset1:22
    ds_read2st64_b32 v[88:89], v75 offset0:128 offset1:130
    ds_read2st64_b32 v[90:91], v75 offset0:144 offset1:146
    ds_read2st64_b32 v[92:93], v75 offset0:132 offset1:134
    ds_read2st64_b32 v[94:95], v75 offset0:148 offset1:150
    v_add_u32 v75, 82176, v74
    ds_read2st64_b32 v[96:97], v75 offset0:0 offset1:2
    ds_read2st64_b32 v[98:99], v75 offset0:16 offset1:18
    ds_read2st64_b32 v[100:101], v75 offset0:4 offset1:6
    ds_read2st64_b32 v[102:103], v75 offset0:20 offset1:22
    ds_read2st64_b32 v[104:105], v75 offset0:128 offset1:130
    ds_read2st64_b32 v[106:107], v75 offset0:144 offset1:146
    ds_read2st64_b32 v[108:109], v75 offset0:132 offset1:134
    ds_read2st64_b32 v[110:111], v75 offset0:148 offset1:150
    s_waitcnt lgkmcnt(0)
    s_barrier
    s_add_u32 m0, s43, 16384
    s_add_u32 s35, s81, 512
    buffer_load_dwordx4 v72, s[76:79], s35 offen lds
    s_add_u32 m0, s43, 17408
    s_add_u32 s35, s81, 2560
    buffer_load_dwordx4 v72, s[76:79], s35 offen lds
    s_add_u32 m0, s43, 18432
    s_add_u32 s35, s81, 4608
    buffer_load_dwordx4 v72, s[76:79], s35 offen lds
    s_add_u32 m0, s43, 19456
    s_add_u32 s35, s81, 6656
    buffer_load_dwordx4 v72, s[76:79], s35 offen lds
    s_add_u32 m0, s43, 20480
    s_add_u32 s35, s81, 8704
    buffer_load_dwordx4 v72, s[76:79], s35 offen lds
    s_add_u32 m0, s43, 21504
    s_add_u32 s35, s81, 10752
    buffer_load_dwordx4 v72, s[76:79], s35 offen lds
    s_add_u32 m0, s43, 22528
    s_add_u32 s35, s81, 12800
    buffer_load_dwordx4 v72, s[76:79], s35 offen lds
    s_add_u32 m0, s43, 23552
    s_add_u32 s35, s81, 14848
    buffer_load_dwordx4 v72, s[76:79], s35 offen lds
    s_add_u32 m0, s43, 24576
    s_add_u32 s35, s81, 16896
    buffer_load_dwordx4 v72, s[76:79], s35 offen lds
    s_add_u32 m0, s43, 25600
    s_add_u32 s35, s81, 18944
    buffer_load_dwordx4 v72, s[76:79], s35 offen lds
    s_add_u32 m0, s43, 26624
    s_add_u32 s35, s81, 20992
    buffer_load_dwordx4 v72, s[76:79], s35 offen lds
    s_add_u32 m0, s43, 27648
    s_add_u32 s35, s81, 23040
    buffer_load_dwordx4 v72, s[76:79], s35 offen lds
    s_add_u32 m0, s43, 28672
    s_add_u32 s35, s81, 25088
    buffer_load_dwordx4 v72, s[76:79], s35 offen lds
    s_add_u32 m0, s43, 29696
    s_add_u32 s35, s81, 27136
    buffer_load_dwordx4 v72, s[76:79], s35 offen lds
    s_add_u32 m0, s43, 30720
    s_add_u32 s35, s81, 29184
    buffer_load_dwordx4 v72, s[76:79], s35 offen lds
    s_add_u32 m0, s43, 31744
    s_add_u32 s35, s81, 31232
    buffer_load_dwordx4 v72, s[76:79], s35 offen lds
    v_perm_b32 v192, v25, v24, s32
    v_perm_b32 v200, v25, v24, s33
    v_perm_b32 v193, v27, v26, s32
    v_perm_b32 v201, v27, v26, s33
    v_perm_b32 v194, v29, v28, s32
    v_perm_b32 v202, v29, v28, s33
    v_perm_b32 v195, v31, v30, s32
    v_perm_b32 v203, v31, v30, s33
    v_perm_b32 v196, v33, v32, s32
    v_perm_b32 v204, v33, v32, s33
    v_perm_b32 v197, v35, v34, s32
    v_perm_b32 v205, v35, v34, s33
    v_perm_b32 v198, v37, v36, s32
    v_perm_b32 v206, v37, v36, s33
    v_perm_b32 v199, v39, v38, s32
    v_perm_b32 v207, v39, v38, s33
    v_perm_b32 v208, v41, v40, s32
    v_perm_b32 v216, v41, v40, s33
    v_perm_b32 v209, v43, v42, s32
    v_perm_b32 v217, v43, v42, s33
    v_perm_b32 v210, v45, v44, s32
    v_perm_b32 v218, v45, v44, s33
    v_perm_b32 v211, v47, v46, s32
    v_perm_b32 v219, v47, v46, s33
    v_perm_b32 v212, v49, v48, s32
    v_perm_b32 v220, v49, v48, s33
    v_perm_b32 v213, v51, v50, s32
    v_perm_b32 v221, v51, v50, s33
    v_perm_b32 v214, v53, v52, s32
    v_perm_b32 v222, v53, v52, s33
    v_perm_b32 v215, v55, v54, s32
    v_perm_b32 v223, v55, v54, s33
    v_perm_b32 v224, v81, v80, s32
    v_perm_b32 v232, v81, v80, s33
    v_perm_b32 v225, v83, v82, s32
    v_perm_b32 v233, v83, v82, s33
    v_perm_b32 v226, v85, v84, s32
    v_perm_b32 v234, v85, v84, s33
    v_perm_b32 v227, v87, v86, s32
    v_perm_b32 v235, v87, v86, s33
    v_perm_b32 v228, v89, v88, s32
    v_perm_b32 v236, v89, v88, s33
    v_perm_b32 v229, v91, v90, s32
    v_perm_b32 v237, v91, v90, s33
    v_perm_b32 v230, v93, v92, s32
    v_perm_b32 v238, v93, v92, s33
    v_perm_b32 v231, v95, v94, s32
    v_perm_b32 v239, v95, v94, s33
    v_perm_b32 v240, v97, v96, s32
    v_perm_b32 v248, v97, v96, s33
    v_perm_b32 v241, v99, v98, s32
    v_perm_b32 v249, v99, v98, s33
    v_perm_b32 v242, v101, v100, s32
    v_perm_b32 v250, v101, v100, s33
    v_perm_b32 v243, v103, v102, s32
    v_perm_b32 v251, v103, v102, s33
    v_perm_b32 v244, v105, v104, s32
    v_perm_b32 v252, v105, v104, s33
    v_perm_b32 v245, v107, v106, s32
    v_perm_b32 v253, v107, v106, s33
    v_perm_b32 v246, v109, v108, s32
    v_perm_b32 v254, v109, v108, s33
    v_perm_b32 v247, v111, v110, s32
    v_perm_b32 v255, v111, v110, s33
    s_waitcnt vmcnt(16)
    s_barrier
    v_readfirstlane_b32 s37, v79
    s_mov_b64 exec, 3
    v_min_u32 v70, v70, v78
    v_cmp_eq_u32 vcc, 0, v70
    s_cbranch_vccz L_rec_f0
    s_mov_b32 s34, 400000
L_rf1_26:
    buffer_load_dword v14, v1, s[8:11], s58 offen offset:2048 sc1
    s_waitcnt vmcnt(0)
    v_cmp_eq_u32 vcc, 0, v14
    s_cbranch_vccz L_rf1d_27
    s_sub_u32 s34, s34, 1
    s_cbranch_scc1 L_rec_fail
    s_sleep 2
    s_branch L_rf1_26
L_rf1d_27:
    s_mov_b32 s34, 400000
L_rf0_28:
    buffer_load_dword v14, v1, s[8:11], s58 offen sc1
    s_waitcnt vmcnt(0)
    v_cmp_eq_u32 vcc, 0, v14
    s_cbranch_vccz L_rf0d_29
    s_sub_u32 s34, s34, 1
    s_cbranch_scc1 L_rec_fail
    s_sleep 2
    s_branch L_rf0_28
L_rf0d_29:
L_rec_f0:
    s_mov_b64 exec, -1
    buffer_load_dwordx4 v[56:59], v1, s[8:11], s21 offen sc1
    buffer_load_dwordx4 v[60:63], v1, s[8:11], s21 offen offset:1024 sc1
    s_mov_b32 m0, s30
    s_add_u32 s23, s20, 4096
    buffer_load_dwordx4 v1, s[8:11], s20 offen sc1 lds
    s_add_u32 m0, s30, 4096
    s_xor_b32 s30, s30, 8192
    buffer_load_dwordx4 v1, s[8:11], s23 offen sc1 lds
    v_add_u32 v75, s82, v73
    ds_read2st64_b32 v[24:25], v75 offset0:0 offset1:1
    ds_read2st64_b32 v[26:27], v75 offset0:8 offset1:9
    ds_read2st64_b32 v[28:29], v75 offset0:2 offset1:3
    ds_read2st64_b32 v[30:31], v75 offset0:10 offset1:11
    ds_read2st64_b32 v[32:33], v75 offset0:32 offset1:33
    ds_read2st64_b32 v[34:35], v75 offset0:40 offset1:41
    ds_read2st64_b32 v[36:37], v75 offset0:34 offset1:35
    ds_read2st64_b32 v[38:39], v75 offset0:42 offset1:43
    v_add_u32 v75, s83, v73
    ds_read2st64_b32 v[40:41], v75 offset0:0 offset1:1
    ds_read2st64_b32 v[42:43], v75 offset0:8 offset1:9
    ds_read2st64_b32 v[44:45], v75 offset0:2 offset1:3
    ds_read2st64_b32 v[46:47], v75 offset0:10 offset1:11
    ds_read2st64_b32 v[48:49], v75 offset0:32 offset1:33
    ds_read2st64_b32 v[50:51], v75 offset0:40 offset1:41
    ds_read2st64_b32 v[52:53], v75 offset0:34 offset1:35
    ds_read2st64_b32 v[54:55], v75 offset0:42 offset1:43
    s_waitcnt lgkmcnt(0)
    v_add_u32 v75, s84, v73
    ds_read2st64_b32 v[80:81], v75 offset0:0 offset1:1
    ds_read2st64_b32 v[82:83], v75 offset0:8 offset1:9
    ds_read2st64_b32 v[84:85], v75 offset0:2 offset1:3
    ds_read2st64_b32 v[86:87], v75 offset0:10 offset1:11
    ds_read2st64_b32 v[88:89], v75 offset0:32 offset1:33
    ds_read2st64_b32 v[90:91], v75 offset0:40 offset1:41
    ds_read2st64_b32 v[92:93], v75 offset0:34 offset1:35
    ds_read2st64_b32 v[94:95], v75 offset0:42 offset1:43
    v_add_u32 v75, s85, v73
    ds_read2st64_b32 v[96:97], v75 offset0:0 offset1:1
    ds_read2st64_b32 v[98:99], v75 offset0:8 offset1:9
    ds_read2st64_b32 v[100:101], v75 offset0:2 offset1:3
    ds_read2st64_b32 v[102:103], v75 offset0:10 offset1:11
    ds_read2st64_b32 v[104:105], v75 offset0:32 offset1:33
    ds_read2st64_b32 v[106:107], v75 offset0:40 offset1:41
    ds_read2st64_b32 v[108:109], v75 offset0:34 offset1:35
    ds_read2st64_b32 v[110:111], v75 offset0:42 offset1:43
    s_waitcnt lgkmcnt(0)
    s_barrier
    v_perm_b32 v112, v25, v24, s32
    v_perm_b32 v120, v25, v24, s33
    v_perm_b32 v113, v27, v26, s32
    v_perm_b32 v121, v27, v26, s33
    v_perm_b32 v114, v29, v28, s32
    v_perm_b32 v122, v29, v28, s33
    v_perm_b32 v115, v31, v30, s32
    v_perm_b32 v123, v31, v30, s33
    v_perm_b32 v116, v33, v32, s32
    v_perm_b32 v124, v33, v32, s33
    v_perm_b32 v117, v35, v34, s32
    v_perm_b32 v125, v35, v34, s33
    v_perm_b32 v118, v37, v36, s32
    v_perm_b32 v126, v37, v36, s33
    v_perm_b32 v119, v39, v38, s32
    v_perm_b32 v127, v39, v38, s33
    ds_write_b128 v1, v[112:115] offset:0
    ds_write_b128 v1, v[116:119] offset:1024
    ds_write_b128 v1, v[120:123] offset:2048
    ds_write_b128 v1, v[124:127] offset:3072
    s_waitcnt lgkmcnt(0)
    v_perm_b32 v112, v41, v40, s32
    v_perm_b32 v120, v41, v40, s33
    v_perm_b32 v113, v43, v42, s32
    v_perm_b32 v121, v43, v42, s33
    v_perm_b32 v114, v45, v44, s32
    v_perm_b32 v122, v45, v44, s33
    v_perm_b32 v115, v47, v46, s32
    v_perm_b32 v123, v47, v46, s33
    v_perm_b32 v116, v49, v48, s32
    v_perm_b32 v124, v49, v48, s33
    v_perm_b32 v117, v51, v50, s32
    v_perm_b32 v125, v51, v50, s33
    v_perm_b32 v118, v53, v52, s32
    v_perm_b32 v126, v53, v52, s33
    v_perm_b32 v119, v55, v54, s32
    v_perm_b32 v127, v55, v54, s33
    ds_write_b128 v1, v[112:115] offset:4096
    ds_write_b128 v1, v[116:119] offset:5120
    ds_write_b128 v1, v[120:123] offset:6144
    ds_write_b128 v1, v[124:127] offset:7168
    s_waitcnt lgkmcnt(0)
    v_perm_b32 v112, v81, v80, s32
    v_perm_b32 v120, v81, v80, s33
    v_perm_b32 v113, v83, v82, s32
    v_perm_b32 v121, v83, v82, s33
    v_perm_b32 v114, v85, v84, s32
    v_perm_b32 v122, v85, v84, s33
    v_perm_b32 v115, v87, v86, s32
    v_perm_b32 v123, v87, v86, s33
    v_perm_b32 v116, v89, v88, s32
    v_perm_b32 v124, v89, v88, s33
    v_perm_b32 v117, v91, v90, s32
    v_perm_b32 v125, v91, v90, s33
    v_perm_b32 v118, v93, v92, s32
    v_perm_b32 v126, v93, v92, s33
    v_perm_b32 v119, v95, v94, s32
    v_perm_b32 v127, v95, v94, s33
    ds_write_b128 v1, v[112:115] offset:8192
    ds_write_b128 v1, v[116:119] offset:9216
    ds_write_b128 v1, v[120:123] offset:10240
    ds_write_b128 v1, v[124:127] offset:11264
    s_waitcnt lgkmcnt(0)
    v_perm_b32 v112, v97, v96, s32
    v_perm_b32 v120, v97, v96, s33
    v_perm_b32 v113, v99, v98, s32
    v_perm_b32 v121, v99, v98, s33
    v_perm_b32 v114, v101, v100, s32
    v_perm_b32 v122, v101, v100, s33
    v_perm_b32 v115, v103, v102, s32
    v_perm_b32 v123, v103, v102, s33
    v_perm_b32 v116, v105, v104, s32
    v_perm_b32 v124, v105, v104, s33
    v_perm_b32 v117, v107, v106, s32
    v_perm_b32 v125, v107, v106, s33
    v_perm_b32 v118, v109, v108, s32
    v_perm_b32 v126, v109, v108, s33
    v_perm_b32 v119, v111, v110, s32
    v_perm_b32 v127, v111, v110, s33
    ds_write_b128 v1, v[112:115] offset:12288
    ds_write_b128 v1, v[116:119] offset:13312
    ds_write_b128 v1, v[120:123] offset:14336
    ds_write_b128 v1, v[124:127] offset:15360
    s_waitcnt lgkmcnt(0)
    s_waitcnt vmcnt(4)
    s_barrier
    v_add_u32 v75, 16384, v74
    ds_read2st64_b32 v[24:25], v75 offset0:0 offset1:2
    ds_read2st64_b32 v[26:27], v75 offset0:16 offset1:18
    ds_read2st64_b32 v[28:29], v75 offset0:4 offset1:6
    ds_read2st64_b32 v[30:31], v75 offset0:20 offset1:22
    ds_read2st64_b32 v[32:33], v75 offset0:128 offset1:130
    ds_read2st64_b32 v[34:35], v75 offset0:144 offset1:146
    ds_read2st64_b32 v[36:37], v75 offset0:132 offset1:134
    ds_read2st64_b32 v[38:39], v75 offset0:148 offset1:150
    v_add_u32 v75, 81920, v74
    ds_read2st64_b32 v[40:41], v75 offset0:0 offset1:2
    ds_read2st64_b32 v[42:43], v75 offset0:16 offset1:18
    ds_read2st64_b32 v[44:45], v75 offset0:4 offset1:6
    ds_read2st64_b32 v[46:47], v75 offset0:20 offset1:22
    ds_read2st64_b32 v[48:49], v75 offset0:128 offset1:130
    ds_read2st64_b32 v[50:51], v75 offset0:144 offset1:146
    ds_read2st64_b32 v[52:53], v75 offset0:132 offset1:134
    ds_read2st64_b32 v[54:55], v75 offset0:148 offset1:150
    s_waitcnt lgkmcnt(0)
    v_add_u32 v75, 16640, v74
    ds_read2st64_b32 v[80:81], v75 offset0:0 offset1:2
    ds_read2st64_b32 v[82:83], v75 offset0:16 offset1:18
    ds_read2st64_b32 v[84:85], v75 offset0:4 offset1:6
    ds_read2st64_b32 v[86:87], v75 offset0:20 offset1:22
    ds_read2st64_b32 v[88:89], v75 offset0:128 offset1:130
    ds_read2st64_b32 v[90:91], v75 offset0:144 offset1:146
    ds_read2st64_b32 v[92:93], v75 offset0:132 offset1:134
    ds_read2st64_b32 v[94:95], v75 offset0:148 offset1:150
    v_add_u32 v75, 82176, v74
    ds_read2st64_b32 v[96:97], v75 offset0:0 offset1:2
    ds_read2st64_b32 v[98:99], v75 offset0:16 offset1:18
    ds_read2st64_b32 v[100:101], v75 offset0:4 offset1:6
    ds_read2st64_b32 v[102:103], v75 offset0:20 offset1:22
    ds_read2st64_b32 v[104:105], v75 offset0:128 offset1:130
    ds_read2st64_b32 v[106:107], v75 offset0:144 offset1:146
    ds_read2st64_b32 v[108:109], v75 offset0:132 offset1:134
    ds_read2st64_b32 v[110:111], v75 offset0:148 offset1:150
    s_waitcnt lgkmcnt(0)
    s_barrier
    v_perm_b32 v112, v25, v24, s32
    v_perm_b32 v120, v25, v24, s33
    v_perm_b32 v113, v27, v26, s32
    v_perm_b32 v121, v27, v26, s33
    v_perm_b32 v114, v29, v28, s32
    v_perm_b32 v122, v29, v28, s33
    v_perm_b32 v115, v31, v30, s32
    v_perm_b32 v123, v31, v30, s33
    v_perm_b32 v116, v33, v32, s32
    v_perm_b32 v124, v33, v32, s33
    v_perm_b32 v117, v35, v34, s32
    v_perm_b32 v125, v35, v34, s33
    v_perm_b32 v118, v37, v36, s32
    v_perm_b32 v126, v37, v36, s33
    v_perm_b32 v119, v39, v38, s32
    v_perm_b32 v127, v39, v38, s33
    ds_write_b128 v1, v[112:115] offset:16384
    ds_write_b128 v1, v[116:119] offset:17408
    ds_write_b128 v1, v[120:123] offset:18432
    ds_write_b128 v1, v[124:127] offset:19456
    s_waitcnt lgkmcnt(0)
    v_perm_b32 v112, v41, v40, s32
    v_perm_b32 v120, v41, v40, s33
    v_perm_b32 v113, v43, v42, s32
    v_perm_b32 v121, v43, v42, s33
    v_perm_b32 v114, v45, v44, s32
    v_perm_b32 v122, v45, v44, s33
    v_perm_b32 v115, v47, v46, s32
    v_perm_b32 v123, v47, v46, s33
    v_perm_b32 v116, v49, v48, s32
    v_perm_b32 v124, v49, v48, s33
    v_perm_b32 v117, v51, v50, s32
    v_perm_b32 v125, v51, v50, s33
    v_perm_b32 v118, v53, v52, s32
    v_perm_b32 v126, v53, v52, s33
    v_perm_b32 v119, v55, v54, s32
    v_perm_b32 v127, v55, v54, s33
    ds_write_b128 v1, v[112:115] offset:20480
    ds_write_b128 v1, v[116:119] offset:21504
    ds_write_b128 v1, v[120:123] offset:22528
    ds_write_b128 v1, v[124:127] offset:23552
    s_waitcnt lgkmcnt(0)
    v_perm_b32 v112, v81, v80, s32
    v_perm_b32 v120, v81, v80, s33
    v_perm_b32 v113, v83, v82, s32
    v_perm_b32 v121, v83, v82, s33
    v_perm_b32 v114, v85, v84, s32
    v_perm_b32 v122, v85, v84, s33
    v_perm_b32 v115, v87, v86, s32
    v_perm_b32 v123, v87, v86, s33
    v_perm_b32 v116, v89, v88, s32
    v_perm_b32 v124, v89, v88, s33
    v_perm_b32 v117, v91, v90, s32
    v_perm_b32 v125, v91, v90, s33
    v_perm_b32 v118, v93, v92, s32
    v_perm_b32 v126, v93, v92, s33
    v_perm_b32 v119, v95, v94, s32
    v_perm_b32 v127, v95, v94, s33
    ds_write_b128 v1, v[112:115] offset:24576
    ds_write_b128 v1, v[116:119] offset:25600
    ds_write_b128 v1, v[120:123] offset:26624
    ds_write_b128 v1, v[124:127] offset:27648
    s_waitcnt lgkmcnt(0)
    v_perm_b32 v112, v97, v96, s32
    v_perm_b32 v120, v97, v96, s33
    v_perm_b32 v113, v99, v98, s32
    v_perm_b32 v121, v99, v98, s33
    v_perm_b32 v114, v101, v100, s32
    v_perm_b32 v122, v101, v100, s33
    v_perm_b32 v115, v103, v102, s32
    v_perm_b32 v123, v103, v102, s33
    v_perm_b32 v116, v105, v104, s32
    v_perm_b32 v124, v105, v104, s33
    v_perm_b32 v117, v107, v106, s32
    v_perm_b32 v125, v107, v106, s33
    v_perm_b32 v118, v109, v108, s32
    v_perm_b32 v126, v109, v108, s33
    v_perm_b32 v119, v111, v110, s32
    v_perm_b32 v127, v111, v110, s33
    ds_write_b128 v1, v[112:115] offset:28672
    ds_write_b128 v1, v[116:119] offset:29696
    ds_write_b128 v1, v[120:123] offset:30720
    ds_write_b128 v1, v[124:127] offset:31744
    s_waitcnt lgkmcnt(0)
    s_add_u32 s20, s20, 262144
    s_add_u32 s21, s21, 262144
    s_waitcnt vmcnt(0) lgkmcnt(0)
    v_mov_b64 v[48:49], v[56:57]
    v_mov_b64 v[50:51], v[58:59]
    v_mov_b64 v[52:53], v[60:61]
    v_mov_b64 v[54:55], v[62:63]
    ds_read_b128 v[64:67], v1 offset:0
    ds_read_b128 v[68:71], v1 offset:1024
    ds_read_b128 v[72:75], v1 offset:2048
    ds_read_b128 v[76:79], v1 offset:3072
    ds_read_b128 v[80:83], v1 offset:4096
    ds_read_b128 v[84:87], v1 offset:5120
    ds_read_b128 v[88:91], v1 offset:6144
    ds_read_b128 v[92:95], v1 offset:7168
    ds_read_b128 v[96:99], v1 offset:8192
    ds_read_b128 v[100:103], v1 offset:9216
    ds_read_b128 v[104:107], v1 offset:10240
    ds_read_b128 v[108:111], v1 offset:11264
    ds_read_b128 v[112:115], v1 offset:12288
    ds_read_b128 v[116:119], v1 offset:13312
    ds_read_b128 v[120:123], v1 offset:14336
    ds_read_b128 v[124:127], v1 offset:15360
    v_mov_b64 v[24:25], 0
    v_mov_b64 v[26:27], 0
    v_mov_b64 v[28:29], 0
    v_mov_b64 v[30:31], 0
    v_mov_b64 v[32:33], 0
    v_mov_b64 v[34:35], 0
    v_mov_b64 v[36:37], 0
    v_mov_b64 v[38:39], 0
    v_mov_b64 v[40:41], 0
    v_mov_b64 v[42:43], 0
    v_mov_b64 v[44:45], 0
    v_mov_b64 v[46:47], 0
    s_waitcnt lgkmcnt(0)
    s_barrier
    ds_write_b128 v2, v[16:19]
    s_lshr_b32 s84, s5, 4
    s_mov_b32 s83, 162560
    v_mov_b32 v14, 1
    v_mov_b32 v15, 1
    s_mov_b64 exec, 1
    ds_write_b64 v8, v[14:15] offset:2560
    s_mov_b64 exec, -1
    s_mov_b32 s34, 100000
    s_cmp_lt_u32 s37, 32
    s_cbranch_scc1 L_rec1_loop
    .p2align 6
L_rec0_loop:
    buffer_load_dwordx4 v[20:23], v1, s[8:11], s42 offen sc1
    v_smfmac_f32_16x16x64_bf16 v[24:27], v[16:19], v[64:71], v0
    v_smfmac_f32_16x16x64_bf16 v[28:31], v[16:19], v[72:79], v0
    s_waitcnt lgkmcnt(0)
    s_barrier
    v_smfmac_f32_16x16x64_bf16 v[32:35], v[16:19], a[0:7], v0
    ds_read_b128 v[64:67], v3 offset:0
    v_smfmac_f32_16x16x64_bf16 v[36:39], v[16:19], a[8:15], v0
    ds_read_b128 v[68:71], v4 offset:0
    v_smfmac_f32_16x16x64_bf16 v[40:43], v[16:19], a[128:135], v0
    ds_read_b128 v[72:75], v5 offset:0
    v_smfmac_f32_16x16x64_bf16 v[44:47], v[16:19], a[136:143], v0
    s_waitcnt lgkmcnt(2)
    v_smfmac_f32_16x16x64_bf16 v[24:27], v[64:67], v[80:87], v0
    s_add_u32 s36, s6, 3
    s_lshr_b32 s36, s36, 1
    s_min_u32 s36, s36, 31
    v_smfmac_f32_16x16x64_bf16 v[28:31], v[64:67], v[88:95], v0
    s_waitcnt lgkmcnt(1)
    s_lshl_b32 s36, s36, 11
    s_add_u32 s36, s36, s58
    v_smfmac_f32_16x16x64_bf16 v[24:27], v[68:71], v[96:103], v0
    ds_read_b32 v88, v7 offset:2304
    ds_read_b32 v89, v7 offset:2592
    v_smfmac_f32_16x16x64_bf16 v[28:31], v[68:71], v[104:111], v0
    s_waitcnt lgkmcnt(2)
    s_max_u32 s35, s6, 1
    s_sub_u32 s35, s35, 1
    v_smfmac_f32_16x16x64_bf16 v[24:27], v[72:75], v[112:119], v0
    ds_read2_b32 v[90:91], v7 offset0:0 offset1:72
    v_mov_b32 v15, s35
    v_smfmac_f32_16x16x64_bf16 v[28:31], v[72:75], v[120:127], v0
    s_add_u32 s23, s20, 4096
    s_xor_b32 s84, s84, 1
    s_cselect_b32 s37, s36, s90
    v_smfmac_f32_16x16x64_bf16 v[32:35], v[64:67], a[16:23], v0
    ds_read_b128 v[112:115], v6 offset:0
    s_cselect_b32 s85, 158208, s83
    v_smfmac_f32_16x16x64_bf16 v[36:39], v[64:67], a[24:31], v0
    ds_read_b128 v[116:119], v6 offset:1024
    v_smfmac_f32_16x16x64_bf16 v[32:35], v[68:71], a[32:39], v0
    ds_read_b128 v[120:123], v6 offset:2048
    v_smfmac_f32_16x16x64_bf16 v[36:39], v[68:71], a[40:47], v0
    ds_read_b128 v[124:127], v6 offset:3072
    v_smfmac_f32_16x16x64_bf16 v[32:35], v[72:75], a[48:55], v0
    s_waitcnt vmcnt(0)
    v_max3_u32 v14, v20, v21, v22
    v_smfmac_f32_16x16x64_bf16 v[36:39], v[72:75], a[56:63], v0
    v_max_u32 v14, v14, v23
    v_smfmac_f32_16x16x64_bf16 v[40:43], v[64:67], a[144:151], v0
    ds_write_b128 v2, v[20:23] offset:4096
    v_cmp_eq_u32 vcc, -1, v14
    v_smfmac_f32_16x16x64_bf16 v[44:47], v[64:67], a[152:159], v0
    s_mov_b32 m0, s30
    s_cbranch_vccnz L_rec0_lspin
L_rec0_lok:
    v_smfmac_f32_16x16x64_bf16 v[24:27], v[20:23], v[128:135], v0
    buffer_load_dwordx4 v1, s[8:11], s20 offen sc1 lds
    s_add_u32 m0, s30, 4096
    v_smfmac_f32_16x16x64_bf16 v[28:31], v[20:23], v[136:143], v0
    s_mov_b64 exec, s[96:97]
    buffer_store_dword v15, v1, s[8:11], s59 offen sc1
    s_mov_b64 exec, -1
    v_smfmac_f32_16x16x64_bf16 v[32:35], v[20:23], a[64:71], v0
    s_waitcnt lgkmcnt(0)
    s_barrier
    v_smfmac_f32_16x16x64_bf16 v[36:39], v[20:23], a[72:79], v0
    ds_read_b128 v[76:79], v3 offset:4096
    v_smfmac_f32_16x16x64_bf16 v[40:43], v[68:71], a[160:167], v0
    ds_read_b128 v[80:83], v4 offset:4096
    buffer_load_dwordx4 v1, s[8:11], s23 offen sc1 lds
    v_smfmac_f32_16x16x64_bf16 v[44:47], v[68:71], a[168:175], v0
    ds_read_b128 v[84:87], v5 offset:4096
    s_mov_b32 m0, s85
    s_xor_b32 s30, s30, 8192
    v_smfmac_f32_16x16x64_bf16 v[40:43], v[72:75], a[176:183], v0
    s_waitcnt lgkmcnt(2)
    v_mov_b32 v14, -1
    v_smfmac_f32_16x16x64_bf16 v[24:27], v[76:79], v[144:151], v0
    s_mov_b64 exec, 3
    buffer_load_dword v1, s[8:11], s37 offen sc1 lds
    s_mov_b64 exec, -1
    v_smfmac_f32_16x16x64_bf16 v[28:31], v[76:79], v[152:159], v0
    buffer_load_dwordx4 v[56:59], v1, s[8:11], s21 offen sc1
    s_waitcnt lgkmcnt(1)
    v_smfmac_f32_16x16x64_bf16 v[24:27], v[80:83], v[160:167], v0
    v_smfmac_f32_16x16x64_bf16 v[28:31], v[80:83], v[168:175], v0
    s_waitcnt lgkmcnt(0)
    s_add_u32 s29, s29, 8192
    s_add_u32 s42, s42, 8192
    v_smfmac_f32_16x16x64_bf16 v[24:27], v[84:87], v[176:183], v0
    s_add_u32 s90, s90, 8192
    v_smfmac_f32_16x16x64_bf16 v[28:31], v[84:87], v[184:191], v0
    buffer_load_dwordx4 v[60:63], v1, s[8:11], s21 offen offset:1024 sc1
    v_smfmac_f32_16x16x64_bf16 v[32:35], v[76:79], a[80:87], v0
    s_cmp_lt_u32 s6, 62
    s_cselect_b32 s35, 262144, 0
    v_smfmac_f32_16x16x64_bf16 v[36:39], v[76:79], a[88:95], v0
    s_add_u32 s20, s20, s35
    s_add_u32 s21, s21, s35
    v_smfmac_f32_16x16x64_bf16 v[32:35], v[80:83], a[96:103], v0
    v_add_f32 v24, v24, v26
    v_add_f32 v28, v28, v30
    v_add_f32 v25, v25, v27
    v_add_f32 v29, v29, v31
    v_cvt_pk_bf16_f32 v14, v24, v28
    v_cvt_pk_bf16_f32 v15, v25, v29
    ds_write2_b32 v7, v14, v15 offset0:0 offset1:72
    v_smfmac_f32_16x16x64_bf16 v[36:39], v[80:83], a[104:111], v0
    ds_read_b128 v[24:27], v6 offset:4096
    buffer_store_dwordx4 v[88:91], v1, s[8:11], s22 offen sc1
    v_smfmac_f32_16x16x64_bf16 v[32:35], v[84:87], a[112:119], v0
    ds_read_b128 v[28:31], v6 offset:5120
    v_smfmac_f32_16x16x64_bf16 v[36:39], v[84:87], a[120:127], v0
    v_smfmac_f32_16x16x64_bf16 v[44:47], v[72:75], a[184:191], v0
    s_waitcnt lgkmcnt(2)
    s_barrier
    v_smfmac_f32_16x16x64_bf16 v[40:43], v[20:23], a[192:199], v0
    ds_read_b128 v[96:99], v8 offset:0
    ds_read_b128 v[100:103], v8 offset:64
    v_add_f32 v32, v32, v34
    v_add_f32 v36, v36, v38
    v_add_f32 v33, v33, v35
    ds_read_b128 v[104:107], v8 offset:128
    v_add_f32 v37, v37, v39
    v_cvt_pk_bf16_f32 v14, v32, v36
    v_cvt_pk_bf16_f32 v15, v33, v37
    ds_read_b128 v[108:111], v8 offset:192
    v_smfmac_f32_16x16x64_bf16 v[44:47], v[20:23], a[200:207], v0
    ds_write_b32 v7, v14 offset:2304
    ds_write_b32 v7, v15 offset:2592
    v_smfmac_f32_16x16x64_bf16 v[40:43], v[76:79], a[208:215], v0
    s_waitcnt lgkmcnt(2)
    v_mfma_f32_16x16x32_bf16 v[88:91], v[112:115], v[96:99], 0
    ds_read_b128 v[112:115], v6 offset:6144
    v_mfma_f32_16x16x32_bf16 v[88:91], v[116:119], v[100:103], v[88:91]
    ds_read_b128 v[116:119], v6 offset:7168
    v_mfma_f32_16x16x32_bf16 v[88:91], v[120:123], v[104:107], v[88:91]
    s_waitcnt lgkmcnt(2)
    s_barrier
    v_mfma_f32_16x16x32_bf16 v[88:91], v[124:127], v[108:111], v[88:91]
    ds_read_b128 v[32:35], v9 offset:0
    ds_read_b128 v[36:39], v9 offset:64
    v_mfma_f32_16x16x32_bf16 v[92:95], v[24:27], v[96:99], 0
    ds_read_b128 v[120:123], v9 offset:128
    ds_read_b128 v[124:127], v9 offset:192
    v_mfma_f32_16x16x32_bf16 v[92:95], v[28:31], v[100:103], v[92:95]
    s_waitcnt lgkmcnt(4)
    v_mfma_f32_16x16x32_bf16 v[92:95], v[112:115], v[104:107], v[92:95]
    v_max3_f32 v14, v88, v89, v90
    v_mfma_f32_16x16x32_bf16 v[92:95], v[116:119], v[108:111], v[92:95]
    s_waitcnt lgkmcnt(2)
    v_mfma_f32_16x16x32_bf16 v[24:27], v[32:35], v[96:99], 0
    v_mfma_f32_16x16x32_bf16 v[24:27], v[36:39], v[100:103], v[24:27]
    s_waitcnt lgkmcnt(0)
    v_mfma_f32_16x16x32_bf16 v[24:27], v[120:123], v[104:107], v[24:27]
    v_max3_f32 v15, v91, v92, v93
    v_max3_f32 v14, v14, v94, v95
    v_mfma_f32_16x16x32_bf16 v[24:27], v[124:127], v[108:111], v[24:27]
    v_max_f32 v14, v14, v15
    v_mov_b32 v15, v14
    v_smfmac_f32_16x16x64_bf16 v[44:47], v[76:79], a[216:223], v0
    ds_read_b128 v[112:115], v1 offset:20480
    v_permlane16_swap_b32 v14, v15
    v_max_f32 v14, v14, v15
    v_mov_b32 v15, v14
    v_smfmac_f32_16x16x64_bf16 v[40:43], v[80:83], a[224:231], v0
    ds_read_b128 v[116:119], v1 offset:21504
    v_permlane32_swap_b32 v14, v15
    v_max_f32 v14, v14, v15
    v_mul_f32 v14, s31, v14
    v_smfmac_f32_16x16x64_bf16 v[44:47], v[80:83], a[232:239], v0
    ds_read_b128 v[120:123], v1 offset:22528
    v_fma_f32 v88, v88, s31, -v14
    v_fma_f32 v89, v89, s31, -v14
    v_fma_f32 v90, v90, s31, -v14
    v_fma_f32 v91, v91, s31, -v14
    v_smfmac_f32_16x16x64_bf16 v[40:43], v[84:87], a[240:247], v0
    ds_read_b128 v[124:127], v1 offset:23552
    v_fma_f32 v92, v92, s31, -v14
    v_fma_f32 v93, v93, s31, -v14
    v_fma_f32 v94, v94, s31, -v14
    v_fma_f32 v95, v95, s31, -v14
    v_smfmac_f32_16x16x64_bf16 v[44:47], v[84:87], a[248:255], v0
    ds_read_b128 v[64:67], v1 offset:16384
    v_exp_f32 v88, v88
    v_exp_f32 v89, v89
    v_exp_f32 v90, v90
    v_exp_f32 v91, v91
    v_exp_f32 v92, v92
    v_exp_f32 v93, v93
    v_exp_f32 v94, v94
    v_exp_f32 v95, v95
    v_fma_f32 v26, v24, s31, -v14
    v_cvt_pk_bf16_f32 v88, v88, v89
    v_cvt_pk_bf16_f32 v89, v90, v91
    v_cvt_pk_bf16_f32 v90, v92, v93
    v_cvt_pk_bf16_f32 v91, v94, v95
    v_fma_f32 v27, v25, s31, -v14
    v_mov_b64 v[92:93], s[40:41]
    v_mfma_f32_16x16x32_bf16 v[32:35], v[48:51], v[88:91], 0
    ds_read_b128 v[68:71], v1 offset:17408
    v_max_f32 v15, v26, v27
    v_mov_b64 v[94:95], s[40:41]
    v_mfma_f32_16x16x32_bf16 v[36:39], v[52:55], v[88:91], 0
    ds_read_b128 v[72:75], v1 offset:18432
    v_cmp_lt_f32 vcc, s39, v15
    v_add_f32 v40, v40, v42
    v_mfma_f32_16x16x32_bf16 v[28:31], v[92:95], v[88:91], 0
    ds_read_b128 v[76:79], v1 offset:19456
    v_add_f32 v41, v41, v43
    v_add_f32 v44, v44, v46
    v_add_f32 v45, v45, v47
    v_mov_b32 v97, 0
    v_mov_b32 v98, 0
    s_cbranch_vccnz L_rec0_slow
L_rec0_back:
    v_exp_f32 v26, v26
    v_exp_f32 v27, v27
    v_cvt_pk_bf16_f32 v42, v40, v41
    v_cvt_pk_bf16_f32 v96, v26, v27
    v_cvt_pk_bf16_f32 v43, v44, v45
    v_cvt_pk_bf16_f32 v99, v26, v27
    v_mfma_f32_16x16x16_bf16 v[28:31], v[92:93], v[96:97], v[28:31]
    ds_write2_b32 v7, v42, v43 offset0:0 offset1:72
    v_mfma_f32_16x16x16_bf16 v[32:35], v[42:43], v[96:97], v[32:35]
    s_cmp_eq_u32 s6, 63
    v_mov_b64 v[48:49], 0
    v_mfma_f32_16x16x16_bf16 v[36:39], v[42:43], v[98:99], v[36:39]
    s_nop 0
    v_mov_b64 v[50:51], 0
    s_cbranch_scc1 L_rec_done
    v_rcp_f32 v28, v28
    v_mov_b64 v[52:53], 0
    v_mov_b32 v29, v28
    v_mov_b64 v[54:55], 0
    v_pk_mul_f32 v[32:33], v[32:33], v[28:29]
    v_pk_mul_f32 v[34:35], v[34:35], v[28:29]
    v_pk_mul_f32 v[36:37], v[36:37], v[28:29]
    v_pk_mul_f32 v[38:39], v[38:39], v[28:29]
    v_cvt_pk_bf16_f32 v16, v32, v36
    v_cvt_pk_bf16_f32 v17, v33, v37
    v_cvt_pk_bf16_f32 v18, v34, v38
    v_cvt_pk_bf16_f32 v19, v35, v39
    ds_write_b128 v10, v[16:19]
    v_mov_b64 v[24:25], 0
    v_mov_b64 v[26:27], 0
    v_mov_b64 v[28:29], 0
    v_mov_b64 v[30:31], 0
    v_mov_b64 v[32:33], 0
    v_mov_b64 v[34:35], 0
    v_mov_b64 v[36:37], 0
    v_mov_b64 v[38:39], 0
    v_mov_b64 v[40:41], 0
    v_mov_b64 v[42:43], 0
    v_mov_b64 v[44:45], 0
    v_mov_b64 v[46:47], 0
    s_waitcnt lgkmcnt(0)
    s_barrier
    ds_read_b128 v[16:19], v11
    ds_read_b128 v[20:23], v11 offset:128
    v_mov_b32 v14, 0
    s_nop 3
    v_mov_b32 v14, 0
    s_nop 3
    s_waitcnt lgkmcnt(1)
    v_smfmac_f32_16x16x64_bf16 v[24:27], v[16:19], v[192:199], v0
    v_smfmac_f32_16x16x64_bf16 v[28:31], v[16:19], v[200:207], v0
    s_waitcnt lgkmcnt(0)
    v_smfmac_f32_16x16x64_bf16 v[24:27], v[20:23], v[208:215], v0
    ds_read_b128 v[96:99], v1 offset:24576
    v_smfmac_f32_16x16x64_bf16 v[28:31], v[20:23], v[216:223], v0
    ds_read_b128 v[100:103], v1 offset:25600
    v_smfmac_f32_16x16x64_bf16 v[32:35], v[16:19], v[224:231], v0
    ds_read_b128 v[104:107], v1 offset:26624
    v_smfmac_f32_16x16x64_bf16 v[36:39], v[16:19], v[232:239], v0
    ds_read_b128 v[108:111], v1 offset:27648
    v_add_f32 v24, v24, v26
    v_add_f32 v25, v25, v27
    v_smfmac_f32_16x16x64_bf16 v[32:35], v[20:23], v[240:247], v0
    ds_read_b128 v[80:83], v1 offset:28672
    v_add_f32 v28, v28, v30
    v_add_f32 v29, v29, v31
    v_cvt_pk_bf16_f32 v26, v24, v28
    v_smfmac_f32_16x16x64_bf16 v[36:39], v[20:23], v[248:255], v0
    ds_read_b128 v[84:87], v1 offset:29696
    v_cvt_pk_bf16_f32 v27, v25, v29
    v_bfi_b32 v26, 1, s7, v26
    buffer_store_dwordx2 v[26:27], v12, s[8:11], s24 offen
    v_smfmac_f32_16x16x64_bf16 v[40:43], v[16:19], v[64:71], v0
    ds_read_b128 v[88:91], v1 offset:30720
    v_smfmac_f32_16x16x64_bf16 v[44:47], v[16:19], v[72:79], v0
    ds_read_b128 v[92:95], v1 offset:31744
    v_add_f32 v32, v32, v34
    v_add_f32 v33, v33, v35
    v_smfmac_f32_16x16x64_bf16 v[40:43], v[20:23], v[112:119], v0
    v_add_f32 v36, v36, v38
    v_add_f32 v37, v37, v39
    v_cvt_pk_bf16_f32 v34, v32, v36
    v_smfmac_f32_16x16x64_bf16 v[44:47], v[20:23], v[120:127], v0
    s_waitcnt lgkmcnt(0)
    v_cvt_pk_bf16_f32 v35, v33, v37
    v_bfi_b32 v34, 1, s7, v34
    buffer_store_dwordx2 v[34:35], v12, s[8:11], s25 offen
    v_smfmac_f32_16x16x64_bf16 v[48:51], v[16:19], v[96:103], v0
    s_cmp_lt_u32 s88, 16
    v_subrev_u32 v15, s43, v1
    v_smfmac_f32_16x16x64_bf16 v[52:55], v[16:19], v[104:111], v0
    v_add_f32 v40, v40, v42
    v_add_f32 v41, v41, v43
    v_smfmac_f32_16x16x64_bf16 v[48:51], v[20:23], v[80:87], v0
    v_add_f32 v44, v44, v46
    v_add_f32 v45, v45, v47
    v_cvt_pk_bf16_f32 v42, v40, v44
    v_smfmac_f32_16x16x64_bf16 v[52:55], v[20:23], v[88:95], v0
    v_cvt_pk_bf16_f32 v43, v41, v45
    v_bfi_b32 v42, 1, s7, v42
    buffer_store_dwordx2 v[42:43], v12, s[8:11], s86 offen
    v_add_u32 v15, 162816, v15
    v_add_f32 v48, v48, v50
    v_add_f32 v49, v49, v51
    s_nop 1
    v_add_f32 v52, v52, v54
    v_add_f32 v53, v53, v55
    v_cvt_pk_bf16_f32 v50, v48, v52
    v_cvt_pk_bf16_f32 v51, v49, v53
    v_bfi_b32 v50, 1, s7, v50
    buffer_store_dwordx2 v[50:51], v12, s[8:11], s87 offen
    s_cbranch_scc1 L_rec0_early
    ds_read_b128 v[40:43], v15
    s_waitcnt vmcnt(4)
    v_mov_b64 v[48:49], v[56:57]
    ds_read_b128 v[64:67], v1 offset:0
    v_mov_b64 v[50:51], v[58:59]
    ds_read_b128 v[68:71], v1 offset:1024
    v_mov_b64 v[52:53], v[60:61]
    ds_read_b128 v[72:75], v1 offset:2048
    v_mov_b64 v[54:55], v[62:63]
    ds_read_b128 v[76:79], v1 offset:3072
    v_mov_b64 v[24:25], 0
    ds_read_b128 v[80:83], v1 offset:4096
    v_mov_b64 v[26:27], 0
    ds_read_b128 v[84:87], v1 offset:5120
    v_mov_b64 v[28:29], 0
    ds_read_b128 v[88:91], v1 offset:6144
    v_mov_b64 v[30:31], 0
    ds_read_b128 v[92:95], v1 offset:7168
    v_xor_b32 v6, 8192, v6
    ds_read_b128 v[96:99], v1 offset:8192
    v_mov_b32 v14, 0
    ds_read_b128 v[100:103], v1 offset:9216
    v_mov_b32 v14, 0
    ds_read_b128 v[104:107], v1 offset:10240
    v_mov_b32 v14, 0
    ds_read_b128 v[108:111], v1 offset:11264
    v_mov_b32 v14, 0
    ds_read_b128 v[112:115], v1 offset:12288
    v_mov_b32 v14, 0
    ds_read_b128 v[116:119], v1 offset:13312
    v_mov_b32 v14, 0
    ds_read_b128 v[120:123], v1 offset:14336
    v_mov_b32 v14, 0
    buffer_load_dwordx4 v[32:35], v1, s[8:11], s26 offen sc1
    buffer_load_dwordx4 v[36:39], v1, s[8:11], s26 offen offset:1024 sc1
    ds_read_b128 v[124:127], v1 offset:15360
    v_mov_b32 v14, 0
    ds_read_b64 v[56:57], v8 offset:2560
    v_mov_b32 v14, 0
    s_nop 3
    v_mov_b32 v14, 0
    s_nop 3
    v_mov_b32 v14, 0
    s_nop 3
    v_mov_b32 v14, 0
    s_nop 3
    v_mov_b32 v14, 0
    s_nop 3
    v_mov_b32 v14, 0
    s_nop 3
    v_mov_b32 v14, 0
    s_nop 3
    v_mov_b32 v14, 0
    s_nop 3
    s_branch L_rec0_ppc
L_rec0_early:
    ds_read_b128 v[40:43], v15
    s_waitcnt vmcnt(4)
    v_mov_b64 v[48:49], v[56:57]
    ds_read_b128 v[64:67], v1 offset:0
    v_mov_b64 v[50:51], v[58:59]
    ds_read_b128 v[68:71], v1 offset:1024
    v_mov_b64 v[52:53], v[60:61]
    ds_read_b128 v[72:75], v1 offset:2048
    v_mov_b64 v[54:55], v[62:63]
    ds_read_b128 v[76:79], v1 offset:3072
    v_mov_b64 v[24:25], 0
    ds_read_b128 v[80:83], v1 offset:4096
    v_mov_b64 v[26:27], 0
    ds_read_b128 v[84:87], v1 offset:5120
    v_mov_b64 v[28:29], 0
    ds_read_b128 v[88:91], v1 offset:6144
    v_mov_b64 v[30:31], 0
    ds_read_b128 v[92:95], v1 offset:7168
    v_xor_b32 v6, 8192, v6
    buffer_load_dwordx4 v[32:35], v1, s[8:11], s26 offen sc1
    buffer_load_dwordx4 v[36:39], v1, s[8:11], s26 offen offset:1024 sc1
    ds_read_b128 v[96:99], v1 offset:8192
    v_mov_b32 v14, 0
    ds_read_b128 v[100:103], v1 offset:9216
    v_mov_b32 v14, 0
    ds_read_b128 v[104:107], v1 offset:10240
    v_mov_b32 v14, 0
    ds_read_b128 v[108:111], v1 offset:11264
    v_mov_b32 v14, 0
    ds_read_b128 v[112:115], v1 offset:12288
    v_mov_b32 v14, 0
    ds_read_b128 v[116:119], v1 offset:13312
    v_mov_b32 v14, 0
    ds_read_b128 v[120:123], v1 offset:14336
    v_mov_b32 v14, 0
    ds_read_b128 v[124:127], v1 offset:15360
    v_mov_b32 v14, 0
    ds_read_b64 v[56:57], v8 offset:2560
    v_mov_b32 v14, 0
    s_nop 3
    s_branch L_rec0_ppc
L_rec0_pp:
    s_mov_b64 exec, vcc
    buffer_load_dwordx4 v[32:35], v1, s[8:11], s26 offen sc1
    buffer_load_dwordx4 v[36:39], v1, s[8:11], s26 offen offset:1024 sc1
    s_sub_u32 s34, s34, 1
    s_cbranch_scc1 L_rec_fail
    v_mov_b32 v14, 0
    s_nop 3
    v_mov_b32 v14, 0
    s_nop 3
    v_mov_b32 v14, 0
    s_nop 3
    v_mov_b32 v14, 0
    s_nop 3
    v_mov_b32 v14, 0
    s_nop 3
    v_mov_b32 v14, 0
    s_nop 3
    v_mov_b32 v14, 0
    s_nop 3
    v_mov_b32 v14, 0
    s_nop 3
L_rec0_ppc:
    v_mov_b32 v14, 0
    s_waitcnt vmcnt(0) lgkmcnt(0)
    v_bitop3_b32 v15, v32, v36, s7 bitop3:0x7e
    v_and_b32 v15, 1, v15
    v_cmp_eq_u32 vcc, 1, v15
    s_mov_b64 exec, -1
    v_mfma_f32_16x16x32_bf16 v[44:47], v[40:43], v[32:35], 0
    v_mfma_f32_16x16x32_bf16 v[44:47], v[40:43], v[36:39], v[44:47]
    s_cbranch_vccnz L_rec0_pp
L_rec0_ppd:
    s_cmp_lt_u32 s88, 16
    s_cbranch_scc1 L_rec0_nofe
    buffer_load_dwordx4 v[16:19], v1, s[8:11], s29 offen sc1
L_rec0_nofe:
    s_add_u32 s6, s6, 1
    s_xor_b32 s7, s7, 1
    s_add_u32 s22, s22, 131072
    s_cmp_lt_u32 s88, 16
    s_nop 0
    v_add_f32_dpp v44, v44, v44 row_ror:8 row_mask:0xf bank_mask:0xf
    v_add_f32_dpp v45, v45, v45 row_ror:8 row_mask:0xf bank_mask:0xf
    s_nop 0
    v_add_f32_dpp v44, v44, v44 row_ror:4 row_mask:0xf bank_mask:0xf
    v_add_f32_dpp v45, v45, v45 row_ror:4 row_mask:0xf bank_mask:0xf
    v_cvt_pk_bf16_f32 v15, v44, v45
    v_min_u32 v15, -2, v15
    buffer_store_dword v15, v13, s[8:11], s28 offen
    v_mov_b64 v[32:33], 0
    v_mov_b64 v[34:35], 0
    v_mov_b64 v[36:37], 0
    v_mov_b64 v[38:39], 0
    v_mov_b64 v[40:41], 0
    v_mov_b64 v[42:43], 0
    v_mov_b64 v[44:45], 0
    v_mov_b64 v[46:47], 0
    v_min_u32 v56, v56, v57
    s_add_u32 s28, s28, 8192
    v_readfirstlane_b32 s37, v56
    s_cmp_eq_u32 s37, 0
    s_cbranch_scc1 L_rec0_kvwait
L_rec0_kvok:
    s_cmp_lt_u32 s88, 16
    s_cbranch_scc1 L_rec0_fee
    v_mov_b32 v14, 0
    s_nop 3
    v_mov_b32 v14, 0
    s_nop 3
    v_mov_b32 v14, 0
    s_waitcnt vmcnt(1)
    v_max3_u32 v14, v16, v17, v18
    v_max_u32 v14, v14, v19
    v_cmp_eq_u32 vcc, -1, v14
    ds_write_b128 v2, v[16:19]
    s_mov_b64 exec, -1
    s_cbranch_vccz L_rec0_loop
    s_branch L_rec0_fp
L_rec0_fee:
    v_mov_b32 v14, 0
    s_nop 3
    v_mov_b32 v14, 0
    s_nop 3
    v_mov_b32 v14, 0
    s_nop 3
    v_mov_b32 v14, 0
    s_nop 3
    v_mov_b32 v14, 0
    s_nop 3
    s_mov_b64 vcc, -1
L_rec0_fp:
    s_mov_b64 exec, vcc
    buffer_load_dwordx4 v[16:19], v1, s[8:11], s29 offen sc1
    s_sub_u32 s34, s34, 1
    s_cbranch_scc1 L_rec_fail
    v_mov_b32 v14, 0
    s_nop 3
    v_mov_b32 v14, 0
    s_nop 3
    v_mov_b32 v14, 0
    s_nop 3
    v_mov_b32 v14, 0
    s_nop 3
    v_mov_b32 v14, 0
    s_nop 3
    v_mov_b32 v14, 0
    s_nop 3
    v_mov_b32 v14, 0
    s_nop 3
    v_mov_b32 v14, 0
    s_waitcnt vmcnt(0)
    v_max3_u32 v14, v16, v17, v18
    v_max_u32 v14, v14, v19
    v_cmp_eq_u32 vcc, -1, v14
    ds_write_b128 v2, v[16:19]
    s_mov_b64 exec, -1
    s_cbranch_vccz L_rec0_loop
    s_branch L_rec0_fp
L_rec0_lspin:
    s_mov_b64 exec, vcc
    buffer_load_dwordx4 v[20:23], v1, s[8:11], s42 offen sc1
    s_sub_u32 s34, s34, 1
    s_cbranch_scc1 L_rec_fail
    v_mov_b32 v14, 0
    s_nop 3
    v_mov_b32 v14, 0
    s_nop 3
    v_mov_b32 v14, 0
    s_nop 3
    v_mov_b32 v14, 0
    s_nop 3
    v_mov_b32 v14, 0
    s_nop 3
    v_mov_b32 v14, 0
    s_nop 3
    v_mov_b32 v14, 0
    s_nop 3
    v_mov_b32 v14, 0
    s_waitcnt vmcnt(0)
    v_max3_u32 v14, v20, v21, v22
    v_max_u32 v14, v14, v23
    v_cmp_eq_u32 vcc, -1, v14
    ds_write_b128 v2, v[20:23] offset:4096
    s_mov_b64 exec, -1
    s_cbranch_vccz L_rec0_lok
    s_branch L_rec0_lspin
L_rec0_slow:
    v_max_f32 v15, 0, v15
    v_mov_b32 v24, v15
    s_nop 1
    v_permlane16_swap_b32 v15, v24
    v_max_f32 v15, v15, v24
    v_mov_b32 v24, v15
    s_nop 1
    v_permlane32_swap_b32 v15, v24
    v_max_f32 v15, v15, v24
    v_sub_f32 v26, v26, v15
    v_sub_f32 v27, v27, v15
    v_sub_f32 v15, 0, v15
    v_exp_f32 v15, v15
    s_nop 7
    v_mul_f32 v32, v32, v15
    v_mul_f32 v33, v33, v15
    v_mul_f32 v34, v34, v15
    v_mul_f32 v35, v35, v15
    v_mul_f32 v36, v36, v15
    v_mul_f32 v37, v37, v15
    v_mul_f32 v38, v38, v15
    v_mul_f32 v39, v39, v15
    v_mul_f32 v28, v28, v15
    v_mul_f32 v29, v29, v15
    v_mul_f32 v30, v30, v15
    v_mul_f32 v31, v31, v15
    s_branch L_rec0_back
L_rec0_kvwait:
    s_mov_b64 exec, 3
    s_mov_b32 s35, 400000
L_rkv_30:
    buffer_load_dword v14, v1, s[8:11], s36 offen sc1
    s_waitcnt vmcnt(0)
    v_cmp_eq_u32 vcc, 0, v14
    s_cbranch_vccz L_rkvd_31
    s_sub_u32 s35, s35, 1
    s_cbranch_scc1 L_rec_fail
    s_sleep 2
    s_branch L_rkv_30
L_rkvd_31:
    s_mov_b64 exec, -1
    s_branch L_rec0_kvok
    .p2align 6
L_rec1_loop:
    buffer_load_dwordx4 v[20:23], v1, s[8:11], s42 offen sc1
    v_smfmac_f32_16x16x64_bf16 v[24:27], v[16:19], v[64:71], v0
    v_smfmac_f32_16x16x64_bf16 v[28:31], v[16:19], v[72:79], v0
    s_waitcnt lgkmcnt(0)
    s_barrier
    v_smfmac_f32_16x16x64_bf16 v[32:35], v[16:19], a[0:7], v0
    ds_read_b128 v[64:67], v3 offset:0
    v_smfmac_f32_16x16x64_bf16 v[36:39], v[16:19], a[8:15], v0
    ds_read_b128 v[68:71], v4 offset:0
    v_smfmac_f32_16x16x64_bf16 v[40:43], v[16:19], a[128:135], v0
    ds_read_b128 v[72:75], v5 offset:0
    v_smfmac_f32_16x16x64_bf16 v[44:47], v[16:19], a[136:143], v0
    s_waitcnt lgkmcnt(2)
    v_smfmac_f32_16x16x64_bf16 v[24:27], v[64:67], v[80:87], v0
    s_add_u32 s36, s6, 3
    s_lshr_b32 s36, s36, 1
    s_min_u32 s36, s36, 31
    v_smfmac_f32_16x16x64_bf16 v[28:31], v[64:67], v[88:95], v0
    s_waitcnt lgkmcnt(1)
    s_lshl_b32 s36, s36, 11
    s_add_u32 s36, s36, s58
    v_smfmac_f32_16x16x64_bf16 v[24:27], v[68:71], v[96:103], v0
    ds_read_b32 v88, v7 offset:2304
    ds_read_b32 v89, v7 offset:2592
    v_smfmac_f32_16x16x64_bf16 v[28:31], v[68:71], v[104:111], v0
    s_waitcnt lgkmcnt(2)
    s_max_u32 s35, s6, 1
    s_sub_u32 s35, s35, 1
    v_smfmac_f32_16x16x64_bf16 v[24:27], v[72:75], v[112:119], v0
    ds_read2_b32 v[90:91], v7 offset0:0 offset1:72
    v_mov_b32 v15, s35
    v_smfmac_f32_16x16x64_bf16 v[28:31], v[72:75], v[120:127], v0
    s_add_u32 s23, s20, 4096
    s_xor_b32 s84, s84, 1
    s_cselect_b32 s37, s36, s90
    v_smfmac_f32_16x16x64_bf16 v[32:35], v[64:67], a[16:23], v0
    ds_read_b128 v[112:115], v6 offset:0
    s_cselect_b32 s85, 158208, s83
    v_smfmac_f32_16x16x64_bf16 v[36:39], v[64:67], a[24:31], v0
    ds_read_b128 v[116:119], v6 offset:1024
    v_smfmac_f32_16x16x64_bf16 v[32:35], v[68:71], a[32:39], v0
    ds_read_b128 v[120:123], v6 offset:2048
    v_smfmac_f32_16x16x64_bf16 v[36:39], v[68:71], a[40:47], v0
    ds_read_b128 v[124:127], v6 offset:3072
    v_smfmac_f32_16x16x64_bf16 v[32:35], v[72:75], a[48:55], v0
    s_waitcnt vmcnt(0)
    v_max3_u32 v14, v20, v21, v22
    v_smfmac_f32_16x16x64_bf16 v[36:39], v[72:75], a[56:63], v0
    v_max_u32 v14, v14, v23
    v_smfmac_f32_16x16x64_bf16 v[40:43], v[64:67], a[144:151], v0
    ds_write_b128 v2, v[20:23] offset:4096
    v_cmp_eq_u32 vcc, -1, v14
    v_smfmac_f32_16x16x64_bf16 v[44:47], v[64:67], a[152:159], v0
    s_mov_b32 m0, s30
    s_cbranch_vccnz L_rec1_lspin
L_rec1_lok:
    v_smfmac_f32_16x16x64_bf16 v[24:27], v[20:23], v[128:135], v0
    buffer_load_dwordx4 v1, s[8:11], s20 offen sc1 lds
    s_add_u32 m0, s30, 4096
    v_smfmac_f32_16x16x64_bf16 v[28:31], v[20:23], v[136:143], v0
    s_mov_b64 exec, s[96:97]
    buffer_store_dword v15, v1, s[8:11], s59 offen sc1
    s_mov_b64 exec, -1
    v_smfmac_f32_16x16x64_bf16 v[32:35], v[20:23], a[64:71], v0
    s_waitcnt lgkmcnt(0)
    s_barrier
    v_smfmac_f32_16x16x64_bf16 v[36:39], v[20:23], a[72:79], v0
    ds_read_b128 v[76:79], v3 offset:4096
    v_smfmac_f32_16x16x64_bf16 v[40:43], v[68:71], a[160:167], v0
    ds_read_b128 v[80:83], v4 offset:4096
    buffer_load_dwordx4 v1, s[8:11], s23 offen sc1 lds
    v_smfmac_f32_16x16x64_bf16 v[44:47], v[68:71], a[168:175], v0
    ds_read_b128 v[84:87], v5 offset:4096
    s_mov_b32 m0, s85
    s_xor_b32 s30, s30, 8192
    v_smfmac_f32_16x16x64_bf16 v[40:43], v[72:75], a[176:183], v0
    s_waitcnt lgkmcnt(2)
    v_mov_b32 v14, -1
    v_smfmac_f32_16x16x64_bf16 v[24:27], v[76:79], v[144:151], v0
    s_mov_b64 exec, 3
    buffer_load_dword v1, s[8:11], s37 offen sc1 lds
    s_mov_b64 exec, -1
    v_smfmac_f32_16x16x64_bf16 v[28:31], v[76:79], v[152:159], v0
    buffer_load_dwordx4 v[56:59], v1, s[8:11], s21 offen sc1
    s_waitcnt lgkmcnt(1)
    v_smfmac_f32_16x16x64_bf16 v[24:27], v[80:83], v[160:167], v0
    v_smfmac_f32_16x16x64_bf16 v[28:31], v[80:83], v[168:175], v0
    s_waitcnt lgkmcnt(0)
    s_add_u32 s29, s29, 8192
    s_add_u32 s42, s42, 8192
    v_smfmac_f32_16x16x64_bf16 v[24:27], v[84:87], v[176:183], v0
    s_add_u32 s90, s90, 8192
    v_smfmac_f32_16x16x64_bf16 v[28:31], v[84:87], v[184:191], v0
    buffer_load_dwordx4 v[60:63], v1, s[8:11], s21 offen offset:1024 sc1
    v_smfmac_f32_16x16x64_bf16 v[32:35], v[76:79], a[80:87], v0
    s_cmp_lt_u32 s6, 62
    s_cselect_b32 s35, 262144, 0
    v_smfmac_f32_16x16x64_bf16 v[36:39], v[76:79], a[88:95], v0
    s_add_u32 s20, s20, s35
    s_add_u32 s21, s21, s35
    v_smfmac_f32_16x16x64_bf16 v[32:35], v[80:83], a[96:103], v0
    v_add_f32 v24, v24, v26
    v_add_f32 v28, v28, v30
    v_add_f32 v25, v25, v27
    v_add_f32 v29, v29, v31
    v_cvt_pk_bf16_f32 v14, v24, v28
    v_cvt_pk_bf16_f32 v15, v25, v29
    ds_write2_b32 v7, v14, v15 offset0:0 offset1:72
    v_smfmac_f32_16x16x64_bf16 v[36:39], v[80:83], a[104:111], v0
    ds_read_b128 v[24:27], v6 offset:4096
    buffer_store_dwordx4 v[88:91], v1, s[8:11], s22 offen sc1
    v_smfmac_f32_16x16x64_bf16 v[32:35], v[84:87], a[112:119], v0
    ds_read_b128 v[28:31], v6 offset:5120
    v_smfmac_f32_16x16x64_bf16 v[36:39], v[84:87], a[120:127], v0
    v_smfmac_f32_16x16x64_bf16 v[44:47], v[72:75], a[184:191], v0
    s_waitcnt lgkmcnt(2)
    s_barrier
    v_smfmac_f32_16x16x64_bf16 v[40:43], v[20:23], a[192:199], v0
    ds_read_b128 v[96:99], v8 offset:0
    ds_read_b128 v[100:103], v8 offset:64
    v_add_f32 v32, v32, v34
    v_add_f32 v36, v36, v38
    v_add_f32 v33, v33, v35
    ds_read_b128 v[104:107], v8 offset:128
    v_add_f32 v37, v37, v39
    v_cvt_pk_bf16_f32 v14, v32, v36
    v_cvt_pk_bf16_f32 v15, v33, v37
    ds_read_b128 v[108:111], v8 offset:192
    v_smfmac_f32_16x16x64_bf16 v[44:47], v[20:23], a[200:207], v0
    ds_write_b32 v7, v14 offset:2304
    ds_write_b32 v7, v15 offset:2592
    v_smfmac_f32_16x16x64_bf16 v[40:43], v[76:79], a[208:215], v0
    s_waitcnt lgkmcnt(2)
    v_mfma_f32_16x16x32_bf16 v[88:91], v[112:115], v[96:99], 0
    ds_read_b128 v[112:115], v6 offset:6144
    v_mfma_f32_16x16x32_bf16 v[88:91], v[116:119], v[100:103], v[88:91]
    ds_read_b128 v[116:119], v6 offset:7168
    v_mfma_f32_16x16x32_bf16 v[88:91], v[120:123], v[104:107], v[88:91]
    s_waitcnt lgkmcnt(2)
    s_barrier
    v_mfma_f32_16x16x32_bf16 v[88:91], v[124:127], v[108:111], v[88:91]
    ds_read_b128 v[32:35], v9 offset:0
    ds_read_b128 v[36:39], v9 offset:64
    v_mfma_f32_16x16x32_bf16 v[92:95], v[24:27], v[96:99], 0
    ds_read_b128 v[120:123], v9 offset:128
    ds_read_b128 v[124:127], v9 offset:192
    v_mfma_f32_16x16x32_bf16 v[92:95], v[28:31], v[100:103], v[92:95]
    s_waitcnt lgkmcnt(4)
    v_mfma_f32_16x16x32_bf16 v[92:95], v[112:115], v[104:107], v[92:95]
    v_max3_f32 v14, v88, v89, v90
    v_mfma_f32_16x16x32_bf16 v[92:95], v[116:119], v[108:111], v[92:95]
    s_waitcnt lgkmcnt(2)
    v_mfma_f32_16x16x32_bf16 v[24:27], v[32:35], v[96:99], 0
    v_mfma_f32_16x16x32_bf16 v[24:27], v[36:39], v[100:103], v[24:27]
    s_waitcnt lgkmcnt(0)
    v_mfma_f32_16x16x32_bf16 v[24:27], v[120:123], v[104:107], v[24:27]
    v_max3_f32 v15, v91, v92, v93
    v_max3_f32 v14, v14, v94, v95
    v_mfma_f32_16x16x32_bf16 v[24:27], v[124:127], v[108:111], v[24:27]
    v_max_f32 v14, v14, v15
    v_mov_b32 v15, v14
    v_smfmac_f32_16x16x64_bf16 v[44:47], v[76:79], a[216:223], v0
    ds_read_b128 v[112:115], v1 offset:20480
    v_permlane16_swap_b32 v14, v15
    v_max_f32 v14, v14, v15
    v_mov_b32 v15, v14
    v_smfmac_f32_16x16x64_bf16 v[40:43], v[80:83], a[224:231], v0
    ds_read_b128 v[116:119], v1 offset:21504
    v_permlane32_swap_b32 v14, v15
    v_max_f32 v14, v14, v15
    v_mul_f32 v14, s31, v14
    v_smfmac_f32_16x16x64_bf16 v[44:47], v[80:83], a[232:239], v0
    ds_read_b128 v[120:123], v1 offset:22528
    v_fma_f32 v88, v88, s31, -v14
    v_fma_f32 v89, v89, s31, -v14
    v_fma_f32 v90, v90, s31, -v14
    v_fma_f32 v91, v91, s31, -v14
    v_smfmac_f32_16x16x64_bf16 v[40:43], v[84:87], a[240:247], v0
    ds_read_b128 v[124:127], v1 offset:23552
    v_fma_f32 v92, v92, s31, -v14
    v_fma_f32 v93, v93, s31, -v14
    v_fma_f32 v94, v94, s31, -v14
    v_fma_f32 v95, v95, s31, -v14
    v_smfmac_f32_16x16x64_bf16 v[44:47], v[84:87], a[248:255], v0
    ds_read_b128 v[64:67], v1 offset:16384
    v_exp_f32 v88, v88
    v_exp_f32 v89, v89
    v_exp_f32 v90, v90
    v_exp_f32 v91, v91
    v_exp_f32 v92, v92
    v_exp_f32 v93, v93
    v_exp_f32 v94, v94
    v_exp_f32 v95, v95
    v_fma_f32 v26, v24, s31, -v14
    v_cvt_pk_bf16_f32 v88, v88, v89
    v_cvt_pk_bf16_f32 v89, v90, v91
    v_cvt_pk_bf16_f32 v90, v92, v93
    v_cvt_pk_bf16_f32 v91, v94, v95
    v_fma_f32 v27, v25, s31, -v14
    v_mov_b64 v[92:93], s[40:41]
    v_mfma_f32_16x16x32_bf16 v[32:35], v[48:51], v[88:91], 0
    ds_read_b128 v[68:71], v1 offset:17408
    v_max_f32 v15, v26, v27
    v_mov_b64 v[94:95], s[40:41]
    v_mfma_f32_16x16x32_bf16 v[36:39], v[52:55], v[88:91], 0
    ds_read_b128 v[72:75], v1 offset:18432
    v_cmp_lt_f32 vcc, s39, v15
    v_add_f32 v40, v40, v42
    v_mfma_f32_16x16x32_bf16 v[28:31], v[92:95], v[88:91], 0
    ds_read_b128 v[76:79], v1 offset:19456
    v_add_f32 v41, v41, v43
    v_add_f32 v44, v44, v46
    v_add_f32 v45, v45, v47
    v_mov_b32 v97, 0
    v_mov_b32 v98, 0
    s_cbranch_vccnz L_rec1_slow
L_rec1_back:
    v_exp_f32 v26, v26
    v_exp_f32 v27, v27
    v_cvt_pk_bf16_f32 v42, v40, v41
    v_cvt_pk_bf16_f32 v96, v26, v27
    v_cvt_pk_bf16_f32 v43, v44, v45
    v_cvt_pk_bf16_f32 v99, v26, v27
    v_mfma_f32_16x16x16_bf16 v[28:31], v[92:93], v[96:97], v[28:31]
    ds_write2_b32 v7, v42, v43 offset0:0 offset1:72
    v_mfma_f32_16x16x16_bf16 v[32:35], v[42:43], v[96:97], v[32:35]
    s_cmp_eq_u32 s6, 63
    v_mov_b64 v[48:49], 0
    v_mfma_f32_16x16x16_bf16 v[36:39], v[42:43], v[98:99], v[36:39]
    s_nop 0
    v_mov_b64 v[50:51], 0
    s_cbranch_scc1 L_rec_done
    v_rcp_f32 v28, v28
    v_mov_b64 v[52:53], 0
    v_mov_b32 v29, v28
    v_mov_b64 v[54:55], 0
    v_pk_mul_f32 v[32:33], v[32:33], v[28:29]
    v_pk_mul_f32 v[34:35], v[34:35], v[28:29]
    v_pk_mul_f32 v[36:37], v[36:37], v[28:29]
    v_pk_mul_f32 v[38:39], v[38:39], v[28:29]
    v_cvt_pk_bf16_f32 v16, v32, v36
    v_cvt_pk_bf16_f32 v17, v33, v37
    v_cvt_pk_bf16_f32 v18, v34, v38
    v_cvt_pk_bf16_f32 v19, v35, v39
    ds_write_b128 v10, v[16:19]
    v_mov_b64 v[24:25], 0
    v_mov_b64 v[26:27], 0
    v_mov_b64 v[28:29], 0
    v_mov_b64 v[30:31], 0
    v_mov_b64 v[32:33], 0
    v_mov_b64 v[34:35], 0
    v_mov_b64 v[36:37], 0
    v_mov_b64 v[38:39], 0
    v_mov_b64 v[40:41], 0
    v_mov_b64 v[42:43], 0
    v_mov_b64 v[44:45], 0
    v_mov_b64 v[46:47], 0
    s_waitcnt lgkmcnt(0)
    s_barrier
    ds_read_b128 v[16:19], v11
    ds_read_b128 v[20:23], v11 offset:128
    v_mov_b32 v14, 0
    s_nop 3
    v_mov_b32 v14, 0
    s_nop 3
    s_waitcnt lgkmcnt(1)
    v_smfmac_f32_16x16x64_bf16 v[24:27], v[16:19], v[192:199], v0
    v_smfmac_f32_16x16x64_bf16 v[28:31], v[16:19], v[200:207], v0
    s_waitcnt lgkmcnt(0)
    v_smfmac_f32_16x16x64_bf16 v[24:27], v[20:23], v[208:215], v0
    ds_read_b128 v[96:99], v1 offset:24576
    v_smfmac_f32_16x16x64_bf16 v[28:31], v[20:23], v[216:223], v0
    ds_read_b128 v[100:103], v1 offset:25600
    v_smfmac_f32_16x16x64_bf16 v[32:35], v[16:19], v[224:231], v0
    ds_read_b128 v[104:107], v1 offset:26624
    v_smfmac_f32_16x16x64_bf16 v[36:39], v[16:19], v[232:239], v0
    ds_read_b128 v[108:111], v1 offset:27648
    v_add_f32 v24, v24, v26
    v_add_f32 v25, v25, v27
    v_smfmac_f32_16x16x64_bf16 v[32:35], v[20:23], v[240:247], v0
    ds_read_b128 v[80:83], v1 offset:28672
    v_add_f32 v28, v28, v30
    v_add_f32 v29, v29, v31
    v_cvt_pk_bf16_f32 v26, v24, v28
    v_smfmac_f32_16x16x64_bf16 v[36:39], v[20:23], v[248:255], v0
    ds_read_b128 v[84:87], v1 offset:29696
    v_cvt_pk_bf16_f32 v27, v25, v29
    v_bfi_b32 v26, 1, s7, v26
    buffer_store_dwordx2 v[26:27], v12, s[8:11], s24 offen sc1
    v_smfmac_f32_16x16x64_bf16 v[40:43], v[16:19], v[64:71], v0
    ds_read_b128 v[88:91], v1 offset:30720
    v_smfmac_f32_16x16x64_bf16 v[44:47], v[16:19], v[72:79], v0
    ds_read_b128 v[92:95], v1 offset:31744
    v_add_f32 v32, v32, v34
    v_add_f32 v33, v33, v35
    v_smfmac_f32_16x16x64_bf16 v[40:43], v[20:23], v[112:119], v0
    v_add_f32 v36, v36, v38
    v_add_f32 v37, v37, v39
    v_cvt_pk_bf16_f32 v34, v32, v36
    v_smfmac_f32_16x16x64_bf16 v[44:47], v[20:23], v[120:127], v0
    s_waitcnt lgkmcnt(0)
    v_cvt_pk_bf16_f32 v35, v33, v37
    v_bfi_b32 v34, 1, s7, v34
    buffer_store_dwordx2 v[34:35], v12, s[8:11], s25 offen sc1
    v_smfmac_f32_16x16x64_bf16 v[48:51], v[16:19], v[96:103], v0
    s_cmp_lt_u32 s88, 16
    v_subrev_u32 v15, s43, v1
    v_smfmac_f32_16x16x64_bf16 v[52:55], v[16:19], v[104:111], v0
    v_add_f32 v40, v40, v42
    v_add_f32 v41, v41, v43
    v_smfmac_f32_16x16x64_bf16 v[48:51], v[20:23], v[80:87], v0
    v_add_f32 v44, v44, v46
    v_add_f32 v45, v45, v47
    v_cvt_pk_bf16_f32 v42, v40, v44
    v_smfmac_f32_16x16x64_bf16 v[52:55], v[20:23], v[88:95], v0
    v_cvt_pk_bf16_f32 v43, v41, v45
    v_bfi_b32 v42, 1, s7, v42
    buffer_store_dwordx2 v[42:43], v12, s[8:11], s86 offen sc1
    v_add_u32 v15, 162816, v15
    v_add_f32 v48, v48, v50
    v_add_f32 v49, v49, v51
    s_nop 1
    v_add_f32 v52, v52, v54
    v_add_f32 v53, v53, v55
    v_cvt_pk_bf16_f32 v50, v48, v52
    v_cvt_pk_bf16_f32 v51, v49, v53
    v_bfi_b32 v50, 1, s7, v50
    buffer_store_dwordx2 v[50:51], v12, s[8:11], s87 offen sc1
    s_cbranch_scc1 L_rec1_early
    ds_read_b128 v[40:43], v15
    s_waitcnt vmcnt(4)
    v_mov_b64 v[48:49], v[56:57]
    ds_read_b128 v[64:67], v1 offset:0
    v_mov_b64 v[50:51], v[58:59]
    ds_read_b128 v[68:71], v1 offset:1024
    v_mov_b64 v[52:53], v[60:61]
    ds_read_b128 v[72:75], v1 offset:2048
    v_mov_b64 v[54:55], v[62:63]
    ds_read_b128 v[76:79], v1 offset:3072
    v_mov_b64 v[24:25], 0
    ds_read_b128 v[80:83], v1 offset:4096
    v_mov_b64 v[26:27], 0
    ds_read_b128 v[84:87], v1 offset:5120
    v_mov_b64 v[28:29], 0
    ds_read_b128 v[88:91], v1 offset:6144
    v_mov_b64 v[30:31], 0
    ds_read_b128 v[92:95], v1 offset:7168
    v_xor_b32 v6, 8192, v6
    ds_read_b128 v[96:99], v1 offset:8192
    v_mov_b32 v14, 0
    ds_read_b128 v[100:103], v1 offset:9216
    v_mov_b32 v14, 0
    ds_read_b128 v[104:107], v1 offset:10240
    v_mov_b32 v14, 0
    ds_read_b128 v[108:111], v1 offset:11264
    v_mov_b32 v14, 0
    ds_read_b128 v[112:115], v1 offset:12288
    v_mov_b32 v14, 0
    ds_read_b128 v[116:119], v1 offset:13312
    v_mov_b32 v14, 0
    ds_read_b128 v[120:123], v1 offset:14336
    v_mov_b32 v14, 0
    buffer_load_dwordx4 v[32:35], v1, s[8:11], s26 offen sc1
    buffer_load_dwordx4 v[36:39], v1, s[8:11], s26 offen offset:1024 sc1
    ds_read_b128 v[124:127], v1 offset:15360
    v_mov_b32 v14, 0
    ds_read_b64 v[56:57], v8 offset:2560
    v_mov_b32 v14, 0
    s_nop 3
    v_mov_b32 v14, 0
    s_nop 3
    v_mov_b32 v14, 0
    s_nop 3
    v_mov_b32 v14, 0
    s_nop 3
    v_mov_b32 v14, 0
    s_nop 3
    v_mov_b32 v14, 0
    s_nop 3
    v_mov_b32 v14, 0
    s_nop 3
    v_mov_b32 v14, 0
    s_nop 3
    s_branch L_rec1_ppc
L_rec1_early:
    ds_read_b128 v[40:43], v15
    s_waitcnt vmcnt(4)
    v_mov_b64 v[48:49], v[56:57]
    ds_read_b128 v[64:67], v1 offset:0
    v_mov_b64 v[50:51], v[58:59]
    ds_read_b128 v[68:71], v1 offset:1024
    v_mov_b64 v[52:53], v[60:61]
    ds_read_b128 v[72:75], v1 offset:2048
    v_mov_b64 v[54:55], v[62:63]
    ds_read_b128 v[76:79], v1 offset:3072
    v_mov_b64 v[24:25], 0
    ds_read_b128 v[80:83], v1 offset:4096
    v_mov_b64 v[26:27], 0
    ds_read_b128 v[84:87], v1 offset:5120
    v_mov_b64 v[28:29], 0
    ds_read_b128 v[88:91], v1 offset:6144
    v_mov_b64 v[30:31], 0
    ds_read_b128 v[92:95], v1 offset:7168
    v_xor_b32 v6, 8192, v6
    buffer_load_dwordx4 v[32:35], v1, s[8:11], s26 offen sc1
    buffer_load_dwordx4 v[36:39], v1, s[8:11], s26 offen offset:1024 sc1
    ds_read_b128 v[96:99], v1 offset:8192
    v_mov_b32 v14, 0
    ds_read_b128 v[100:103], v1 offset:9216
    v_mov_b32 v14, 0
    ds_read_b128 v[104:107], v1 offset:10240
    v_mov_b32 v14, 0
    ds_read_b128 v[108:111], v1 offset:11264
    v_mov_b32 v14, 0
    ds_read_b128 v[112:115], v1 offset:12288
    v_mov_b32 v14, 0
    ds_read_b128 v[116:119], v1 offset:13312
    v_mov_b32 v14, 0
    ds_read_b128 v[120:123], v1 offset:14336
    v_mov_b32 v14, 0
    ds_read_b128 v[124:127], v1 offset:15360
    v_mov_b32 v14, 0
    ds_read_b64 v[56:57], v8 offset:2560
    v_mov_b32 v14, 0
    s_nop 3
    s_branch L_rec1_ppc
L_rec1_pp:
    s_mov_b64 exec, vcc
    buffer_load_dwordx4 v[32:35], v1, s[8:11], s26 offen sc1
    buffer_load_dwordx4 v[36:39], v1, s[8:11], s26 offen offset:1024 sc1
    s_sub_u32 s34, s34, 1
    s_cbranch_scc1 L_rec_fail
    v_mov_b32 v14, 0
    s_nop 3
    v_mov_b32 v14, 0
    s_nop 3
    v_mov_b32 v14, 0
    s_nop 3
    v_mov_b32 v14, 0
    s_nop 3
    v_mov_b32 v14, 0
    s_nop 3
    v_mov_b32 v14, 0
    s_nop 3
    v_mov_b32 v14, 0
    s_nop 3
    v_mov_b32 v14, 0
    s_nop 3
L_rec1_ppc:
    v_mov_b32 v14, 0
    s_waitcnt vmcnt(0) lgkmcnt(0)
    v_bitop3_b32 v15, v32, v36, s7 bitop3:0x7e
    v_and_b32 v15, 1, v15
    v_cmp_eq_u32 vcc, 1, v15
    s_mov_b64 exec, -1
    v_mfma_f32_16x16x32_bf16 v[44:47], v[40:43], v[32:35], 0
    v_mfma_f32_16x16x32_bf16 v[44:47], v[40:43], v[36:39], v[44:47]
    s_cbranch_vccnz L_rec1_pp
L_rec1_ppd:
    s_cmp_lt_u32 s88, 16
    s_cbranch_scc1 L_rec1_nofe
    buffer_load_dwordx4 v[16:19], v1, s[8:11], s29 offen sc1
L_rec1_nofe:
    s_add_u32 s6, s6, 1
    s_xor_b32 s7, s7, 1
    s_add_u32 s22, s22, 131072
    s_cmp_lt_u32 s88, 16
    s_nop 0
    v_add_f32_dpp v44, v44, v44 row_ror:8 row_mask:0xf bank_mask:0xf
    v_add_f32_dpp v45, v45, v45 row_ror:8 row_mask:0xf bank_mask:0xf
    s_nop 0
    v_add_f32_dpp v44, v44, v44 row_ror:4 row_mask:0xf bank_mask:0xf
    v_add_f32_dpp v45, v45, v45 row_ror:4 row_mask:0xf bank_mask:0xf
    v_cvt_pk_bf16_f32 v15, v44, v45
    v_min_u32 v15, -2, v15
    buffer_store_dword v15, v13, s[8:11], s28 offen sc1
    v_mov_b64 v[32:33], 0
    v_mov_b64 v[34:35], 0
    v_mov_b64 v[36:37], 0
    v_mov_b64 v[38:39], 0
    v_mov_b64 v[40:41], 0
    v_mov_b64 v[42:43], 0
    v_mov_b64 v[44:45], 0
    v_mov_b64 v[46:47], 0
    v_min_u32 v56, v56, v57
    s_add_u32 s28, s28, 8192
    v_readfirstlane_b32 s37, v56
    s_cmp_eq_u32 s37, 0
    s_cbranch_scc1 L_rec1_kvwait
L_rec1_kvok:
    s_cmp_lt_u32 s88, 16
    s_cbranch_scc1 L_rec1_fee
    v_mov_b32 v14, 0
    s_nop 3
    v_mov_b32 v14, 0
    s_nop 3
    v_mov_b32 v14, 0
    s_waitcnt vmcnt(1)
    v_max3_u32 v14, v16, v17, v18
    v_max_u32 v14, v14, v19
    v_cmp_eq_u32 vcc, -1, v14
    ds_write_b128 v2, v[16:19]
    s_mov_b64 exec, -1
    s_cbranch_vccz L_rec1_loop
    s_branch L_rec1_fp
L_rec1_fee:
    v_mov_b32 v14, 0
    s_nop 3
    v_mov_b32 v14, 0
    s_nop 3
    v_mov_b32 v14, 0
    s_nop 3
    v_mov_b32 v14, 0
    s_nop 3
    v_mov_b32 v14, 0
    s_nop 3
    s_mov_b64 vcc, -1
L_rec1_fp:
    s_mov_b64 exec, vcc
    buffer_load_dwordx4 v[16:19], v1, s[8:11], s29 offen sc1
    s_sub_u32 s34, s34, 1
    s_cbranch_scc1 L_rec_fail
    v_mov_b32 v14, 0
    s_nop 3
    v_mov_b32 v14, 0
    s_nop 3
    v_mov_b32 v14, 0
    s_nop 3
    v_mov_b32 v14, 0
    s_nop 3
    v_mov_b32 v14, 0
    s_nop 3
    v_mov_b32 v14, 0
    s_nop 3
    v_mov_b32 v14, 0
    s_nop 3
    v_mov_b32 v14, 0
    s_waitcnt vmcnt(0)
    v_max3_u32 v14, v16, v17, v18
    v_max_u32 v14, v14, v19
    v_cmp_eq_u32 vcc, -1, v14
    ds_write_b128 v2, v[16:19]
    s_mov_b64 exec, -1
    s_cbranch_vccz L_rec1_loop
    s_branch L_rec1_fp
L_rec1_lspin:
    s_mov_b64 exec, vcc
    buffer_load_dwordx4 v[20:23], v1, s[8:11], s42 offen sc1
    s_sub_u32 s34, s34, 1
    s_cbranch_scc1 L_rec_fail
    v_mov_b32 v14, 0
    s_nop 3
    v_mov_b32 v14, 0
    s_nop 3
    v_mov_b32 v14, 0
    s_nop 3
    v_mov_b32 v14, 0
    s_nop 3
    v_mov_b32 v14, 0
    s_nop 3
    v_mov_b32 v14, 0
    s_nop 3
    v_mov_b32 v14, 0
    s_nop 3
    v_mov_b32 v14, 0
    s_waitcnt vmcnt(0)
    v_max3_u32 v14, v20, v21, v22
    v_max_u32 v14, v14, v23
    v_cmp_eq_u32 vcc, -1, v14
    ds_write_b128 v2, v[20:23] offset:4096
    s_mov_b64 exec, -1
    s_cbranch_vccz L_rec1_lok
    s_branch L_rec1_lspin
L_rec1_slow:
    v_max_f32 v15, 0, v15
    v_mov_b32 v24, v15
    s_nop 1
    v_permlane16_swap_b32 v15, v24
    v_max_f32 v15, v15, v24
    v_mov_b32 v24, v15
    s_nop 1
    v_permlane32_swap_b32 v15, v24
    v_max_f32 v15, v15, v24
    v_sub_f32 v26, v26, v15
    v_sub_f32 v27, v27, v15
    v_sub_f32 v15, 0, v15
    v_exp_f32 v15, v15
    s_nop 7
    v_mul_f32 v32, v32, v15
    v_mul_f32 v33, v33, v15
    v_mul_f32 v34, v34, v15
    v_mul_f32 v35, v35, v15
    v_mul_f32 v36, v36, v15
    v_mul_f32 v37, v37, v15
    v_mul_f32 v38, v38, v15
    v_mul_f32 v39, v39, v15
    v_mul_f32 v28, v28, v15
    v_mul_f32 v29, v29, v15
    v_mul_f32 v30, v30, v15
    v_mul_f32 v31, v31, v15
    s_branch L_rec1_back
L_rec1_kvwait:
    s_mov_b64 exec, 3
    s_mov_b32 s35, 400000
L_rkv_32:
    buffer_load_dword v14, v1, s[8:11], s36 offen sc1
    s_waitcnt vmcnt(0)
    v_cmp_eq_u32 vcc, 0, v14
    s_cbranch_vccz L_rkvd_33
    s_sub_u32 s35, s35, 1
    s_cbranch_scc1 L_rec_fail
    s_sleep 2
    s_branch L_rkv_32
L_rkvd_33:
    s_mov_b64 exec, -1
    s_branch L_rec1_kvok
L_rec_fail:
    s_mov_b64 exec, -1
    v_mov_b32 v14, 0
    v_mov_b32 v15, 0xdead
    buffer_store_dword v15, v14, s[16:19], 0 offen offset:64
    s_endpgm
L_rec_done:
    s_waitcnt lgkmcnt(0)
    ds_read_b32 v88, v7 offset:2304
    ds_read_b32 v89, v7 offset:2592
    ds_read2_b32 v[90:91], v7 offset0:0 offset1:72
    s_add_u32 s22, s22, 131072
    s_waitcnt lgkmcnt(0)
    buffer_store_dwordx4 v[88:91], v1, s[8:11], s22 offen sc1
    s_waitcnt vmcnt(0)
    s_barrier
    v_mov_b32 v15, 64
    s_mov_b64 exec, s[96:97]
    buffer_store_dword v15, v1, s[8:11], s59 offen sc1
    s_mov_b64 exec, -1
    s_branch L_m_g2pre
.section .rodata,"a"
.p2align 6
.amdhsa_kernel mega_kernel
  .amdhsa_next_free_vgpr 512
  .amdhsa_next_free_sgpr 102
  .amdhsa_accum_offset 256
  .amdhsa_group_segment_fixed_size 0
  .amdhsa_kernarg_size 120
  .amdhsa_user_sgpr_count 2
  .amdhsa_user_sgpr_kernarg_segment_ptr 1
  .amdhsa_system_sgpr_workgroup_id_x 1
.end_amdhsa_kernel
```
